```python
import torch

def _softmax(x, axis=-1):
    return torch.softmax(x, dim=axis)
def _gelu(x):
    return torch.nn.functional.gelu(x, approximate="tanh")
def _silu(x):
    return torch.nn.functional.silu(x)
def _sigmoid(x):
    return torch.sigmoid(x)
def _layernorm(x, axis=-1, eps=1e-5):
    m = x.mean(dim=axis, keepdim=True)
    v = x.var(dim=axis, keepdim=True, unbiased=False)
    return (x - m) / torch.sqrt(v + eps)
def _scatter_add(tgt, idx, src, axis=0):
    return tgt.clone().index_add_(axis, idx, src)
def _segment_sum(src, seg, n):
    out = torch.zeros((n,) + src.shape[1:], dtype=src.dtype)
    return out.index_add_(0, seg, src)
def _pad(x, pw):
    flat = tuple(v for pair in reversed(pw) for v in pair)
    return torch.nn.functional.pad(x, flat)

kernel_name = 'parallel_sum__sliding_local_dilated__swiglu_ffn__prompt'

def setup_inputs():

    _w = (lambda a: (lambda t: t.to(torch.bfloat16) if t.is_floating_point() else t)(torch.as_tensor(a)))
    def _A_setup():
        B, S, D = 1, 2048, 576
        return {
            "x": _w((lambda *s: torch.randn(*s, dtype=torch.bfloat16) * 0.05)(B, S, D)),
            "wqkv": _w((lambda *s: torch.randn(*s, dtype=torch.bfloat16) * 0.1)(D, 3 * D)),
            "wo": _w((lambda *s: torch.randn(*s, dtype=torch.bfloat16) * 0.05)(D, D)),
        }
    _A_in = _A_setup()

    def _B_setup():
        B, S, D, F = 1, 2048, 576, 4608
        return {
            "x": _w((lambda *s: torch.randn(*s, dtype=torch.bfloat16) * 0.05)(B, S, D)),
            "w_gate": _w((lambda *s: torch.randn(*s, dtype=torch.bfloat16) * 0.05)(D, F)),
            "w_up": _w((lambda *s: torch.randn(*s, dtype=torch.bfloat16) * 0.05)(D, F)),
            "w_down": _w((lambda *s: torch.randn(*s, dtype=torch.bfloat16) * 0.05)(F, D)),
        }
    _B_in = _B_setup()

    return {
        "A_x": _A_in["x"],
        "A_wqkv": _A_in["wqkv"],
        "A_wo": _A_in["wo"],
        "B_x": _B_in["x"],
        "B_w_gate": _B_in["w_gate"],
        "B_w_up": _B_in["w_up"],
        "B_w_down": _B_in["w_down"],
    }

def reference(A_x, A_wqkv, A_wo, B_x, B_w_gate, B_w_up, B_w_down):
    def _A_ref(x, wqkv, wo):
        B, S, D = x.shape
        H = 32; Dh = D // H
        W, dil = 8, 2
        qkv = (lambda x, *d: x.permute(*d))((x @ wqkv).reshape(B, S, 3, H, Dh), 2, 0, 3, 1, 4)
        q, k, v = qkv[0], qkv[1], qkv[2]
        scale = Dh ** -0.5
        pos = torch.arange(S)
        off = torch.arange(W) * dil
        idx = pos[:, None] - off[None, :]
        mask = idx >= 0
        idx_c = torch.where(mask, idx, 0).reshape(-1)
        kg = k[:, :, idx_c, :].reshape(B, H, S, W, Dh)
        vg = v[:, :, idx_c, :].reshape(B, H, S, W, Dh)
        logits = torch.einsum("bhsd,bhswd->bhsw", q, kg) * scale
        logits = torch.where(mask[None, None, :, :], logits, -1e9)
        attn = _softmax(logits, axis=-1)
        o = torch.einsum("bhsw,bhswd->bhsd", attn, vg)
        return (lambda x, *d: x.permute(*d))(o, 0, 2, 1, 3).reshape(B, S, D) @ wo

    def _B_ref(x, w_gate, w_up, w_down):
        g = _silu(x @ w_gate)
        u = x @ w_up
        return (g * u) @ w_down

    x = A_x
    xn = _layernorm(x, axis=-1)
    return x + _A_ref(xn, A_wqkv, A_wo) + _B_ref(xn, B_w_gate, B_w_up, B_w_down)
```

```asm
; @launch kernel=k0_ln_kernel grid=(424,1,1) block=(128,1,1) lds=1024
; @launch kernel=k1_main_kernel grid=(256,1,1) block=(256,1,1) lds=157696
; @launch kernel=k2_reduce_kernel grid=(576,1,1) block=(256,1,1) lds=0
.amdgcn_target "amdgcn-amd-amdhsa--gfx950"
.text
.globl k0_ln_kernel
.p2align 8
.type k0_ln_kernel,@function
k0_ln_kernel:
  s_cmp_ge_u32 s2, 424
  s_cbranch_scc1 K0_end
  s_cmp_ge_u32 s2, 416
  s_cbranch_scc1 K0_code
  s_cmp_ge_u32 s2, 128
  s_cbranch_scc1 K0_pack
  s_load_dwordx2 s[4:5], s[0:1], 0
  s_load_dwordx2 s[6:7], s[0:1], 72
  v_and_b32 v1, 63, v0
  v_lshrrev_b32 v2, 6, v0
  v_and_b32 v3, 15, v1
  v_lshrrev_b32 v4, 4, v1
  v_readfirstlane_b32 s20, v2
  s_waitcnt lgkmcnt(0)
  s_mov_b32 s8, s4
  s_and_b32 s9, s5, 0xffff
  s_mov_b32 s10, 2359296
  s_mov_b32 s11, 0x20000
  s_mov_b32 s12, s6
  s_and_b32 s13, s7, 0xffff
  s_mov_b32 s14, 2359296
  s_mov_b32 s15, 0x20000
  s_lshl_b32 s21, s2, 4
  v_add_u32 v5, s21, v3
  s_movk_i32 s22, 1152
  v_mul_lo_u32 v5, v5, s22
  v_lshlrev_b32 v6, 4, v4
  v_add_u32 v5, v5, v6
  s_mul_i32 s23, s20, 576
  buffer_load_dwordx4 v[16:19], v5, s[8:11], s23 offen offset:0
  buffer_load_dwordx4 v[20:23], v5, s[8:11], s23 offen offset:64
  buffer_load_dwordx4 v[24:27], v5, s[8:11], s23 offen offset:128
  buffer_load_dwordx4 v[28:31], v5, s[8:11], s23 offen offset:192
  buffer_load_dwordx4 v[32:35], v5, s[8:11], s23 offen offset:256
  buffer_load_dwordx4 v[36:39], v5, s[8:11], s23 offen offset:320
  buffer_load_dwordx4 v[40:43], v5, s[8:11], s23 offen offset:384
  buffer_load_dwordx4 v[44:47], v5, s[8:11], s23 offen offset:448
  buffer_load_dwordx4 v[48:51], v5, s[8:11], s23 offen offset:512
  s_add_u32 s28, s6, 44040192
  s_addc_u32 s29, s7, 0
  s_mov_b32 s32, s28
  s_and_b32 s33, s29, 0xffff
  s_mov_b32 s34, 32768
  s_mov_b32 s35, 0x20000
  v_mov_b32 v60, 0
  v_mov_b32 v61, 0
  v_mov_b32 v62, 0
  v_mov_b32 v63, 0
  v_lshlrev_b32 v59, 4, v0
  s_lshl_b32 s30, s2, 8
  v_cmp_gt_u32 vcc, 16, v0
  s_nop 3
  s_and_saveexec_b64 s[36:37], vcc
  s_cbranch_execz K0_nz
  buffer_store_dwordx4 v[60:63], v59, s[32:35], s30 offen
K0_nz:
  s_mov_b64 exec, s[36:37]
  v_mov_b32 v7, 0x3f803f80
  v_mov_b32 v8, 0
  v_mov_b32 v9, 0
  v_mov_b32 v10, 0
  v_mov_b32 v11, 0
  s_waitcnt vmcnt(8)
  v_dot2c_f32_bf16 v8, v16, v7
  v_dot2c_f32_bf16 v9, v16, v16
  v_dot2c_f32_bf16 v10, v17, v7
  v_dot2c_f32_bf16 v11, v17, v17
  v_dot2c_f32_bf16 v8, v18, v7
  v_dot2c_f32_bf16 v9, v18, v18
  v_dot2c_f32_bf16 v10, v19, v7
  v_dot2c_f32_bf16 v11, v19, v19
  s_waitcnt vmcnt(7)
  v_dot2c_f32_bf16 v8, v20, v7
  v_dot2c_f32_bf16 v9, v20, v20
  v_dot2c_f32_bf16 v10, v21, v7
  v_dot2c_f32_bf16 v11, v21, v21
  v_dot2c_f32_bf16 v8, v22, v7
  v_dot2c_f32_bf16 v9, v22, v22
  v_dot2c_f32_bf16 v10, v23, v7
  v_dot2c_f32_bf16 v11, v23, v23
  s_waitcnt vmcnt(6)
  v_dot2c_f32_bf16 v8, v24, v7
  v_dot2c_f32_bf16 v9, v24, v24
  v_dot2c_f32_bf16 v10, v25, v7
  v_dot2c_f32_bf16 v11, v25, v25
  v_dot2c_f32_bf16 v8, v26, v7
  v_dot2c_f32_bf16 v9, v26, v26
  v_dot2c_f32_bf16 v10, v27, v7
  v_dot2c_f32_bf16 v11, v27, v27
  s_waitcnt vmcnt(5)
  v_dot2c_f32_bf16 v8, v28, v7
  v_dot2c_f32_bf16 v9, v28, v28
  v_dot2c_f32_bf16 v10, v29, v7
  v_dot2c_f32_bf16 v11, v29, v29
  v_dot2c_f32_bf16 v8, v30, v7
  v_dot2c_f32_bf16 v9, v30, v30
  v_dot2c_f32_bf16 v10, v31, v7
  v_dot2c_f32_bf16 v11, v31, v31
  s_waitcnt vmcnt(4)
  v_dot2c_f32_bf16 v8, v32, v7
  v_dot2c_f32_bf16 v9, v32, v32
  v_dot2c_f32_bf16 v10, v33, v7
  v_dot2c_f32_bf16 v11, v33, v33
  v_dot2c_f32_bf16 v8, v34, v7
  v_dot2c_f32_bf16 v9, v34, v34
  v_dot2c_f32_bf16 v10, v35, v7
  v_dot2c_f32_bf16 v11, v35, v35
  s_waitcnt vmcnt(3)
  v_dot2c_f32_bf16 v8, v36, v7
  v_dot2c_f32_bf16 v9, v36, v36
  v_dot2c_f32_bf16 v10, v37, v7
  v_dot2c_f32_bf16 v11, v37, v37
  v_dot2c_f32_bf16 v8, v38, v7
  v_dot2c_f32_bf16 v9, v38, v38
  v_dot2c_f32_bf16 v10, v39, v7
  v_dot2c_f32_bf16 v11, v39, v39
  s_waitcnt vmcnt(2)
  v_dot2c_f32_bf16 v8, v40, v7
  v_dot2c_f32_bf16 v9, v40, v40
  v_dot2c_f32_bf16 v10, v41, v7
  v_dot2c_f32_bf16 v11, v41, v41
  v_dot2c_f32_bf16 v8, v42, v7
  v_dot2c_f32_bf16 v9, v42, v42
  v_dot2c_f32_bf16 v10, v43, v7
  v_dot2c_f32_bf16 v11, v43, v43
  s_waitcnt vmcnt(1)
  v_dot2c_f32_bf16 v8, v44, v7
  v_dot2c_f32_bf16 v9, v44, v44
  v_dot2c_f32_bf16 v10, v45, v7
  v_dot2c_f32_bf16 v11, v45, v45
  v_dot2c_f32_bf16 v8, v46, v7
  v_dot2c_f32_bf16 v9, v46, v46
  v_dot2c_f32_bf16 v10, v47, v7
  v_dot2c_f32_bf16 v11, v47, v47
  s_waitcnt vmcnt(0)
  v_dot2c_f32_bf16 v8, v48, v7
  v_dot2c_f32_bf16 v9, v48, v48
  v_dot2c_f32_bf16 v10, v49, v7
  v_dot2c_f32_bf16 v11, v49, v49
  v_dot2c_f32_bf16 v8, v50, v7
  v_dot2c_f32_bf16 v9, v50, v50
  v_dot2c_f32_bf16 v10, v51, v7
  v_dot2c_f32_bf16 v11, v51, v51
  s_nop 1
  v_add_f32 v8, v8, v10
  v_add_f32 v9, v9, v11
  v_mov_b32 v10, v8
  v_mov_b32 v11, v9
  v_mov_b32 v12, v8
  v_mov_b32 v13, v9
  s_nop 0
  v_permlane32_swap_b32 v10, v12
  v_permlane32_swap_b32 v11, v13
  v_add_f32 v8, v10, v12
  v_add_f32 v9, v11, v13
  v_mov_b32 v10, v8
  v_mov_b32 v11, v9
  v_mov_b32 v12, v8
  v_mov_b32 v13, v9
  s_nop 0
  v_permlane16_swap_b32 v10, v12
  v_permlane16_swap_b32 v11, v13
  v_add_f32 v8, v10, v12
  v_add_f32 v9, v11, v13
  v_lshlrev_b32 v10, 3, v0
  ds_write_b64 v10, v[8:9]
  v_xor_b32 v11, 512, v10
  s_waitcnt lgkmcnt(0)
  s_barrier
  ds_read_b64 v[12:13], v11
  s_waitcnt lgkmcnt(0)
  v_add_f32 v8, v8, v12
  v_add_f32 v9, v9, v13
  v_mul_f32 v8, 0x3ae38e39, v8
  v_mul_f32 v9, 0x3ae38e39, v9
  v_fma_f32 v9, -v8, v8, v9
  v_max_f32 v9, 0, v9
  v_add_f32 v9, 0x3727c5ac, v9
  v_rsq_f32 v9, v9
  s_nop 0
  v_mul_f32 v8, v8, v9
  v_sub_f32 v8, 0, v8
  s_mov_b32 s24, 0xffff0000
  v_lshlrev_b32 v10, 16, v16
  v_and_b32 v11, s24, v16
  v_fma_f32 v10, v10, v9, v8
  v_fma_f32 v11, v11, v9, v8
  v_cvt_pk_bf16_f32 v16, v10, v11
  v_lshlrev_b32 v12, 16, v17
  v_and_b32 v13, s24, v17
  v_fma_f32 v12, v12, v9, v8
  v_fma_f32 v13, v13, v9, v8
  v_cvt_pk_bf16_f32 v17, v12, v13
  v_lshlrev_b32 v10, 16, v18
  v_and_b32 v11, s24, v18
  v_fma_f32 v10, v10, v9, v8
  v_fma_f32 v11, v11, v9, v8
  v_cvt_pk_bf16_f32 v18, v10, v11
  v_lshlrev_b32 v12, 16, v19
  v_and_b32 v13, s24, v19
  v_fma_f32 v12, v12, v9, v8
  v_fma_f32 v13, v13, v9, v8
  v_cvt_pk_bf16_f32 v19, v12, v13
  v_lshlrev_b32 v10, 16, v20
  v_and_b32 v11, s24, v20
  v_fma_f32 v10, v10, v9, v8
  v_fma_f32 v11, v11, v9, v8
  v_cvt_pk_bf16_f32 v20, v10, v11
  v_lshlrev_b32 v12, 16, v21
  v_and_b32 v13, s24, v21
  v_fma_f32 v12, v12, v9, v8
  v_fma_f32 v13, v13, v9, v8
  v_cvt_pk_bf16_f32 v21, v12, v13
  v_lshlrev_b32 v10, 16, v22
  v_and_b32 v11, s24, v22
  v_fma_f32 v10, v10, v9, v8
  v_fma_f32 v11, v11, v9, v8
  v_cvt_pk_bf16_f32 v22, v10, v11
  v_lshlrev_b32 v12, 16, v23
  v_and_b32 v13, s24, v23
  v_fma_f32 v12, v12, v9, v8
  v_fma_f32 v13, v13, v9, v8
  v_cvt_pk_bf16_f32 v23, v12, v13
  v_lshlrev_b32 v10, 16, v24
  v_and_b32 v11, s24, v24
  v_fma_f32 v10, v10, v9, v8
  v_fma_f32 v11, v11, v9, v8
  v_cvt_pk_bf16_f32 v24, v10, v11
  v_lshlrev_b32 v12, 16, v25
  v_and_b32 v13, s24, v25
  v_fma_f32 v12, v12, v9, v8
  v_fma_f32 v13, v13, v9, v8
  v_cvt_pk_bf16_f32 v25, v12, v13
  v_lshlrev_b32 v10, 16, v26
  v_and_b32 v11, s24, v26
  v_fma_f32 v10, v10, v9, v8
  v_fma_f32 v11, v11, v9, v8
  v_cvt_pk_bf16_f32 v26, v10, v11
  v_lshlrev_b32 v12, 16, v27
  v_and_b32 v13, s24, v27
  v_fma_f32 v12, v12, v9, v8
  v_fma_f32 v13, v13, v9, v8
  v_cvt_pk_bf16_f32 v27, v12, v13
  v_lshlrev_b32 v10, 16, v28
  v_and_b32 v11, s24, v28
  v_fma_f32 v10, v10, v9, v8
  v_fma_f32 v11, v11, v9, v8
  v_cvt_pk_bf16_f32 v28, v10, v11
  v_lshlrev_b32 v12, 16, v29
  v_and_b32 v13, s24, v29
  v_fma_f32 v12, v12, v9, v8
  v_fma_f32 v13, v13, v9, v8
  v_cvt_pk_bf16_f32 v29, v12, v13
  v_lshlrev_b32 v10, 16, v30
  v_and_b32 v11, s24, v30
  v_fma_f32 v10, v10, v9, v8
  v_fma_f32 v11, v11, v9, v8
  v_cvt_pk_bf16_f32 v30, v10, v11
  v_lshlrev_b32 v12, 16, v31
  v_and_b32 v13, s24, v31
  v_fma_f32 v12, v12, v9, v8
  v_fma_f32 v13, v13, v9, v8
  v_cvt_pk_bf16_f32 v31, v12, v13
  v_lshlrev_b32 v10, 16, v32
  v_and_b32 v11, s24, v32
  v_fma_f32 v10, v10, v9, v8
  v_fma_f32 v11, v11, v9, v8
  v_cvt_pk_bf16_f32 v32, v10, v11
  v_lshlrev_b32 v12, 16, v33
  v_and_b32 v13, s24, v33
  v_fma_f32 v12, v12, v9, v8
  v_fma_f32 v13, v13, v9, v8
  v_cvt_pk_bf16_f32 v33, v12, v13
  v_lshlrev_b32 v10, 16, v34
  v_and_b32 v11, s24, v34
  v_fma_f32 v10, v10, v9, v8
  v_fma_f32 v11, v11, v9, v8
  v_cvt_pk_bf16_f32 v34, v10, v11
  v_lshlrev_b32 v12, 16, v35
  v_and_b32 v13, s24, v35
  v_fma_f32 v12, v12, v9, v8
  v_fma_f32 v13, v13, v9, v8
  v_cvt_pk_bf16_f32 v35, v12, v13
  v_lshlrev_b32 v10, 16, v36
  v_and_b32 v11, s24, v36
  v_fma_f32 v10, v10, v9, v8
  v_fma_f32 v11, v11, v9, v8
  v_cvt_pk_bf16_f32 v36, v10, v11
  v_lshlrev_b32 v12, 16, v37
  v_and_b32 v13, s24, v37
  v_fma_f32 v12, v12, v9, v8
  v_fma_f32 v13, v13, v9, v8
  v_cvt_pk_bf16_f32 v37, v12, v13
  v_lshlrev_b32 v10, 16, v38
  v_and_b32 v11, s24, v38
  v_fma_f32 v10, v10, v9, v8
  v_fma_f32 v11, v11, v9, v8
  v_cvt_pk_bf16_f32 v38, v10, v11
  v_lshlrev_b32 v12, 16, v39
  v_and_b32 v13, s24, v39
  v_fma_f32 v12, v12, v9, v8
  v_fma_f32 v13, v13, v9, v8
  v_cvt_pk_bf16_f32 v39, v12, v13
  v_lshlrev_b32 v10, 16, v40
  v_and_b32 v11, s24, v40
  v_fma_f32 v10, v10, v9, v8
  v_fma_f32 v11, v11, v9, v8
  v_cvt_pk_bf16_f32 v40, v10, v11
  v_lshlrev_b32 v12, 16, v41
  v_and_b32 v13, s24, v41
  v_fma_f32 v12, v12, v9, v8
  v_fma_f32 v13, v13, v9, v8
  v_cvt_pk_bf16_f32 v41, v12, v13
  v_lshlrev_b32 v10, 16, v42
  v_and_b32 v11, s24, v42
  v_fma_f32 v10, v10, v9, v8
  v_fma_f32 v11, v11, v9, v8
  v_cvt_pk_bf16_f32 v42, v10, v11
  v_lshlrev_b32 v12, 16, v43
  v_and_b32 v13, s24, v43
  v_fma_f32 v12, v12, v9, v8
  v_fma_f32 v13, v13, v9, v8
  v_cvt_pk_bf16_f32 v43, v12, v13
  v_lshlrev_b32 v10, 16, v44
  v_and_b32 v11, s24, v44
  v_fma_f32 v10, v10, v9, v8
  v_fma_f32 v11, v11, v9, v8
  v_cvt_pk_bf16_f32 v44, v10, v11
  v_lshlrev_b32 v12, 16, v45
  v_and_b32 v13, s24, v45
  v_fma_f32 v12, v12, v9, v8
  v_fma_f32 v13, v13, v9, v8
  v_cvt_pk_bf16_f32 v45, v12, v13
  v_lshlrev_b32 v10, 16, v46
  v_and_b32 v11, s24, v46
  v_fma_f32 v10, v10, v9, v8
  v_fma_f32 v11, v11, v9, v8
  v_cvt_pk_bf16_f32 v46, v10, v11
  v_lshlrev_b32 v12, 16, v47
  v_and_b32 v13, s24, v47
  v_fma_f32 v12, v12, v9, v8
  v_fma_f32 v13, v13, v9, v8
  v_cvt_pk_bf16_f32 v47, v12, v13
  v_lshlrev_b32 v10, 16, v48
  v_and_b32 v11, s24, v48
  v_fma_f32 v10, v10, v9, v8
  v_fma_f32 v11, v11, v9, v8
  v_cvt_pk_bf16_f32 v48, v10, v11
  v_lshlrev_b32 v12, 16, v49
  v_and_b32 v13, s24, v49
  v_fma_f32 v12, v12, v9, v8
  v_fma_f32 v13, v13, v9, v8
  v_cvt_pk_bf16_f32 v49, v12, v13
  v_lshlrev_b32 v10, 16, v50
  v_and_b32 v11, s24, v50
  v_fma_f32 v10, v10, v9, v8
  v_fma_f32 v11, v11, v9, v8
  v_cvt_pk_bf16_f32 v50, v10, v11
  v_lshlrev_b32 v12, 16, v51
  v_and_b32 v13, s24, v51
  v_fma_f32 v12, v12, v9, v8
  v_fma_f32 v13, v13, v9, v8
  v_cvt_pk_bf16_f32 v51, v12, v13
  v_lshlrev_b32 v6, 4, v1
  s_mul_i32 s25, s2, 18432
  s_mul_i32 s26, s20, 9216
  s_add_u32 s25, s25, s26
  buffer_store_dwordx4 v[16:19], v6, s[12:15], s25 offen offset:0
  buffer_store_dwordx4 v[20:23], v6, s[12:15], s25 offen offset:1024
  buffer_store_dwordx4 v[24:27], v6, s[12:15], s25 offen offset:2048
  buffer_store_dwordx4 v[28:31], v6, s[12:15], s25 offen offset:3072
  s_add_u32 s25, s25, 4096
  buffer_store_dwordx4 v[32:35], v6, s[12:15], s25 offen offset:0
  buffer_store_dwordx4 v[36:39], v6, s[12:15], s25 offen offset:1024
  buffer_store_dwordx4 v[40:43], v6, s[12:15], s25 offen offset:2048
  buffer_store_dwordx4 v[44:47], v6, s[12:15], s25 offen offset:3072
  s_add_u32 s25, s25, 4096
  buffer_store_dwordx4 v[48:51], v6, s[12:15], s25 offen offset:0
  s_endpgm
K0_pack:
  s_load_dwordx2 s[4:5], s[0:1], 8
  s_load_dwordx2 s[6:7], s[0:1], 72
  v_and_b32 v1, 63, v0
  v_lshrrev_b32 v2, 6, v0
  s_nop 0
  v_readfirstlane_b32 s20, v2
  s_sub_u32 s21, s2, 128
  s_lshl_b32 s21, s21, 1
  s_nop 1
  s_add_u32 s21, s21, s20
  s_waitcnt lgkmcnt(0)
  s_mov_b32 s12, s4
  s_and_b32 s13, s5, 0xffff
  s_mov_b32 s14, 1990656
  s_mov_b32 s15, 0x20000
  s_add_u32 s6, s6, 2621440
  s_addc_u32 s7, s7, 0
  s_mov_b32 s16, s6
  s_and_b32 s17, s7, 0xffff
  s_mov_b32 s18, 2359296
  s_mov_b32 s19, 0x20000
  v_and_b32 v3, 15, v1
  v_lshrrev_b32 v4, 4, v1
  v_lshlrev_b32 v9, 4, v1
  s_lshl_b32 s22, s21, 2
  s_add_u32 s22, s22, 0
  s_mul_hi_u32 s23, s22, 29826162
  s_mul_i32 s24, s23, 144
  s_sub_u32 s24, s22, s24
  s_mul_hi_u32 s25, s24, 715827883
  s_mul_i32 s26, s25, 6
  s_sub_u32 s26, s24, s26
  s_lshr_b32 s27, s25, 2
  s_and_b32 s28, s25, 3
  s_mul_i32 s29, s27, 96
  s_lshl_b32 s30, s26, 4
  s_add_u32 s29, s29, s30
  s_lshl_b32 s30, s28, 2
  s_add_u32 s29, s29, s30
  v_add_u32 v5, s29, v4
  s_lshr_b32 s30, s28, 1
  s_lshl_b32 s30, s30, 2
  v_or_b32 v6, s30, v4
  v_lshrrev_b32 v7, 1, v3
  v_xor_b32 v6, v6, v7
  v_lshlrev_b32 v6, 1, v6
  v_and_b32 v7, 1, v3
  v_or_b32 v6, v6, v7
  v_mul_u32_u24 v7, 13, v6
  v_lshrrev_b32 v7, 6, v7
  v_min_u32 v7, 2, v7
  v_mul_u32_u24 v8, 5, v7
  v_sub_u32 v8, v6, v8
  v_lshlrev_b32 v8, 4, v8
  v_add_u32 v7, 1, v7
  v_cmp_eq_u32 vcc, 3, v7
  v_mov_b32 v10, 0
  s_nop 0
  v_cndmask_b32 v7, v7, v10, vcc
  v_mul_u32_u24 v7, 1152, v7
  v_add_u32 v8, v8, v7
  s_mul_i32 s30, s23, 72
  v_add_u32 v8, s30, v8
  v_mul_u32_u24 v5, 3456, v5
  v_add_u32 v5, v5, v8
  buffer_load_dwordx4 v[16:19], v5, s[12:15], 0 offen
  s_lshl_b32 s22, s21, 2
  s_add_u32 s22, s22, 1
  s_mul_hi_u32 s23, s22, 29826162
  s_mul_i32 s24, s23, 144
  s_sub_u32 s24, s22, s24
  s_mul_hi_u32 s25, s24, 715827883
  s_mul_i32 s26, s25, 6
  s_sub_u32 s26, s24, s26
  s_lshr_b32 s27, s25, 2
  s_and_b32 s28, s25, 3
  s_mul_i32 s29, s27, 96
  s_lshl_b32 s30, s26, 4
  s_add_u32 s29, s29, s30
  s_lshl_b32 s30, s28, 2
  s_add_u32 s29, s29, s30
  v_add_u32 v5, s29, v4
  s_lshr_b32 s30, s28, 1
  s_lshl_b32 s30, s30, 2
  v_or_b32 v6, s30, v4
  v_lshrrev_b32 v7, 1, v3
  v_xor_b32 v6, v6, v7
  v_lshlrev_b32 v6, 1, v6
  v_and_b32 v7, 1, v3
  v_or_b32 v6, v6, v7
  v_mul_u32_u24 v7, 13, v6
  v_lshrrev_b32 v7, 6, v7
  v_min_u32 v7, 2, v7
  v_mul_u32_u24 v8, 5, v7
  v_sub_u32 v8, v6, v8
  v_lshlrev_b32 v8, 4, v8
  v_add_u32 v7, 1, v7
  v_cmp_eq_u32 vcc, 3, v7
  v_mov_b32 v10, 0
  s_nop 0
  v_cndmask_b32 v7, v7, v10, vcc
  v_mul_u32_u24 v7, 1152, v7
  v_add_u32 v8, v8, v7
  s_mul_i32 s30, s23, 72
  v_add_u32 v8, s30, v8
  v_mul_u32_u24 v5, 3456, v5
  v_add_u32 v5, v5, v8
  buffer_load_dwordx4 v[20:23], v5, s[12:15], 0 offen
  s_lshl_b32 s22, s21, 2
  s_add_u32 s22, s22, 2
  s_mul_hi_u32 s23, s22, 29826162
  s_mul_i32 s24, s23, 144
  s_sub_u32 s24, s22, s24
  s_mul_hi_u32 s25, s24, 715827883
  s_mul_i32 s26, s25, 6
  s_sub_u32 s26, s24, s26
  s_lshr_b32 s27, s25, 2
  s_and_b32 s28, s25, 3
  s_mul_i32 s29, s27, 96
  s_lshl_b32 s30, s26, 4
  s_add_u32 s29, s29, s30
  s_lshl_b32 s30, s28, 2
  s_add_u32 s29, s29, s30
  v_add_u32 v5, s29, v4
  s_lshr_b32 s30, s28, 1
  s_lshl_b32 s30, s30, 2
  v_or_b32 v6, s30, v4
  v_lshrrev_b32 v7, 1, v3
  v_xor_b32 v6, v6, v7
  v_lshlrev_b32 v6, 1, v6
  v_and_b32 v7, 1, v3
  v_or_b32 v6, v6, v7
  v_mul_u32_u24 v7, 13, v6
  v_lshrrev_b32 v7, 6, v7
  v_min_u32 v7, 2, v7
  v_mul_u32_u24 v8, 5, v7
  v_sub_u32 v8, v6, v8
  v_lshlrev_b32 v8, 4, v8
  v_add_u32 v7, 1, v7
  v_cmp_eq_u32 vcc, 3, v7
  v_mov_b32 v10, 0
  s_nop 0
  v_cndmask_b32 v7, v7, v10, vcc
  v_mul_u32_u24 v7, 1152, v7
  v_add_u32 v8, v8, v7
  s_mul_i32 s30, s23, 72
  v_add_u32 v8, s30, v8
  v_mul_u32_u24 v5, 3456, v5
  v_add_u32 v5, v5, v8
  buffer_load_dwordx4 v[24:27], v5, s[12:15], 0 offen
  s_lshl_b32 s22, s21, 2
  s_add_u32 s22, s22, 3
  s_mul_hi_u32 s23, s22, 29826162
  s_mul_i32 s24, s23, 144
  s_sub_u32 s24, s22, s24
  s_mul_hi_u32 s25, s24, 715827883
  s_mul_i32 s26, s25, 6
  s_sub_u32 s26, s24, s26
  s_lshr_b32 s27, s25, 2
  s_and_b32 s28, s25, 3
  s_mul_i32 s29, s27, 96
  s_lshl_b32 s30, s26, 4
  s_add_u32 s29, s29, s30
  s_lshl_b32 s30, s28, 2
  s_add_u32 s29, s29, s30
  v_add_u32 v5, s29, v4
  s_lshr_b32 s30, s28, 1
  s_lshl_b32 s30, s30, 2
  v_or_b32 v6, s30, v4
  v_lshrrev_b32 v7, 1, v3
  v_xor_b32 v6, v6, v7
  v_lshlrev_b32 v6, 1, v6
  v_and_b32 v7, 1, v3
  v_or_b32 v6, v6, v7
  v_mul_u32_u24 v7, 13, v6
  v_lshrrev_b32 v7, 6, v7
  v_min_u32 v7, 2, v7
  v_mul_u32_u24 v8, 5, v7
  v_sub_u32 v8, v6, v8
  v_lshlrev_b32 v8, 4, v8
  v_add_u32 v7, 1, v7
  v_cmp_eq_u32 vcc, 3, v7
  v_mov_b32 v10, 0
  s_nop 0
  v_cndmask_b32 v7, v7, v10, vcc
  v_mul_u32_u24 v7, 1152, v7
  v_add_u32 v8, v8, v7
  s_mul_i32 s30, s23, 72
  v_add_u32 v8, s30, v8
  v_mul_u32_u24 v5, 3456, v5
  v_add_u32 v5, v5, v8
  buffer_load_dwordx4 v[28:31], v5, s[12:15], 0 offen
  s_lshl_b32 s22, s21, 12
  s_waitcnt vmcnt(3)
  buffer_store_dwordx4 v[16:19], v9, s[16:19], s22 offen offset:0
  s_waitcnt vmcnt(3)
  buffer_store_dwordx4 v[20:23], v9, s[16:19], s22 offen offset:1024
  s_waitcnt vmcnt(3)
  buffer_store_dwordx4 v[24:27], v9, s[16:19], s22 offen offset:2048
  s_waitcnt vmcnt(3)
  buffer_store_dwordx4 v[28:31], v9, s[16:19], s22 offen offset:3072
  s_endpgm
K0_code:
  s_getpc_b64 s[4:5]
K0_pc:
  s_add_u32 s4, s4, k1_main_kernel-K0_pc
  s_addc_u32 s5, s5, 0
  s_mov_b32 s8, s4
  s_and_b32 s9, s5, 0xffff
  s_mov_b32 s10, K2_end-k1_main_kernel
  s_mov_b32 s11, 0x20000
  v_lshlrev_b32 v1, 4, v0
  s_mov_b32 s12, 0
K0_cl:
  buffer_load_dwordx4 v[4:7], v1, s[8:11], s12 offen
  s_add_u32 s12, s12, 2048
  s_cmp_lt_u32 s12, s10
  s_cbranch_scc1 K0_cl
K0_end:
  s_endpgm
.globl k1_main_kernel
.p2align 8
.type k1_main_kernel,@function
k1_main_kernel:
  s_cmp_ge_u32 s2, 256
  s_cbranch_scc1 K1_end
  s_load_dwordx2 s[14:15], s[0:1], 72
  s_load_dwordx2 s[6:7], s[0:1], 16
  s_load_dwordx4 s[8:11], s[0:1], 32
  s_load_dwordx2 s[12:13], s[0:1], 48
  v_and_b32 v1, 63, v0
  v_lshrrev_b32 v4, 6, v0
  v_and_b32 v2, 15, v1
  v_lshrrev_b32 v3, 4, v1
  v_readfirstlane_b32 s20, v4
  v_lshlrev_b32 v243, 4, v1
  s_and_b32 s21, s2, 3
  s_lshl_b32 s21, s21, 2
  s_bfe_u32 s34, s2, 0x20003
  s_add_u32 s21, s21, s34
  s_bfe_u32 s22, s2, 0x10002
  s_lshl_b32 s22, s22, 3
  s_lshr_b32 s34, s2, 5
  s_add_u32 s22, s22, s34
  s_and_b32 s23, s20, 1
  s_lshr_b32 s24, s20, 1
  s_mul_i32 s25, s20, 6144
  s_lshl_b32 s34, s22, 3
  s_lshl_b32 s35, s20, 1
  s_add_u32 s34, s34, s35
  s_mul_i32 s26, s34, 18432
  s_lshr_b32 s34, s20, 1
  s_mul_i32 s17, s34, 36864
  s_and_b32 s34, s20, 1
  s_mul_i32 s34, s34, 6144
  s_add_u32 s17, s17, s34
  s_min_u32 s35, s20, 2
  s_lshl_b32 s18, s35, 10
  s_lshl_b32 s34, s22, 3
  s_sub_u32 s34, s34, 1
  s_mul_i32 s34, s34, 18432
  s_add_u32 s34, s34, s18
  s_cmp_eq_u32 s22, 0
  s_cselect_b32 s27, 0x7f000000, s34
  s_mul_i32 s36, s21, 147456
  s_add_u32 s36, s36, 2621440
  s_waitcnt lgkmcnt(0)
  s_add_u32 s34, s14, 0
  s_addc_u32 s35, s15, 0
  s_mov_b32 s48, s34
  s_and_b32 s49, s35, 0xffff
  s_mov_b32 s50, 2359296
  s_mov_b32 s51, 0x20000
  s_add_u32 s34, s14, s36
  s_addc_u32 s35, s15, 0
  s_mov_b32 s52, s34
  s_and_b32 s53, s35, 0xffff
  s_mov_b32 s54, 147456
  s_mov_b32 s55, 0x20000
  s_add_u32 m0, s17, 73728
  s_add_u32 s19, s26, 0
  buffer_load_dwordx4 v243, s[48:51], s19 offen lds
  buffer_load_dwordx4 v243, s[48:51], s19 offen offset:1024 lds
  buffer_load_dwordx4 v243, s[48:51], s19 offen offset:2048 lds
  s_add_u32 m0, s25, 0
  s_add_u32 s38, s25, 0
  buffer_load_dwordx4 v243, s[52:55], s38 offen lds
  buffer_load_dwordx4 v243, s[52:55], s38 offen offset:1024 lds
  buffer_load_dwordx4 v243, s[52:55], s38 offen offset:2048 lds
  s_add_u32 m0, s17, 76800
  s_add_u32 s19, s26, 18432
  buffer_load_dwordx4 v243, s[48:51], s19 offen lds
  buffer_load_dwordx4 v243, s[48:51], s19 offen offset:1024 lds
  buffer_load_dwordx4 v243, s[48:51], s19 offen offset:2048 lds
  s_add_u32 m0, s18, 147456
  s_add_u32 s19, s27, 0
  buffer_load_dwordx4 v243, s[48:51], s19 offen lds
  s_add_u32 m0, s25, 0
  s_add_u32 s38, s25, 0
  buffer_load_dwordx4 v243, s[52:55], s38 offen offset:3072 lds
  s_add_u32 m0, s25, 4096
  s_add_u32 s38, s25, 4096
  buffer_load_dwordx4 v243, s[52:55], s38 offen lds
  buffer_load_dwordx4 v243, s[52:55], s38 offen offset:1024 lds
  s_add_u32 m0, s17, 86016
  s_add_u32 s19, s26, 3072
  buffer_load_dwordx4 v243, s[48:51], s19 offen lds
  buffer_load_dwordx4 v243, s[48:51], s19 offen offset:1024 lds
  buffer_load_dwordx4 v243, s[48:51], s19 offen offset:2048 lds
  s_add_u32 m0, s25, 24576
  s_add_u32 s38, s25, 24576
  buffer_load_dwordx4 v243, s[52:55], s38 offen lds
  buffer_load_dwordx4 v243, s[52:55], s38 offen offset:1024 lds
  buffer_load_dwordx4 v243, s[52:55], s38 offen offset:2048 lds
  s_add_u32 m0, s17, 89088
  s_add_u32 s19, s26, 21504
  buffer_load_dwordx4 v243, s[48:51], s19 offen lds
  buffer_load_dwordx4 v243, s[48:51], s19 offen offset:1024 lds
  buffer_load_dwordx4 v243, s[48:51], s19 offen offset:2048 lds
  s_add_u32 m0, s18, 150528
  s_add_u32 s19, s27, 3072
  buffer_load_dwordx4 v243, s[48:51], s19 offen lds
  s_add_u32 m0, s25, 24576
  s_add_u32 s38, s25, 24576
  buffer_load_dwordx4 v243, s[52:55], s38 offen offset:3072 lds
  s_add_u32 m0, s25, 28672
  s_add_u32 s38, s25, 28672
  buffer_load_dwordx4 v243, s[52:55], s38 offen lds
  buffer_load_dwordx4 v243, s[52:55], s38 offen offset:1024 lds
  v_lshrrev_b32 v247, 2, v2
  v_and_b32 v244, 3, v2
  v_lshlrev_b32 v244, 3, v244
  v_and_b32 v242, 1, v3
  v_lshrrev_b32 v241, 1, v3
  v_mul_u32_u24 v4, 12288, v242
  v_lshl_add_u32 v4, v241, 10, v4
  v_lshl_add_u32 v4, v247, 8, v4
  v_add_u32 v4, v4, v244
  v_lshl_or_b32 v5, v242, 2, v247
  s_mov_b32 s34, 0x10525210
  s_mov_b32 s35, 0x63747463
  s_lshl_b32 s36, s20, 4
  s_lshr_b64 s[34:35], s[34:35], s36
  s_mov_b32 s44, s34
  s_bfe_u32 s36, s34, 0x40000
  v_xor_b32 v6, s36, v5
  v_lshl_add_u32 v200, v6, 5, v4
  s_bfe_u32 s36, s34, 0x40004
  v_xor_b32 v6, s36, v5
  v_lshl_add_u32 v201, v6, 5, v4
  s_bfe_u32 s36, s34, 0x40008
  v_xor_b32 v6, s36, v5
  v_lshl_add_u32 v202, v6, 5, v4
  s_bfe_u32 s36, s34, 0x4000c
  v_xor_b32 v6, s36, v5
  v_lshl_add_u32 v203, v6, 5, v4
  s_mul_i32 s34, s23, 36864
  s_add_u32 s34, s34, 73728
  v_add_u32 v245, s34, v243
  v_add_u32 v246, 147456, v243
  s_waitcnt vmcnt(13)
  s_barrier
  ds_read_b128 a[0:3], v245 offset:0
  ds_read_b128 a[4:7], v245 offset:3072
  ds_read_b128 a[8:11], v245 offset:6144
  ds_read_b128 a[12:15], v245 offset:9216
  ds_read_b128 v[80:83], v246 offset:0
  ds_read_b64_tr_b16 v[144:145], v200 offset:0
  ds_read_b64_tr_b16 v[146:147], v200 offset:6144
  ds_read_b64_tr_b16 v[148:149], v201 offset:0
  ds_read_b64_tr_b16 v[150:151], v201 offset:6144
  ds_read_b64_tr_b16 v[152:153], v202 offset:0
  ds_read_b64_tr_b16 v[154:155], v202 offset:6144
  ds_read_b64_tr_b16 v[156:157], v203 offset:0
  ds_read_b64_tr_b16 v[158:159], v203 offset:6144
  ds_read_b64_tr_b16 v[160:161], v200 offset:2048
  ds_read_b64_tr_b16 v[162:163], v200 offset:8192
  ds_read_b128 a[16:19], v245 offset:1024
  ds_read_b128 a[20:23], v245 offset:4096
  ds_read_b128 a[24:27], v245 offset:7168
  ds_read_b128 a[28:31], v245 offset:10240
  ds_read_b128 v[84:87], v246 offset:1024
  ds_read_b128 a[32:35], v245 offset:2048
  ds_read_b128 a[36:39], v245 offset:5120
  ds_read_b128 a[40:43], v245 offset:8192
  ds_read_b128 a[44:47], v245 offset:11264
  ds_read_b128 v[88:91], v246 offset:2048
  s_waitcnt lgkmcnt(15)
  v_mfma_f32_16x16x32_bf16 v[16:19], v[144:147], a[0:3], 0
  ds_read_b64_tr_b16 v[164:165], v201 offset:2048
  v_mfma_f32_16x16x32_bf16 v[20:23], v[144:147], a[4:7], 0
  s_add_u32 m0, s17, 98304
  s_add_u32 s19, s26, 6144
  buffer_load_dwordx4 v243, s[48:51], s19 offen lds
  v_mfma_f32_16x16x32_bf16 v[24:27], v[144:147], a[8:11], 0
  ds_read_b64_tr_b16 v[166:167], v201 offset:8192
  s_mov_b32 s64, s6
  s_and_b32 s65, s7, 0xffff
  s_mov_b32 s66, 663552
  s_mov_b32 s67, 0x20000
  s_cmp_ge_u32 s20, 2
  s_cselect_b32 s34, s10, s8
  s_cselect_b32 s35, s11, s9
  s_mov_b32 s56, s34
  s_and_b32 s57, s35, 0xffff
  s_mov_b32 s58, 5308416
  s_mov_b32 s59, 0x20000
  s_mov_b32 s60, s12
  s_and_b32 s61, s13, 0xffff
  s_mov_b32 s62, 5308416
  s_mov_b32 s63, 0x20000
  s_add_u32 s34, s14, 6291456
  s_addc_u32 s35, s15, 0
  s_mov_b32 s68, s34
  s_and_b32 s69, s35, 0xffff
  s_mov_b32 s70, 37781504
  s_mov_b32 s71, 0x20000
  s_mul_i32 s34, s21, 288
  s_and_b32 s35, s21, 1
  s_lshl_b32 s36, s35, 5
  s_add_u32 s36, s36, s34
  s_add_u32 s37, s22, 0
  s_and_b32 s37, s37, 3
  s_lshl_b32 s37, s37, 6
  s_add_u32 s88, s36, s37
  s_add_u32 s37, s22, 1
  s_and_b32 s37, s37, 3
  s_lshl_b32 s37, s37, 6
  s_add_u32 s89, s36, s37
  s_add_u32 s37, s22, 2
  s_and_b32 s37, s37, 3
  s_lshl_b32 s37, s37, 6
  s_add_u32 s90, s36, s37
  s_add_u32 s37, s22, 3
  s_and_b32 s37, s37, 3
  s_lshl_b32 s37, s37, 6
  s_add_u32 s91, s36, s37
  s_cmp_eq_u32 s35, 1
  s_cselect_b32 s37, 0, 256
  s_add_u32 s92, s34, s37
  s_lshl_b32 s4, s88, 1
  s_mul_i32 s9, s88, 1152
  s_lshl_b32 s5, s89, 1
  s_mul_i32 s10, s89, 1152
  s_lshl_b32 s6, s90, 1
  s_mul_i32 s11, s90, 1152
  s_lshl_b32 s7, s91, 1
  s_mul_i32 s12, s91, 1152
  s_lshl_b32 s8, s92, 1
  s_mul_i32 s13, s92, 1152
  s_mul_i32 s16, s21, 41472
  s_and_b32 s34, s21, 1
  s_lshl_b32 s34, s34, 1
  s_add_u32 s35, s34, 0
  s_and_b32 s35, s35, 3
  s_lshl_b32 s28, s35, 8
  s_add_u32 s35, s34, 1
  s_and_b32 s35, s35, 3
  s_lshl_b32 s29, s35, 8
  s_add_u32 s35, s34, 2
  s_and_b32 s35, s35, 3
  s_lshl_b32 s30, s35, 8
  s_add_u32 s35, s34, 3
  s_and_b32 s35, s35, 3
  s_lshl_b32 s31, s35, 8
  s_mov_b32 s39, 0x3fb8aa3b
  s_mov_b32 s40, 0x3eae1a93
  s_mov_b32 s41, 0x05040100
  s_mov_b32 s42, 0x07060302
  s_mov_b32 s43, 0xf149f2ca
  v_lshrrev_b32 v5, 3, v1
  v_mfma_f32_16x16x32_bf16 v[28:31], v[144:147], a[12:15], 0
  v_bfe_u32 v4, v5, 1, 1
  s_and_b32 s34, s20, 1
  s_lshl_b32 s35, s34, 1
  v_or_b32 v4, s35, v4
  v_mfma_f32_16x16x32_bf16 v[248:251], v[144:147], v[80:83], 0
  v_bfe_u32 v6, v1, 1, 2
  v_xor_b32 v4, v4, v6
  v_mfma_f32_16x16x32_bf16 v[32:35], v[148:151], a[0:3], 0
  ds_read_b64_tr_b16 v[144:145], v202 offset:2048
  v_lshlrev_b32 v4, 1, v4
  v_mfma_f32_16x16x32_bf16 v[36:39], v[148:151], a[4:7], 0
  buffer_load_dwordx4 v243, s[48:51], s19 offen offset:1024 lds
  v_mfma_f32_16x16x32_bf16 v[40:43], v[148:151], a[8:11], 0
  ds_read_b64_tr_b16 v[146:147], v202 offset:8192
  v_and_b32 v6, 1, v1
  v_mfma_f32_16x16x32_bf16 v[44:47], v[148:151], a[12:15], 0
  v_or_b32 v4, v4, v6
  s_lshl_b32 s35, s34, 3
  v_add_u32 v6, s35, v5
  v_mfma_f32_16x16x32_bf16 v[252:255], v[148:151], v[80:83], 0
  buffer_load_dwordx4 v243, s[48:51], s19 offen offset:2048 lds
  s_add_u32 m0, s25, 49152
  s_add_u32 s38, s25, 49152
  s_waitcnt lgkmcnt(15)
  v_mfma_f32_16x16x32_bf16 v[48:51], v[152:155], a[0:3], 0
  ds_read_b64_tr_b16 v[148:149], v203 offset:2048
  v_mul_u32_u24 v6, 9216, v6
  v_mfma_f32_16x16x32_bf16 v[52:55], v[152:155], a[4:7], 0
  v_lshl_add_u32 v219, v4, 4, v6
  v_add_u32 v220, 146432, v219
  v_mfma_f32_16x16x32_bf16 v[56:59], v[152:155], a[8:11], 0
  ds_read_b64_tr_b16 v[150:151], v203 offset:8192
  v_add_u32 v221, 292864, v219
  s_lshl_b32 s35, s20, 3
  v_mfma_f32_16x16x32_bf16 v[60:63], v[152:155], a[12:15], 0
  buffer_load_dwordx4 v243, s[52:55], s38 offen lds
  v_mfma_f32_16x16x32_bf16 v[64:67], v[156:159], a[0:3], 0
  ds_read_b64_tr_b16 v[152:153], v200 offset:4096
  v_add_u32 v6, s35, v5
  v_mfma_f32_16x16x32_bf16 v[68:71], v[156:159], a[4:7], 0
  v_mul_u32_u24 v6, 1152, v6
  v_lshl_add_u32 v228, v4, 4, v6
  v_mfma_f32_16x16x32_bf16 v[72:75], v[156:159], a[8:11], 0
  ds_read_b64_tr_b16 v[154:155], v200 offset:10240
  v_add_u32 v229, 35840, v228
  v_mfma_f32_16x16x32_bf16 v[76:79], v[156:159], a[12:15], 0
  buffer_load_dwordx4 v243, s[52:55], s38 offen offset:1024 lds
  s_waitcnt lgkmcnt(15)
  v_mfma_f32_16x16x32_bf16 v[16:19], v[160:163], a[16:19], v[16:19]
  ds_read_b64_tr_b16 v[156:157], v201 offset:4096
  v_add_u32 v230, 71680, v228
  v_mfma_f32_16x16x32_bf16 v[20:23], v[160:163], a[20:23], v[20:23]
  v_lshrrev_b32 v5, 2, v1
  v_lshrrev_b32 v4, 3, v5
  v_mfma_f32_16x16x32_bf16 v[24:27], v[160:163], a[24:27], v[24:27]
  ds_read_b64_tr_b16 v[158:159], v201 offset:10240
  v_lshlrev_b32 v4, 1, v4
  s_waitcnt lgkmcnt(15)
  v_mfma_f32_16x16x32_bf16 v[28:31], v[160:163], a[28:31], v[28:31]
  buffer_load_dwordx4 v243, s[52:55], s38 offen offset:2048 lds
  s_add_u32 m0, s17, 101376
  s_add_u32 s19, s26, 24576
  v_mfma_f32_16x16x32_bf16 v[248:251], v[160:163], v[84:87], v[248:251]
  v_and_b32 v6, 3, v1
  v_xor_b32 v4, v4, v6
  s_lshl_b32 s35, s34, 4
  s_waitcnt lgkmcnt(8)
  v_mfma_f32_16x16x32_bf16 v[32:35], v[164:167], a[16:19], v[32:35]
  ds_read_b64_tr_b16 v[160:161], v202 offset:4096
  v_add_u32 v6, s35, v5
  v_mfma_f32_16x16x32_bf16 v[36:39], v[164:167], a[20:23], v[36:39]
  v_mul_u32_u24 v6, 9216, v6
  v_lshl_add_u32 v222, v4, 4, v6
  v_mfma_f32_16x16x32_bf16 v[40:43], v[164:167], a[24:27], v[40:43]
  ds_read_b64_tr_b16 v[162:163], v202 offset:10240
  v_add_u32 v223, 293888, v222
  v_mfma_f32_16x16x32_bf16 v[44:47], v[164:167], a[28:31], v[44:47]
  buffer_load_dwordx4 v243, s[48:51], s19 offen lds
  v_mfma_f32_16x16x32_bf16 v[252:255], v[164:167], v[84:87], v[252:255]
  v_add_u32 v224, 587776, v222
  s_lshr_b32 s34, s20, 1
  s_lshl_b32 s34, s34, 2
  v_or_b32 v4, s34, v3
  s_waitcnt lgkmcnt(8)
  v_mfma_f32_16x16x32_bf16 v[48:51], v[144:147], a[16:19], v[48:51]
  ds_read_b64_tr_b16 v[164:165], v203 offset:4096
  v_lshrrev_b32 v5, 1, v2
  v_mfma_f32_16x16x32_bf16 v[52:55], v[144:147], a[20:23], v[52:55]
  buffer_load_dwordx4 v243, s[48:51], s19 offen offset:1024 lds
  v_mfma_f32_16x16x32_bf16 v[56:59], v[144:147], a[24:27], v[56:59]
  ds_read_b64_tr_b16 v[166:167], v203 offset:10240
  v_xor_b32 v4, v4, v5
  v_mfma_f32_16x16x32_bf16 v[60:63], v[144:147], a[28:31], v[60:63]
  v_lshlrev_b32 v4, 1, v4
  v_and_b32 v5, 1, v2
  s_waitcnt lgkmcnt(8)
  v_mfma_f32_16x16x32_bf16 v[64:67], v[148:151], a[16:19], v[64:67]
  v_or_b32 v4, v4, v5
  s_lshl_b32 s35, s20, 2
  v_add_u32 v5, s35, v3
  v_mfma_f32_16x16x32_bf16 v[68:71], v[148:151], a[20:23], v[68:71]
  buffer_load_dwordx4 v243, s[48:51], s19 offen offset:2048 lds
  s_add_u32 m0, s18, 153600
  s_add_u32 s19, s27, 6144
  v_mfma_f32_16x16x32_bf16 v[72:75], v[148:151], a[24:27], v[72:75]
  v_mul_u32_u24 v6, 1152, v5
  v_lshl_add_u32 v225, v4, 4, v6
  v_mfma_f32_16x16x32_bf16 v[76:79], v[148:151], a[28:31], v[76:79]
  v_add_u32 v226, 17408, v225
  v_add_u32 v227, 34816, v225
  s_waitcnt lgkmcnt(0)
  s_waitcnt vmcnt(9)
  s_barrier
  v_mfma_f32_16x16x32_bf16 v[16:19], v[152:155], a[32:35], v[16:19]
  ds_read_b64_tr_b16 v[144:145], v200 offset:24576
  v_mul_u32_u24 v4, 6144, v242
  v_mfma_f32_16x16x32_bf16 v[20:23], v[152:155], a[36:39], v[20:23]
  ds_read_b128 a[48:51], v245 offset:12288
  v_lshl_add_u32 v4, v241, 10, v4
  v_mfma_f32_16x16x32_bf16 v[24:27], v[152:155], a[40:43], v[24:27]
  ds_read_b64_tr_b16 v[146:147], v200 offset:30720
  ds_read_b128 a[52:55], v245 offset:15360
  v_mfma_f32_16x16x32_bf16 v[28:31], v[152:155], a[44:47], v[28:31]
  ds_read_b64_tr_b16 v[148:149], v201 offset:24576
  v_lshl_add_u32 v4, v247, 7, v4
  v_mfma_f32_16x16x32_bf16 v[248:251], v[152:155], v[88:91], v[248:251]
  ds_read_b64_tr_b16 v[150:151], v201 offset:30720
  ds_read_b128 a[56:59], v245 offset:18432
  buffer_load_dwordx4 v243, s[48:51], s19 offen lds
  s_add_u32 m0, s25, 49152
  s_add_u32 s38, s25, 49152
  v_mfma_f32_16x16x32_bf16 v[32:35], v[156:159], a[32:35], v[32:35]
  ds_read_b64_tr_b16 v[152:153], v202 offset:24576
  v_add_u32 v4, v4, v244
  v_mfma_f32_16x16x32_bf16 v[36:39], v[156:159], a[36:39], v[36:39]
  ds_read_b128 a[60:63], v245 offset:21504
  v_lshrrev_b32 v5, 1, v247
  v_mfma_f32_16x16x32_bf16 v[40:43], v[156:159], a[40:43], v[40:43]
  ds_read_b64_tr_b16 v[154:155], v202 offset:30720
  v_lshl_or_b32 v5, v242, 1, v5
  s_lshl_b32 s36, s24, 1
  s_add_u32 s36, s36, 0
  v_mfma_f32_16x16x32_bf16 v[44:47], v[156:159], a[44:47], v[44:47]
  ds_read_b128 v[92:95], v246 offset:3072
  buffer_load_dwordx4 v243, s[52:55], s38 offen offset:3072 lds
  s_add_u32 m0, s25, 53248
  s_add_u32 s38, s25, 53248
  v_mfma_f32_16x16x32_bf16 v[252:255], v[156:159], v[88:91], v[252:255]
  ds_read_b128 a[64:67], v245 offset:13312
  v_xor_b32 v6, s36, v5
  v_mfma_f32_16x16x32_bf16 v[48:51], v[160:163], a[32:35], v[48:51]
  ds_read_b64_tr_b16 v[156:157], v203 offset:24576
  v_lshl_add_u32 v204, v6, 5, v4
  v_mfma_f32_16x16x32_bf16 v[52:55], v[160:163], a[36:39], v[52:55]
  ds_read_b128 a[68:71], v245 offset:16384
  v_add_u32 v206, 12288, v204
  s_lshl_b32 s36, s24, 1
  s_add_u32 s36, s36, 1
  v_mfma_f32_16x16x32_bf16 v[56:59], v[160:163], a[40:43], v[56:59]
  ds_read_b64_tr_b16 v[158:159], v203 offset:30720
  buffer_load_dwordx4 v243, s[52:55], s38 offen lds
  v_mfma_f32_16x16x32_bf16 v[60:63], v[160:163], a[44:47], v[60:63]
  ds_read_b128 a[72:75], v245 offset:19456
  v_xor_b32 v6, s36, v5
  v_mfma_f32_16x16x32_bf16 v[64:67], v[164:167], a[32:35], v[64:67]
  ds_read_b64_tr_b16 v[160:161], v200 offset:26624
  v_lshl_add_u32 v205, v6, 5, v4
  v_mfma_f32_16x16x32_bf16 v[68:71], v[164:167], a[36:39], v[68:71]
  ds_read_b128 a[76:79], v245 offset:22528
  v_add_u32 v207, 12288, v205
  v_mfma_f32_16x16x32_bf16 v[72:75], v[164:167], a[40:43], v[72:75]
  ds_read_b64_tr_b16 v[162:163], v200 offset:32768
  buffer_load_dwordx4 v243, s[52:55], s38 offen offset:1024 lds
  s_add_u32 m0, s17, 73728
  s_add_u32 s19, s26, 9216
  v_mfma_f32_16x16x32_bf16 v[76:79], v[164:167], a[44:47], v[76:79]
  ds_read_b128 v[96:99], v246 offset:4096
  buffer_load_dwordx4 v243, s[48:51], s19 offen lds
  s_waitcnt lgkmcnt(15)
  v_mfma_f32_16x16x32_bf16 v[16:19], v[144:147], a[48:51], v[16:19]
  ds_read_b64_tr_b16 v[164:165], v201 offset:26624
  v_mul_u32_u24 v4, 6144, v3
  v_mfma_f32_16x16x32_bf16 v[20:23], v[144:147], a[52:55], v[20:23]
  ds_read_b128 a[80:83], v245 offset:14336
  v_lshl_add_u32 v4, v247, 7, v4
  s_waitcnt lgkmcnt(15)
  v_mfma_f32_16x16x32_bf16 v[24:27], v[144:147], a[56:59], v[24:27]
  ds_read_b64_tr_b16 v[166:167], v201 offset:32768
  v_add_u32 v4, v4, v244
  s_lshl_b32 s36, s24, 1
  s_add_u32 s36, s36, 0
  s_waitcnt lgkmcnt(14)
  v_mfma_f32_16x16x32_bf16 v[28:31], v[144:147], a[60:63], v[28:31]
  ds_read_b128 a[84:87], v245 offset:17408
  buffer_load_dwordx4 v243, s[48:51], s19 offen offset:1024 lds
  s_waitcnt lgkmcnt(13)
  v_mfma_f32_16x16x32_bf16 v[248:251], v[144:147], v[92:95], v[248:251]
  ds_read_b128 a[88:91], v245 offset:20480
  v_xor_b32 v6, s36, v5
  v_mfma_f32_16x16x32_bf16 v[32:35], v[148:151], a[48:51], v[32:35]
  ds_read_b64_tr_b16 v[144:145], v202 offset:26624
  v_lshl_add_u32 v214, v6, 5, v4
  s_lshl_b32 s36, s24, 1
  s_add_u32 s36, s36, 1
  v_mfma_f32_16x16x32_bf16 v[36:39], v[148:151], a[52:55], v[36:39]
  ds_read_b128 a[92:95], v245 offset:23552
  v_xor_b32 v6, s36, v5
  v_lshl_add_u32 v215, v6, 5, v4
  v_mul_u32_u24 v4, 6144, v241
  v_lshl_add_u32 v6, v242, 3, v247
  v_lshl_add_u32 v4, v6, 6, v4
  v_add_u32 v4, v4, v244
  v_xor_b32 v6, s24, v242
  v_lshl_add_u32 v208, v6, 5, v4
  v_add_u32 v209, 12288, v208
  v_mul_u32_u24 v4, 12288, v242
  v_lshl_add_u32 v4, v241, 10, v4
  v_lshl_add_u32 v4, v247, 8, v4
  v_add_u32 v4, v4, v244
  v_lshl_or_b32 v5, v242, 2, v247
  s_lshl_b32 s36, s24, 2
  s_add_u32 s36, s36, 0
  v_xor_b32 v6, s36, v5
  v_lshl_add_u32 v210, v6, 5, v4
  s_lshl_b32 s36, s24, 2
  s_add_u32 s36, s36, 1
  v_xor_b32 v6, s36, v5
  v_lshl_add_u32 v211, v6, 5, v4
  s_lshl_b32 s36, s24, 2
  s_add_u32 s36, s36, 2
  v_xor_b32 v6, s36, v5
  v_lshl_add_u32 v212, v6, 5, v4
  s_lshl_b32 s36, s24, 2
  s_add_u32 s36, s36, 3
  v_xor_b32 v6, s36, v5
  v_lshl_add_u32 v213, v6, 5, v4
  s_lshl_b32 s37, s23, 6
  s_add_u32 s37, s37, 16
  v_add_u32 v6, s37, v2
  v_mul_u32_u24 v6, 272, v6
  v_lshl_add_u32 v6, v3, 3, v6
  s_bfe_u32 s36, s44, 0x40000
  s_lshl_b32 s36, s36, 5
  s_add_u32 s36, s36, 90112
  v_add_u32 v237, s36, v6
  s_bfe_u32 s36, s44, 0x40004
  s_lshl_b32 s36, s36, 5
  s_add_u32 s36, s36, 90112
  v_add_u32 v238, s36, v6
  s_bfe_u32 s36, s44, 0x40008
  s_lshl_b32 s36, s36, 5
  s_add_u32 s36, s36, 90112
  v_add_u32 v239, s36, v6
  s_bfe_u32 s36, s44, 0x4000c
  s_lshl_b32 s36, s36, 5
  s_add_u32 s36, s36, 90112
  v_add_u32 v240, s36, v6
  s_lshl_b32 s36, s23, 6
  v_add_u32 v4, s36, v2
  s_lshl_b32 s37, s24, 2
  v_add_u32 v5, s37, v241
  v_and_b32 v6, 7, v2
  v_xor_b32 v5, v5, v6
  v_lshlrev_b32 v5, 4, v5
  v_lshl_add_u32 v5, v242, 3, v5
  v_lshl_add_u32 v5, v4, 7, v5
  v_add_u32 v231, 73728, v5
  v_xor_b32 v232, 32, v231
  v_xor_b32 v5, v3, v6
  v_lshlrev_b32 v5, 4, v5
  v_lshl_add_u32 v5, v4, 7, v5
  v_add_u32 v234, 73728, v5
  v_xor_b32 v235, 64, v234
  v_mul_u32_u24 v5, 144, v4
  v_add_u32 v5, 139264, v5
  v_lshl_add_u32 v236, v3, 4, v5
  s_lshl_b32 s37, s24, 5
  v_lshl_add_u32 v6, v3, 3, v5
  v_add_u32 v233, s37, v6
  v_and_b32 v4, 31, v1
  v_lshrrev_b32 v5, 5, v1
  s_lshl_b32 s36, s20, 5
  v_add_u32 v4, s36, v4
  s_lshl_b32 s37, s22, 7
  v_add_u32 v244, s37, v4
  v_add_u32 v6, 2, v4
  v_mul_u32_u24 v6, 272, v6
  v_lshl_add_u32 v6, v5, 5, v6
  v_add_u32 v241, 90112, v6
  v_mul_u32_u24 v6, 144, v4
  v_lshl_add_u32 v6, v5, 5, v6
  v_add_u32 v242, 139328, v6
  v_mfma_f32_16x16x32_bf16 v[40:43], v[148:151], a[56:59], v[40:43]
  ds_read_b64_tr_b16 v[146:147], v202 offset:32768
  buffer_load_dwordx4 v243, s[48:51], s19 offen offset:2048 lds
  s_add_u32 m0, s25, 0
  s_add_u32 s38, s25, 73728
  v_mfma_f32_16x16x32_bf16 v[44:47], v[148:151], a[60:63], v[44:47]
  ds_read_b128 v[100:103], v246 offset:5120
  v_mfma_f32_16x16x32_bf16 v[252:255], v[148:151], v[92:95], v[252:255]
  buffer_load_dwordx4 v243, s[52:55], s38 offen lds
  v_mfma_f32_16x16x32_bf16 v[48:51], v[152:155], a[48:51], v[48:51]
  ds_read_b64_tr_b16 v[148:149], v203 offset:26624
  v_mfma_f32_16x16x32_bf16 v[52:55], v[152:155], a[52:55], v[52:55]
  v_mfma_f32_16x16x32_bf16 v[56:59], v[152:155], a[56:59], v[56:59]
  ds_read_b64_tr_b16 v[150:151], v203 offset:32768
  v_mfma_f32_16x16x32_bf16 v[60:63], v[152:155], a[60:63], v[60:63]
  buffer_load_dwordx4 v243, s[52:55], s38 offen offset:1024 lds
  s_waitcnt lgkmcnt(15)
  v_mfma_f32_16x16x32_bf16 v[64:67], v[156:159], a[48:51], v[64:67]
  ds_read_b64_tr_b16 v[152:153], v200 offset:28672
  v_mfma_f32_16x16x32_bf16 v[68:71], v[156:159], a[52:55], v[68:71]
  v_mfma_f32_16x16x32_bf16 v[72:75], v[156:159], a[56:59], v[72:75]
  ds_read_b64_tr_b16 v[154:155], v200 offset:34816
  v_mfma_f32_16x16x32_bf16 v[76:79], v[156:159], a[60:63], v[76:79]
  buffer_load_dwordx4 v243, s[52:55], s38 offen offset:2048 lds
  s_add_u32 m0, s17, 76800
  s_add_u32 s19, s26, 27648
  s_waitcnt lgkmcnt(14)
  v_mfma_f32_16x16x32_bf16 v[16:19], v[160:163], a[64:67], v[16:19]
  ds_read_b64_tr_b16 v[156:157], v201 offset:28672
  v_mfma_f32_16x16x32_bf16 v[20:23], v[160:163], a[68:71], v[20:23]
  v_mfma_f32_16x16x32_bf16 v[24:27], v[160:163], a[72:75], v[24:27]
  ds_read_b64_tr_b16 v[158:159], v201 offset:34816
  v_mfma_f32_16x16x32_bf16 v[28:31], v[160:163], a[76:79], v[28:31]
  buffer_load_dwordx4 v243, s[48:51], s19 offen lds
  s_waitcnt lgkmcnt(15)
  v_mfma_f32_16x16x32_bf16 v[248:251], v[160:163], v[96:99], v[248:251]
  s_waitcnt lgkmcnt(12)
  v_mfma_f32_16x16x32_bf16 v[32:35], v[164:167], a[64:67], v[32:35]
  ds_read_b64_tr_b16 v[160:161], v202 offset:28672
  v_mfma_f32_16x16x32_bf16 v[36:39], v[164:167], a[68:71], v[36:39]
  buffer_load_dwordx4 v243, s[48:51], s19 offen offset:1024 lds
  v_mfma_f32_16x16x32_bf16 v[40:43], v[164:167], a[72:75], v[40:43]
  ds_read_b64_tr_b16 v[162:163], v202 offset:34816
  v_mfma_f32_16x16x32_bf16 v[44:47], v[164:167], a[76:79], v[44:47]
  v_mfma_f32_16x16x32_bf16 v[252:255], v[164:167], v[96:99], v[252:255]
  s_waitcnt lgkmcnt(9)
  v_mfma_f32_16x16x32_bf16 v[48:51], v[144:147], a[64:67], v[48:51]
  ds_read_b64_tr_b16 v[164:165], v203 offset:28672
  v_mfma_f32_16x16x32_bf16 v[52:55], v[144:147], a[68:71], v[52:55]
  buffer_load_dwordx4 v243, s[48:51], s19 offen offset:2048 lds
  s_add_u32 m0, s18, 147456
  s_add_u32 s19, s27, 9216
  v_mfma_f32_16x16x32_bf16 v[56:59], v[144:147], a[72:75], v[56:59]
  ds_read_b64_tr_b16 v[166:167], v203 offset:34816
  v_mfma_f32_16x16x32_bf16 v[60:63], v[144:147], a[76:79], v[60:63]
  s_waitcnt lgkmcnt(8)
  v_mfma_f32_16x16x32_bf16 v[64:67], v[148:151], a[64:67], v[64:67]
  buffer_load_dwordx4 v243, s[48:51], s19 offen lds
  s_add_u32 m0, s25, 0
  s_add_u32 s38, s25, 73728
  v_mfma_f32_16x16x32_bf16 v[68:71], v[148:151], a[68:71], v[68:71]
  v_mfma_f32_16x16x32_bf16 v[72:75], v[148:151], a[72:75], v[72:75]
  v_mfma_f32_16x16x32_bf16 v[76:79], v[148:151], a[76:79], v[76:79]
  s_waitcnt lgkmcnt(0)
  s_waitcnt vmcnt(10)
  s_barrier
  v_mfma_f32_16x16x32_bf16 v[16:19], v[152:155], a[80:83], v[16:19]
  ds_read_b64_tr_b16 v[144:145], v200 offset:49152
  v_mfma_f32_16x16x32_bf16 v[20:23], v[152:155], a[84:87], v[20:23]
  ds_read_b128 a[96:99], v245 offset:24576
  v_mfma_f32_16x16x32_bf16 v[24:27], v[152:155], a[88:91], v[24:27]
  ds_read_b64_tr_b16 v[146:147], v200 offset:55296
  ds_read_b128 a[100:103], v245 offset:27648
  v_mfma_f32_16x16x32_bf16 v[28:31], v[152:155], a[92:95], v[28:31]
  ds_read_b64_tr_b16 v[148:149], v201 offset:49152
  buffer_load_dwordx4 v243, s[52:55], s38 offen offset:3072 lds
  s_add_u32 m0, s25, 4096
  s_add_u32 s38, s25, 77824
  v_mfma_f32_16x16x32_bf16 v[248:251], v[152:155], v[100:103], v[248:251]
  ds_read_b64_tr_b16 v[150:151], v201 offset:55296
  ds_read_b128 a[104:107], v245 offset:30720
  v_mfma_f32_16x16x32_bf16 v[32:35], v[156:159], a[80:83], v[32:35]
  ds_read_b64_tr_b16 v[152:153], v202 offset:49152
  v_mfma_f32_16x16x32_bf16 v[36:39], v[156:159], a[84:87], v[36:39]
  ds_read_b128 a[108:111], v245 offset:33792
  v_mfma_f32_16x16x32_bf16 v[40:43], v[156:159], a[88:91], v[40:43]
  ds_read_b64_tr_b16 v[154:155], v202 offset:55296
  buffer_load_dwordx4 v243, s[52:55], s38 offen lds
  v_mfma_f32_16x16x32_bf16 v[44:47], v[156:159], a[92:95], v[44:47]
  ds_read_b128 v[104:107], v246 offset:6144
  v_mfma_f32_16x16x32_bf16 v[252:255], v[156:159], v[100:103], v[252:255]
  ds_read_b128 a[112:115], v245 offset:25600
  v_mfma_f32_16x16x32_bf16 v[48:51], v[160:163], a[80:83], v[48:51]
  ds_read_b64_tr_b16 v[156:157], v203 offset:49152
  v_mfma_f32_16x16x32_bf16 v[52:55], v[160:163], a[84:87], v[52:55]
  ds_read_b128 a[116:119], v245 offset:28672
  buffer_load_dwordx4 v243, s[52:55], s38 offen offset:1024 lds
  s_add_u32 m0, s17, 86016
  s_add_u32 s19, s26, 12288
  v_mfma_f32_16x16x32_bf16 v[56:59], v[160:163], a[88:91], v[56:59]
  ds_read_b64_tr_b16 v[158:159], v203 offset:55296
  buffer_load_dwordx4 v243, s[48:51], s19 offen lds
  v_mfma_f32_16x16x32_bf16 v[60:63], v[160:163], a[92:95], v[60:63]
  ds_read_b128 a[120:123], v245 offset:31744
  v_mfma_f32_16x16x32_bf16 v[64:67], v[164:167], a[80:83], v[64:67]
  ds_read_b64_tr_b16 v[160:161], v200 offset:51200
  v_mfma_f32_16x16x32_bf16 v[68:71], v[164:167], a[84:87], v[68:71]
  ds_read_b128 a[124:127], v245 offset:34816
  v_mfma_f32_16x16x32_bf16 v[72:75], v[164:167], a[88:91], v[72:75]
  ds_read_b64_tr_b16 v[162:163], v200 offset:57344
  buffer_load_dwordx4 v243, s[48:51], s19 offen offset:1024 lds
  v_mfma_f32_16x16x32_bf16 v[76:79], v[164:167], a[92:95], v[76:79]
  ds_read_b128 v[108:111], v246 offset:7168
  s_waitcnt lgkmcnt(15)
  v_mfma_f32_16x16x32_bf16 v[16:19], v[144:147], a[96:99], v[16:19]
  ds_read_b64_tr_b16 v[164:165], v201 offset:51200
  v_mfma_f32_16x16x32_bf16 v[20:23], v[144:147], a[100:103], v[20:23]
  ds_read_b128 a[128:131], v245 offset:26624
  s_waitcnt lgkmcnt(15)
  v_mfma_f32_16x16x32_bf16 v[24:27], v[144:147], a[104:107], v[24:27]
  ds_read_b64_tr_b16 v[166:167], v201 offset:57344
  buffer_load_dwordx4 v243, s[48:51], s19 offen offset:2048 lds
  s_add_u32 m0, s25, 24576
  s_add_u32 s38, s25, 98304
  s_waitcnt lgkmcnt(14)
  v_mfma_f32_16x16x32_bf16 v[28:31], v[144:147], a[108:111], v[28:31]
  ds_read_b128 a[132:135], v245 offset:29696
  s_waitcnt lgkmcnt(13)
  v_mfma_f32_16x16x32_bf16 v[248:251], v[144:147], v[104:107], v[248:251]
  ds_read_b128 a[136:139], v245 offset:32768
  v_mfma_f32_16x16x32_bf16 v[32:35], v[148:151], a[96:99], v[32:35]
  ds_read_b64_tr_b16 v[144:145], v202 offset:51200
  v_mfma_f32_16x16x32_bf16 v[36:39], v[148:151], a[100:103], v[36:39]
  ds_read_b128 a[140:143], v245 offset:35840
  buffer_load_dwordx4 v243, s[52:55], s38 offen lds
  v_mfma_f32_16x16x32_bf16 v[40:43], v[148:151], a[104:107], v[40:43]
  ds_read_b64_tr_b16 v[146:147], v202 offset:57344
  v_mfma_f32_16x16x32_bf16 v[44:47], v[148:151], a[108:111], v[44:47]
  ds_read_b128 v[112:115], v246 offset:8192
  v_mfma_f32_16x16x32_bf16 v[252:255], v[148:151], v[104:107], v[252:255]
  buffer_load_dwordx4 v243, s[52:55], s38 offen offset:1024 lds
  v_mfma_f32_16x16x32_bf16 v[48:51], v[152:155], a[96:99], v[48:51]
  ds_read_b64_tr_b16 v[148:149], v203 offset:51200
  v_mfma_f32_16x16x32_bf16 v[52:55], v[152:155], a[100:103], v[52:55]
  buffer_load_dwordx4 v243, s[52:55], s38 offen offset:2048 lds
  s_add_u32 m0, s17, 89088
  s_add_u32 s19, s26, 30720
  v_mfma_f32_16x16x32_bf16 v[56:59], v[152:155], a[104:107], v[56:59]
  ds_read_b64_tr_b16 v[150:151], v203 offset:57344
  v_mfma_f32_16x16x32_bf16 v[60:63], v[152:155], a[108:111], v[60:63]
  s_waitcnt lgkmcnt(15)
  v_mfma_f32_16x16x32_bf16 v[64:67], v[156:159], a[96:99], v[64:67]
  ds_read_b64_tr_b16 v[152:153], v200 offset:53248
  v_mfma_f32_16x16x32_bf16 v[68:71], v[156:159], a[100:103], v[68:71]
  buffer_load_dwordx4 v243, s[48:51], s19 offen lds
  v_mfma_f32_16x16x32_bf16 v[72:75], v[156:159], a[104:107], v[72:75]
  ds_read_b64_tr_b16 v[154:155], v200 offset:59392
  v_mfma_f32_16x16x32_bf16 v[76:79], v[156:159], a[108:111], v[76:79]
  s_waitcnt lgkmcnt(14)
  v_mfma_f32_16x16x32_bf16 v[16:19], v[160:163], a[112:115], v[16:19]
  ds_read_b64_tr_b16 v[156:157], v201 offset:53248
  v_mfma_f32_16x16x32_bf16 v[20:23], v[160:163], a[116:119], v[20:23]
  buffer_load_dwordx4 v243, s[48:51], s19 offen offset:1024 lds
  v_mfma_f32_16x16x32_bf16 v[24:27], v[160:163], a[120:123], v[24:27]
  ds_read_b64_tr_b16 v[158:159], v201 offset:59392
  v_mfma_f32_16x16x32_bf16 v[28:31], v[160:163], a[124:127], v[28:31]
  s_waitcnt lgkmcnt(15)
  v_mfma_f32_16x16x32_bf16 v[248:251], v[160:163], v[108:111], v[248:251]
  s_waitcnt lgkmcnt(12)
  v_mfma_f32_16x16x32_bf16 v[32:35], v[164:167], a[112:115], v[32:35]
  ds_read_b64_tr_b16 v[160:161], v202 offset:53248
  v_mfma_f32_16x16x32_bf16 v[36:39], v[164:167], a[116:119], v[36:39]
  buffer_load_dwordx4 v243, s[48:51], s19 offen offset:2048 lds
  s_add_u32 m0, s18, 150528
  s_add_u32 s19, s27, 12288
  v_mfma_f32_16x16x32_bf16 v[40:43], v[164:167], a[120:123], v[40:43]
  ds_read_b64_tr_b16 v[162:163], v202 offset:59392
  v_mfma_f32_16x16x32_bf16 v[44:47], v[164:167], a[124:127], v[44:47]
  v_mfma_f32_16x16x32_bf16 v[252:255], v[164:167], v[108:111], v[252:255]
  buffer_load_dwordx4 v243, s[48:51], s19 offen lds
  s_add_u32 m0, s25, 24576
  s_add_u32 s38, s25, 98304
  s_waitcnt lgkmcnt(9)
  v_mfma_f32_16x16x32_bf16 v[48:51], v[144:147], a[112:115], v[48:51]
  ds_read_b64_tr_b16 v[164:165], v203 offset:53248
  v_mfma_f32_16x16x32_bf16 v[52:55], v[144:147], a[116:119], v[52:55]
  v_mfma_f32_16x16x32_bf16 v[56:59], v[144:147], a[120:123], v[56:59]
  ds_read_b64_tr_b16 v[166:167], v203 offset:59392
  v_mfma_f32_16x16x32_bf16 v[60:63], v[144:147], a[124:127], v[60:63]
  buffer_load_dwordx4 v243, s[52:55], s38 offen offset:3072 lds
  s_add_u32 m0, s25, 28672
  s_add_u32 s38, s25, 102400
  s_waitcnt lgkmcnt(8)
  v_mfma_f32_16x16x32_bf16 v[64:67], v[148:151], a[112:115], v[64:67]
  v_mfma_f32_16x16x32_bf16 v[68:71], v[148:151], a[116:119], v[68:71]
  v_mfma_f32_16x16x32_bf16 v[72:75], v[148:151], a[120:123], v[72:75]
  v_mfma_f32_16x16x32_bf16 v[76:79], v[148:151], a[124:127], v[76:79]
  buffer_load_dwordx4 v243, s[52:55], s38 offen lds
  s_waitcnt lgkmcnt(0)
  s_waitcnt vmcnt(12)
  s_barrier
  v_mfma_f32_16x16x32_bf16 v[16:19], v[152:155], a[128:131], v[16:19]
  ds_read_b64_tr_b16 v[144:145], v200 offset:0
  v_mfma_f32_16x16x32_bf16 v[20:23], v[152:155], a[132:135], v[20:23]
  ds_read_b128 a[144:147], v245 offset:0
  v_mfma_f32_16x16x32_bf16 v[24:27], v[152:155], a[136:139], v[24:27]
  ds_read_b64_tr_b16 v[146:147], v200 offset:6144
  ds_read_b128 a[148:151], v245 offset:3072
  v_mfma_f32_16x16x32_bf16 v[28:31], v[152:155], a[140:143], v[28:31]
  ds_read_b64_tr_b16 v[148:149], v201 offset:0
  v_mfma_f32_16x16x32_bf16 v[248:251], v[152:155], v[112:115], v[248:251]
  ds_read_b64_tr_b16 v[150:151], v201 offset:6144
  ds_read_b128 a[152:155], v245 offset:6144
  v_mfma_f32_16x16x32_bf16 v[32:35], v[156:159], a[128:131], v[32:35]
  ds_read_b64_tr_b16 v[152:153], v202 offset:0
  v_mfma_f32_16x16x32_bf16 v[36:39], v[156:159], a[132:135], v[36:39]
  ds_read_b128 a[156:159], v245 offset:9216
  buffer_load_dwordx4 v243, s[52:55], s38 offen offset:1024 lds
  s_add_u32 m0, s17, 98304
  s_add_u32 s19, s26, 15360
  v_mfma_f32_16x16x32_bf16 v[40:43], v[156:159], a[136:139], v[40:43]
  ds_read_b64_tr_b16 v[154:155], v202 offset:6144
  buffer_load_dwordx4 v243, s[48:51], s19 offen lds
  v_mfma_f32_16x16x32_bf16 v[44:47], v[156:159], a[140:143], v[44:47]
  ds_read_b128 v[116:119], v246 offset:0
  v_mfma_f32_16x16x32_bf16 v[252:255], v[156:159], v[112:115], v[252:255]
  ds_read_b128 a[160:163], v245 offset:1024
  v_mfma_f32_16x16x32_bf16 v[48:51], v[160:163], a[128:131], v[48:51]
  ds_read_b64_tr_b16 v[156:157], v203 offset:0
  v_mfma_f32_16x16x32_bf16 v[52:55], v[160:163], a[132:135], v[52:55]
  ds_read_b128 a[164:167], v245 offset:4096
  buffer_load_dwordx4 v243, s[48:51], s19 offen offset:1024 lds
  v_mfma_f32_16x16x32_bf16 v[56:59], v[160:163], a[136:139], v[56:59]
  ds_read_b64_tr_b16 v[158:159], v203 offset:6144
  v_mfma_f32_16x16x32_bf16 v[60:63], v[160:163], a[140:143], v[60:63]
  ds_read_b128 a[168:171], v245 offset:7168
  v_mfma_f32_16x16x32_bf16 v[64:67], v[164:167], a[128:131], v[64:67]
  ds_read_b64_tr_b16 v[160:161], v200 offset:2048
  v_mfma_f32_16x16x32_bf16 v[68:71], v[164:167], a[132:135], v[68:71]
  ds_read_b128 a[172:175], v245 offset:10240
  buffer_load_dwordx4 v243, s[48:51], s19 offen offset:2048 lds
  s_add_u32 m0, s25, 49152
  s_add_u32 s38, s25, 122880
  v_mfma_f32_16x16x32_bf16 v[72:75], v[164:167], a[136:139], v[72:75]
  ds_read_b64_tr_b16 v[162:163], v200 offset:8192
  v_mfma_f32_16x16x32_bf16 v[76:79], v[164:167], a[140:143], v[76:79]
  ds_read_b128 v[120:123], v246 offset:1024
  s_waitcnt lgkmcnt(15)
  v_mfma_f32_16x16x32_bf16 v[16:19], v[144:147], a[144:147], v[16:19]
  ds_read_b64_tr_b16 v[164:165], v201 offset:2048
  v_mfma_f32_16x16x32_bf16 v[20:23], v[144:147], a[148:151], v[20:23]
  ds_read_b128 a[176:179], v245 offset:2048
  buffer_load_dwordx4 v243, s[52:55], s38 offen lds
  s_waitcnt lgkmcnt(15)
  v_mfma_f32_16x16x32_bf16 v[24:27], v[144:147], a[152:155], v[24:27]
  ds_read_b64_tr_b16 v[166:167], v201 offset:8192
  s_waitcnt lgkmcnt(14)
  v_mfma_f32_16x16x32_bf16 v[28:31], v[144:147], a[156:159], v[28:31]
  ds_read_b128 a[180:183], v245 offset:5120
  s_waitcnt lgkmcnt(13)
  v_mfma_f32_16x16x32_bf16 v[248:251], v[144:147], v[116:119], v[248:251]
  ds_read_b128 a[184:187], v245 offset:8192
  v_mfma_f32_16x16x32_bf16 v[32:35], v[148:151], a[144:147], v[32:35]
  ds_read_b64_tr_b16 v[144:145], v202 offset:2048
  buffer_load_dwordx4 v243, s[52:55], s38 offen offset:1024 lds
  v_mfma_f32_16x16x32_bf16 v[36:39], v[148:151], a[148:151], v[36:39]
  ds_read_b128 a[188:191], v245 offset:11264
  v_mfma_f32_16x16x32_bf16 v[40:43], v[148:151], a[152:155], v[40:43]
  ds_read_b64_tr_b16 v[146:147], v202 offset:8192
  v_mfma_f32_16x16x32_bf16 v[44:47], v[148:151], a[156:159], v[44:47]
  ds_read_b128 v[124:127], v246 offset:2048
  v_mfma_f32_16x16x32_bf16 v[252:255], v[148:151], v[116:119], v[252:255]
  buffer_load_dwordx4 v243, s[52:55], s38 offen offset:2048 lds
  s_add_u32 m0, s17, 101376
  s_add_u32 s19, s26, 33792
  v_mfma_f32_16x16x32_bf16 v[48:51], v[152:155], a[144:147], v[48:51]
  ds_read_b64_tr_b16 v[148:149], v203 offset:2048
  v_mfma_f32_16x16x32_bf16 v[52:55], v[152:155], a[148:151], v[52:55]
  buffer_load_dwordx4 v243, s[48:51], s19 offen lds
  v_mfma_f32_16x16x32_bf16 v[56:59], v[152:155], a[152:155], v[56:59]
  ds_read_b64_tr_b16 v[150:151], v203 offset:8192
  v_mfma_f32_16x16x32_bf16 v[60:63], v[152:155], a[156:159], v[60:63]
  s_waitcnt lgkmcnt(15)
  v_mfma_f32_16x16x32_bf16 v[64:67], v[156:159], a[144:147], v[64:67]
  ds_read_b64_tr_b16 v[152:153], v200 offset:4096
  v_mfma_f32_16x16x32_bf16 v[68:71], v[156:159], a[148:151], v[68:71]
  buffer_load_dwordx4 v243, s[48:51], s19 offen offset:1024 lds
  v_mfma_f32_16x16x32_bf16 v[72:75], v[156:159], a[152:155], v[72:75]
  ds_read_b64_tr_b16 v[154:155], v200 offset:10240
  v_mfma_f32_16x16x32_bf16 v[76:79], v[156:159], a[156:159], v[76:79]
  s_waitcnt lgkmcnt(14)
  v_mfma_f32_16x16x32_bf16 v[16:19], v[160:163], a[160:163], v[16:19]
  ds_read_b64_tr_b16 v[156:157], v201 offset:4096
  v_mfma_f32_16x16x32_bf16 v[20:23], v[160:163], a[164:167], v[20:23]
  buffer_load_dwordx4 v243, s[48:51], s19 offen offset:2048 lds
  s_add_u32 m0, s18, 153600
  s_add_u32 s19, s27, 15360
  v_mfma_f32_16x16x32_bf16 v[24:27], v[160:163], a[168:171], v[24:27]
  ds_read_b64_tr_b16 v[158:159], v201 offset:10240
  v_mfma_f32_16x16x32_bf16 v[28:31], v[160:163], a[172:175], v[28:31]
  s_waitcnt lgkmcnt(15)
  v_mfma_f32_16x16x32_bf16 v[248:251], v[160:163], v[120:123], v[248:251]
  buffer_load_dwordx4 v243, s[48:51], s19 offen lds
  s_add_u32 m0, s25, 49152
  s_add_u32 s38, s25, 122880
  s_waitcnt lgkmcnt(12)
  v_mfma_f32_16x16x32_bf16 v[32:35], v[164:167], a[160:163], v[32:35]
  ds_read_b64_tr_b16 v[160:161], v202 offset:4096
  v_mfma_f32_16x16x32_bf16 v[36:39], v[164:167], a[164:167], v[36:39]
  v_mfma_f32_16x16x32_bf16 v[40:43], v[164:167], a[168:171], v[40:43]
  ds_read_b64_tr_b16 v[162:163], v202 offset:10240
  v_mfma_f32_16x16x32_bf16 v[44:47], v[164:167], a[172:175], v[44:47]
  buffer_load_dwordx4 v243, s[52:55], s38 offen offset:3072 lds
  s_add_u32 m0, s25, 53248
  s_add_u32 s38, s25, 126976
  v_mfma_f32_16x16x32_bf16 v[252:255], v[164:167], v[120:123], v[252:255]
  s_waitcnt lgkmcnt(9)
  v_mfma_f32_16x16x32_bf16 v[48:51], v[144:147], a[160:163], v[48:51]
  ds_read_b64_tr_b16 v[164:165], v203 offset:4096
  v_mfma_f32_16x16x32_bf16 v[52:55], v[144:147], a[164:167], v[52:55]
  v_mfma_f32_16x16x32_bf16 v[56:59], v[144:147], a[168:171], v[56:59]
  ds_read_b64_tr_b16 v[166:167], v203 offset:10240
  v_mfma_f32_16x16x32_bf16 v[60:63], v[144:147], a[172:175], v[60:63]
  buffer_load_dwordx4 v243, s[52:55], s38 offen lds
  s_waitcnt lgkmcnt(8)
  v_mfma_f32_16x16x32_bf16 v[64:67], v[148:151], a[160:163], v[64:67]
  v_mfma_f32_16x16x32_bf16 v[68:71], v[148:151], a[164:167], v[68:71]
  v_mfma_f32_16x16x32_bf16 v[72:75], v[148:151], a[168:171], v[72:75]
  buffer_load_dwordx4 v243, s[52:55], s38 offen offset:1024 lds
  s_add_u32 m0, s25, 0
  s_add_u32 s38, s4, 0
  v_mfma_f32_16x16x32_bf16 v[76:79], v[148:151], a[172:175], v[76:79]
  s_waitcnt lgkmcnt(0)
  s_waitcnt vmcnt(13)
  s_barrier
  v_mfma_f32_16x16x32_bf16 v[16:19], v[152:155], a[176:179], v[16:19]
  ds_read_b64_tr_b16 v[144:145], v200 offset:24576
  v_mfma_f32_16x16x32_bf16 v[20:23], v[152:155], a[180:183], v[20:23]
  ds_read_b128 a[192:195], v245 offset:12288
  v_mfma_f32_16x16x32_bf16 v[24:27], v[152:155], a[184:187], v[24:27]
  ds_read_b64_tr_b16 v[146:147], v200 offset:30720
  ds_read_b128 a[196:199], v245 offset:15360
  v_mfma_f32_16x16x32_bf16 v[28:31], v[152:155], a[188:191], v[28:31]
  ds_read_b64_tr_b16 v[148:149], v201 offset:24576
  v_mfma_f32_16x16x32_bf16 v[248:251], v[152:155], v[124:127], v[248:251]
  ds_read_b64_tr_b16 v[150:151], v201 offset:30720
  ds_read_b128 a[200:203], v245 offset:18432
  buffer_load_dwordx4 v219, s[56:59], s38 offen lds
  v_mfma_f32_16x16x32_bf16 v[32:35], v[156:159], a[176:179], v[32:35]
  ds_read_b64_tr_b16 v[152:153], v202 offset:24576
  v_mfma_f32_16x16x32_bf16 v[36:39], v[156:159], a[180:183], v[36:39]
  ds_read_b128 a[204:207], v245 offset:21504
  v_mfma_f32_16x16x32_bf16 v[40:43], v[156:159], a[184:187], v[40:43]
  ds_read_b64_tr_b16 v[154:155], v202 offset:30720
  v_mfma_f32_16x16x32_bf16 v[44:47], v[156:159], a[188:191], v[44:47]
  ds_read_b128 v[128:131], v246 offset:3072
  v_mfma_f32_16x16x32_bf16 v[252:255], v[156:159], v[124:127], v[252:255]
  ds_read_b128 a[208:211], v245 offset:13312
  v_mfma_f32_16x16x32_bf16 v[48:51], v[160:163], a[176:179], v[48:51]
  ds_read_b64_tr_b16 v[156:157], v203 offset:24576
  v_mfma_f32_16x16x32_bf16 v[52:55], v[160:163], a[180:183], v[52:55]
  ds_read_b128 a[212:215], v245 offset:16384
  v_mfma_f32_16x16x32_bf16 v[56:59], v[160:163], a[184:187], v[56:59]
  ds_read_b64_tr_b16 v[158:159], v203 offset:30720
  buffer_load_dwordx4 v220, s[56:59], s38 offen offset:1024 lds
  v_mfma_f32_16x16x32_bf16 v[60:63], v[160:163], a[188:191], v[60:63]
  ds_read_b128 a[216:219], v245 offset:19456
  v_mfma_f32_16x16x32_bf16 v[64:67], v[164:167], a[176:179], v[64:67]
  ds_read_b64_tr_b16 v[160:161], v200 offset:26624
  v_mfma_f32_16x16x32_bf16 v[68:71], v[164:167], a[180:183], v[68:71]
  ds_read_b128 a[220:223], v245 offset:22528
  v_mfma_f32_16x16x32_bf16 v[72:75], v[164:167], a[184:187], v[72:75]
  ds_read_b64_tr_b16 v[162:163], v200 offset:32768
  v_mfma_f32_16x16x32_bf16 v[76:79], v[164:167], a[188:191], v[76:79]
  ds_read_b128 v[132:135], v246 offset:4096
  s_waitcnt lgkmcnt(15)
  v_mfma_f32_16x16x32_bf16 v[16:19], v[144:147], a[192:195], v[16:19]
  ds_read_b64_tr_b16 v[164:165], v201 offset:26624
  v_mfma_f32_16x16x32_bf16 v[20:23], v[144:147], a[196:199], v[20:23]
  ds_read_b128 a[224:227], v245 offset:14336
  s_waitcnt lgkmcnt(15)
  v_mfma_f32_16x16x32_bf16 v[24:27], v[144:147], a[200:203], v[24:27]
  ds_read_b64_tr_b16 v[166:167], v201 offset:32768
  buffer_load_dwordx4 v221, s[56:59], s38 offen offset:2048 lds
  s_add_u32 m0, s25, 3072
  s_add_u32 s38, s4, 442368
  s_waitcnt lgkmcnt(14)
  v_mfma_f32_16x16x32_bf16 v[28:31], v[144:147], a[204:207], v[28:31]
  ds_read_b128 a[228:231], v245 offset:17408
  s_waitcnt lgkmcnt(13)
  v_mfma_f32_16x16x32_bf16 v[248:251], v[144:147], v[128:131], v[248:251]
  ds_read_b128 a[232:235], v245 offset:20480
  v_mfma_f32_16x16x32_bf16 v[32:35], v[148:151], a[192:195], v[32:35]
  ds_read_b64_tr_b16 v[144:145], v202 offset:26624
  v_mfma_f32_16x16x32_bf16 v[36:39], v[148:151], a[196:199], v[36:39]
  ds_read_b128 a[236:239], v245 offset:23552
  v_mfma_f32_16x16x32_bf16 v[40:43], v[148:151], a[200:203], v[40:43]
  ds_read_b64_tr_b16 v[146:147], v202 offset:32768
  v_mfma_f32_16x16x32_bf16 v[44:47], v[148:151], a[204:207], v[44:47]
  ds_read_b128 v[136:139], v246 offset:5120
  v_mfma_f32_16x16x32_bf16 v[252:255], v[148:151], v[128:131], v[252:255]
  buffer_load_dwordx4 v219, s[56:59], s38 offen lds
  v_mfma_f32_16x16x32_bf16 v[48:51], v[152:155], a[192:195], v[48:51]
  ds_read_b64_tr_b16 v[148:149], v203 offset:26624
  v_mfma_f32_16x16x32_bf16 v[52:55], v[152:155], a[196:199], v[52:55]
  v_mfma_f32_16x16x32_bf16 v[56:59], v[152:155], a[200:203], v[56:59]
  ds_read_b64_tr_b16 v[150:151], v203 offset:32768
  v_mfma_f32_16x16x32_bf16 v[60:63], v[152:155], a[204:207], v[60:63]
  s_waitcnt lgkmcnt(15)
  v_mfma_f32_16x16x32_bf16 v[64:67], v[156:159], a[192:195], v[64:67]
  ds_read_b64_tr_b16 v[152:153], v200 offset:28672
  v_mfma_f32_16x16x32_bf16 v[68:71], v[156:159], a[196:199], v[68:71]
  buffer_load_dwordx4 v220, s[56:59], s38 offen offset:1024 lds
  v_mfma_f32_16x16x32_bf16 v[72:75], v[156:159], a[200:203], v[72:75]
  ds_read_b64_tr_b16 v[154:155], v200 offset:34816
  v_mfma_f32_16x16x32_bf16 v[76:79], v[156:159], a[204:207], v[76:79]
  s_waitcnt lgkmcnt(14)
  v_mfma_f32_16x16x32_bf16 v[16:19], v[160:163], a[208:211], v[16:19]
  ds_read_b64_tr_b16 v[156:157], v201 offset:28672
  v_mfma_f32_16x16x32_bf16 v[20:23], v[160:163], a[212:215], v[20:23]
  v_mfma_f32_16x16x32_bf16 v[24:27], v[160:163], a[216:219], v[24:27]
  ds_read_b64_tr_b16 v[158:159], v201 offset:34816
  v_mfma_f32_16x16x32_bf16 v[28:31], v[160:163], a[220:223], v[28:31]
  s_waitcnt lgkmcnt(15)
  v_mfma_f32_16x16x32_bf16 v[248:251], v[160:163], v[132:135], v[248:251]
  s_waitcnt lgkmcnt(12)
  v_mfma_f32_16x16x32_bf16 v[32:35], v[164:167], a[208:211], v[32:35]
  ds_read_b64_tr_b16 v[160:161], v202 offset:28672
  v_mfma_f32_16x16x32_bf16 v[36:39], v[164:167], a[212:215], v[36:39]
  buffer_load_dwordx4 v221, s[56:59], s38 offen offset:2048 lds
  s_add_u32 m0, s25, 24576
  s_add_u32 s38, s4, 884736
  v_mfma_f32_16x16x32_bf16 v[40:43], v[164:167], a[216:219], v[40:43]
  ds_read_b64_tr_b16 v[162:163], v202 offset:34816
  v_mfma_f32_16x16x32_bf16 v[44:47], v[164:167], a[220:223], v[44:47]
  v_mfma_f32_16x16x32_bf16 v[252:255], v[164:167], v[132:135], v[252:255]
  s_waitcnt lgkmcnt(9)
  v_mfma_f32_16x16x32_bf16 v[48:51], v[144:147], a[208:211], v[48:51]
  ds_read_b64_tr_b16 v[164:165], v203 offset:28672
  v_mfma_f32_16x16x32_bf16 v[52:55], v[144:147], a[212:215], v[52:55]
  v_mfma_f32_16x16x32_bf16 v[56:59], v[144:147], a[216:219], v[56:59]
  ds_read_b64_tr_b16 v[166:167], v203 offset:34816
  v_mfma_f32_16x16x32_bf16 v[60:63], v[144:147], a[220:223], v[60:63]
  s_waitcnt lgkmcnt(8)
  v_mfma_f32_16x16x32_bf16 v[64:67], v[148:151], a[208:211], v[64:67]
  v_mfma_f32_16x16x32_bf16 v[68:71], v[148:151], a[212:215], v[68:71]
  v_mfma_f32_16x16x32_bf16 v[72:75], v[148:151], a[216:219], v[72:75]
  v_mfma_f32_16x16x32_bf16 v[76:79], v[148:151], a[220:223], v[76:79]
  s_waitcnt lgkmcnt(0)
  s_waitcnt vmcnt(6)
  s_barrier
  v_mfma_f32_16x16x32_bf16 v[16:19], v[152:155], a[224:227], v[16:19]
  ds_read_b64_tr_b16 v[144:145], v200 offset:49152
  v_mfma_f32_16x16x32_bf16 v[20:23], v[152:155], a[228:231], v[20:23]
  ds_read_b128 a[240:243], v245 offset:24576
  v_mfma_f32_16x16x32_bf16 v[24:27], v[152:155], a[232:235], v[24:27]
  ds_read_b64_tr_b16 v[146:147], v200 offset:55296
  ds_read_b128 a[244:247], v245 offset:27648
  v_mfma_f32_16x16x32_bf16 v[28:31], v[152:155], a[236:239], v[28:31]
  ds_read_b64_tr_b16 v[148:149], v201 offset:49152
  v_mfma_f32_16x16x32_bf16 v[248:251], v[152:155], v[136:139], v[248:251]
  ds_read_b64_tr_b16 v[150:151], v201 offset:55296
  ds_read_b128 a[248:251], v245 offset:30720
  buffer_load_dwordx4 v219, s[56:59], s38 offen lds
  v_mfma_f32_16x16x32_bf16 v[32:35], v[156:159], a[224:227], v[32:35]
  ds_read_b64_tr_b16 v[152:153], v202 offset:49152
  v_mfma_f32_16x16x32_bf16 v[36:39], v[156:159], a[228:231], v[36:39]
  ds_read_b128 a[252:255], v245 offset:33792
  v_mfma_f32_16x16x32_bf16 v[40:43], v[156:159], a[232:235], v[40:43]
  ds_read_b64_tr_b16 v[154:155], v202 offset:55296
  v_mfma_f32_16x16x32_bf16 v[44:47], v[156:159], a[236:239], v[44:47]
  ds_read_b128 v[140:143], v246 offset:6144
  v_mfma_f32_16x16x32_bf16 v[252:255], v[156:159], v[136:139], v[252:255]
  ds_read_b128 v[168:171], v245 offset:25600
  v_mfma_f32_16x16x32_bf16 v[48:51], v[160:163], a[224:227], v[48:51]
  ds_read_b64_tr_b16 v[156:157], v203 offset:49152
  v_mfma_f32_16x16x32_bf16 v[52:55], v[160:163], a[228:231], v[52:55]
  ds_read_b128 v[172:175], v245 offset:28672
  v_mfma_f32_16x16x32_bf16 v[56:59], v[160:163], a[232:235], v[56:59]
  ds_read_b64_tr_b16 v[158:159], v203 offset:55296
  buffer_load_dwordx4 v220, s[56:59], s38 offen offset:1024 lds
  v_mfma_f32_16x16x32_bf16 v[60:63], v[160:163], a[236:239], v[60:63]
  ds_read_b128 v[176:179], v245 offset:31744
  v_mfma_f32_16x16x32_bf16 v[64:67], v[164:167], a[224:227], v[64:67]
  ds_read_b64_tr_b16 v[160:161], v200 offset:51200
  v_mfma_f32_16x16x32_bf16 v[68:71], v[164:167], a[228:231], v[68:71]
  ds_read_b128 v[180:183], v245 offset:34816
  v_mfma_f32_16x16x32_bf16 v[72:75], v[164:167], a[232:235], v[72:75]
  ds_read_b64_tr_b16 v[162:163], v200 offset:57344
  v_mfma_f32_16x16x32_bf16 v[76:79], v[164:167], a[236:239], v[76:79]
  ds_read_b128 v[8:11], v246 offset:7168
  s_waitcnt lgkmcnt(15)
  v_mfma_f32_16x16x32_bf16 v[16:19], v[144:147], a[240:243], v[16:19]
  ds_read_b64_tr_b16 v[164:165], v201 offset:51200
  v_mfma_f32_16x16x32_bf16 v[20:23], v[144:147], a[244:247], v[20:23]
  ds_read_b128 v[184:187], v245 offset:26624
  s_waitcnt lgkmcnt(15)
  v_mfma_f32_16x16x32_bf16 v[24:27], v[144:147], a[248:251], v[24:27]
  ds_read_b64_tr_b16 v[166:167], v201 offset:57344
  buffer_load_dwordx4 v221, s[56:59], s38 offen offset:2048 lds
  s_add_u32 m0, s25, 27648
  s_add_u32 s38, s4, 1327104
  s_waitcnt lgkmcnt(14)
  v_mfma_f32_16x16x32_bf16 v[28:31], v[144:147], a[252:255], v[28:31]
  ds_read_b128 v[188:191], v245 offset:29696
  s_waitcnt lgkmcnt(13)
  v_mfma_f32_16x16x32_bf16 v[248:251], v[144:147], v[140:143], v[248:251]
  ds_read_b128 v[192:195], v245 offset:32768
  v_mfma_f32_16x16x32_bf16 v[32:35], v[148:151], a[240:243], v[32:35]
  ds_read_b64_tr_b16 v[144:145], v202 offset:51200
  v_mfma_f32_16x16x32_bf16 v[36:39], v[148:151], a[244:247], v[36:39]
  ds_read_b128 v[196:199], v245 offset:35840
  v_mfma_f32_16x16x32_bf16 v[40:43], v[148:151], a[248:251], v[40:43]
  ds_read_b64_tr_b16 v[146:147], v202 offset:57344
  v_mfma_f32_16x16x32_bf16 v[44:47], v[148:151], a[252:255], v[44:47]
  ds_read_b128 v[12:15], v246 offset:8192
  v_mfma_f32_16x16x32_bf16 v[252:255], v[148:151], v[140:143], v[252:255]
  buffer_load_dwordx4 v219, s[56:59], s38 offen lds
  v_mfma_f32_16x16x32_bf16 v[48:51], v[152:155], a[240:243], v[48:51]
  ds_read_b64_tr_b16 v[148:149], v203 offset:51200
  v_mfma_f32_16x16x32_bf16 v[52:55], v[152:155], a[244:247], v[52:55]
  v_mfma_f32_16x16x32_bf16 v[56:59], v[152:155], a[248:251], v[56:59]
  ds_read_b64_tr_b16 v[150:151], v203 offset:57344
  v_mfma_f32_16x16x32_bf16 v[60:63], v[152:155], a[252:255], v[60:63]
  s_waitcnt lgkmcnt(15)
  v_mfma_f32_16x16x32_bf16 v[64:67], v[156:159], a[240:243], v[64:67]
  ds_read_b64_tr_b16 v[152:153], v200 offset:53248
  v_mfma_f32_16x16x32_bf16 v[68:71], v[156:159], a[244:247], v[68:71]
  buffer_load_dwordx4 v220, s[56:59], s38 offen offset:1024 lds
  v_mfma_f32_16x16x32_bf16 v[72:75], v[156:159], a[248:251], v[72:75]
  ds_read_b64_tr_b16 v[154:155], v200 offset:59392
  v_mfma_f32_16x16x32_bf16 v[76:79], v[156:159], a[252:255], v[76:79]
  s_waitcnt lgkmcnt(14)
  v_mfma_f32_16x16x32_bf16 v[16:19], v[160:163], v[168:171], v[16:19]
  ds_read_b64_tr_b16 v[156:157], v201 offset:53248
  v_mfma_f32_16x16x32_bf16 v[20:23], v[160:163], v[172:175], v[20:23]
  v_mfma_f32_16x16x32_bf16 v[24:27], v[160:163], v[176:179], v[24:27]
  ds_read_b64_tr_b16 v[158:159], v201 offset:59392
  v_mfma_f32_16x16x32_bf16 v[28:31], v[160:163], v[180:183], v[28:31]
  s_waitcnt lgkmcnt(15)
  v_mfma_f32_16x16x32_bf16 v[248:251], v[160:163], v[8:11], v[248:251]
  s_waitcnt lgkmcnt(12)
  v_mfma_f32_16x16x32_bf16 v[32:35], v[164:167], v[168:171], v[32:35]
  ds_read_b64_tr_b16 v[160:161], v202 offset:53248
  v_mfma_f32_16x16x32_bf16 v[36:39], v[164:167], v[172:175], v[36:39]
  buffer_load_dwordx4 v221, s[56:59], s38 offen offset:2048 lds
  s_add_u32 m0, s25, 49152
  s_add_u32 s38, s4, 1769472
  v_mfma_f32_16x16x32_bf16 v[40:43], v[164:167], v[176:179], v[40:43]
  ds_read_b64_tr_b16 v[162:163], v202 offset:59392
  v_mfma_f32_16x16x32_bf16 v[44:47], v[164:167], v[180:183], v[44:47]
  v_mfma_f32_16x16x32_bf16 v[252:255], v[164:167], v[8:11], v[252:255]
  s_waitcnt lgkmcnt(9)
  v_mfma_f32_16x16x32_bf16 v[48:51], v[144:147], v[168:171], v[48:51]
  ds_read_b64_tr_b16 v[164:165], v203 offset:53248
  v_mfma_f32_16x16x32_bf16 v[52:55], v[144:147], v[172:175], v[52:55]
  v_mfma_f32_16x16x32_bf16 v[56:59], v[144:147], v[176:179], v[56:59]
  ds_read_b64_tr_b16 v[166:167], v203 offset:59392
  v_mfma_f32_16x16x32_bf16 v[60:63], v[144:147], v[180:183], v[60:63]
  s_waitcnt lgkmcnt(8)
  v_mfma_f32_16x16x32_bf16 v[64:67], v[148:151], v[168:171], v[64:67]
  v_mfma_f32_16x16x32_bf16 v[68:71], v[148:151], v[172:175], v[68:71]
  v_mfma_f32_16x16x32_bf16 v[72:75], v[148:151], v[176:179], v[72:75]
  v_mfma_f32_16x16x32_bf16 v[76:79], v[148:151], v[180:183], v[76:79]
  s_waitcnt lgkmcnt(0)
  s_waitcnt vmcnt(6)
  s_barrier
  v_mfma_f32_16x16x32_bf16 v[16:19], v[152:155], v[184:187], v[16:19]
  ds_read_b64_tr_b16 v[144:145], v204 offset:0
  v_mfma_f32_16x16x32_bf16 v[20:23], v[152:155], v[188:191], v[20:23]
  buffer_load_dwordx4 v219, s[56:59], s38 offen lds
  v_mfma_f32_16x16x32_bf16 v[24:27], v[152:155], v[192:195], v[24:27]
  ds_read_b64_tr_b16 v[146:147], v204 offset:512
  v_mfma_f32_16x16x32_bf16 v[28:31], v[152:155], v[196:199], v[28:31]
  ds_read_b64_tr_b16 v[148:149], v205 offset:0
  v_mfma_f32_16x16x32_bf16 v[248:251], v[152:155], v[12:15], v[248:251]
  ds_read_b64_tr_b16 v[150:151], v205 offset:512
  v_mfma_f32_16x16x32_bf16 v[32:35], v[156:159], v[184:187], v[32:35]
  ds_read_b64_tr_b16 v[152:153], v206 offset:0
  v_mfma_f32_16x16x32_bf16 v[36:39], v[156:159], v[188:191], v[36:39]
  buffer_load_dwordx4 v220, s[56:59], s38 offen offset:1024 lds
  v_mfma_f32_16x16x32_bf16 v[40:43], v[156:159], v[192:195], v[40:43]
  ds_read_b64_tr_b16 v[154:155], v206 offset:512
  v_mfma_f32_16x16x32_bf16 v[44:47], v[156:159], v[196:199], v[44:47]
  v_mfma_f32_16x16x32_bf16 v[252:255], v[156:159], v[12:15], v[252:255]
  v_mfma_f32_16x16x32_bf16 v[48:51], v[160:163], v[184:187], v[48:51]
  ds_read_b64_tr_b16 v[156:157], v207 offset:0
  v_mfma_f32_16x16x32_bf16 v[52:55], v[160:163], v[188:191], v[52:55]
  buffer_load_dwordx4 v221, s[56:59], s38 offen offset:2048 lds
  s_add_u32 m0, s25, 52224
  s_add_u32 s38, s4, 2211840
  v_mfma_f32_16x16x32_bf16 v[56:59], v[160:163], v[192:195], v[56:59]
  ds_read_b64_tr_b16 v[158:159], v207 offset:512
  v_mfma_f32_16x16x32_bf16 v[60:63], v[160:163], v[196:199], v[60:63]
  v_mfma_f32_16x16x32_bf16 v[64:67], v[164:167], v[184:187], v[64:67]
  ds_read_b64_tr_b16 v[160:161], v204 offset:2048
  v_mfma_f32_16x16x32_bf16 v[68:71], v[164:167], v[188:191], v[68:71]
  v_mfma_f32_16x16x32_bf16 v[72:75], v[164:167], v[192:195], v[72:75]
  ds_read_b64_tr_b16 v[162:163], v204 offset:2560
  v_mfma_f32_16x16x32_bf16 v[76:79], v[164:167], v[196:199], v[76:79]
  buffer_load_dwordx4 v219, s[56:59], s38 offen lds
  s_waitcnt lgkmcnt(8)
  v_mfma_f32_16x16x32_bf16 v[80:83], v[144:147], a[0:3], 0
  ds_read_b64_tr_b16 v[164:165], v205 offset:2048
  v_mfma_f32_16x16x32_bf16 v[84:87], v[144:147], a[4:7], 0
  v_mfma_f32_16x16x32_bf16 v[88:91], v[144:147], a[8:11], 0
  ds_read_b64_tr_b16 v[166:167], v205 offset:2560
  v_mfma_f32_16x16x32_bf16 v[92:95], v[144:147], a[12:15], 0
  buffer_load_dwordx4 v220, s[56:59], s38 offen offset:1024 lds
  s_waitcnt lgkmcnt(8)
  v_mfma_f32_16x16x32_bf16 v[96:99], v[148:151], a[0:3], 0
  ds_read_b64_tr_b16 v[144:145], v206 offset:2048
  v_mfma_f32_16x16x32_bf16 v[100:103], v[148:151], a[4:7], 0
  v_mfma_f32_16x16x32_bf16 v[104:107], v[148:151], a[8:11], 0
  ds_read_b64_tr_b16 v[146:147], v206 offset:2560
  v_mfma_f32_16x16x32_bf16 v[108:111], v[148:151], a[12:15], 0
  s_waitcnt lgkmcnt(8)
  v_mfma_f32_16x16x32_bf16 v[112:115], v[152:155], a[0:3], 0
  ds_read_b64_tr_b16 v[148:149], v207 offset:2048
  v_mfma_f32_16x16x32_bf16 v[116:119], v[152:155], a[4:7], 0
  buffer_load_dwordx4 v221, s[56:59], s38 offen offset:2048 lds
  s_add_u32 m0, s25, 0
  s_add_u32 s38, s4, 2654208
  v_mfma_f32_16x16x32_bf16 v[120:123], v[152:155], a[8:11], 0
  ds_read_b64_tr_b16 v[150:151], v207 offset:2560
  v_mov_b32 v4, 0
  v_mfma_f32_16x16x32_bf16 v[124:127], v[152:155], a[12:15], 0
  v_mov_b32 v5, 0
  v_and_b32 v6, 127, v0
  s_waitcnt lgkmcnt(8)
  v_mfma_f32_16x16x32_bf16 v[128:131], v[156:159], a[0:3], 0
  ds_read_b64_tr_b16 v[152:153], v204 offset:4096
  v_mul_u32_u24 v6, 144, v6
  v_mfma_f32_16x16x32_bf16 v[132:135], v[156:159], a[4:7], 0
  v_add_u32 v6, 139400, v6
  v_mfma_f32_16x16x32_bf16 v[136:139], v[156:159], a[8:11], 0
  ds_read_b64_tr_b16 v[154:155], v204 offset:4608
  v_mfma_f32_16x16x32_bf16 v[140:143], v[156:159], a[12:15], 0
  ds_write_b64 v6, v[4:5]
  s_waitcnt lgkmcnt(9)
  v_mfma_f32_16x16x32_bf16 v[80:83], v[160:163], a[16:19], v[80:83]
  ds_read_b64_tr_b16 v[156:157], v205 offset:4096
  v_cvt_pk_bf16_f32 v16, v16, v17
  v_mfma_f32_16x16x32_bf16 v[84:87], v[160:163], a[20:23], v[84:87]
  v_cvt_pk_bf16_f32 v17, v18, v19
  v_mfma_f32_16x16x32_bf16 v[88:91], v[160:163], a[24:27], v[88:91]
  ds_read_b64_tr_b16 v[158:159], v205 offset:4608
  v_mfma_f32_16x16x32_bf16 v[92:95], v[160:163], a[28:31], v[92:95]
  ds_write_b64 v237, v[16:17] offset:0
  s_waitcnt lgkmcnt(10)
  v_mfma_f32_16x16x32_bf16 v[96:99], v[164:167], a[16:19], v[96:99]
  ds_read_b64_tr_b16 v[160:161], v206 offset:4096
  v_cvt_pk_bf16_f32 v20, v20, v21
  v_mfma_f32_16x16x32_bf16 v[100:103], v[164:167], a[20:23], v[100:103]
  v_cvt_pk_bf16_f32 v21, v22, v23
  v_mfma_f32_16x16x32_bf16 v[104:107], v[164:167], a[24:27], v[104:107]
  ds_read_b64_tr_b16 v[162:163], v206 offset:4608
  v_mfma_f32_16x16x32_bf16 v[108:111], v[164:167], a[28:31], v[108:111]
  ds_write_b64 v237, v[20:21] offset:4352
  s_waitcnt lgkmcnt(11)
  v_mfma_f32_16x16x32_bf16 v[112:115], v[144:147], a[16:19], v[112:115]
  ds_read_b64_tr_b16 v[164:165], v207 offset:4096
  v_cvt_pk_bf16_f32 v24, v24, v25
  v_mfma_f32_16x16x32_bf16 v[116:119], v[144:147], a[20:23], v[116:119]
  v_cvt_pk_bf16_f32 v25, v26, v27
  v_mfma_f32_16x16x32_bf16 v[120:123], v[144:147], a[24:27], v[120:123]
  ds_read_b64_tr_b16 v[166:167], v207 offset:4608
  v_mfma_f32_16x16x32_bf16 v[124:127], v[144:147], a[28:31], v[124:127]
  ds_write_b64 v237, v[24:25] offset:8704
  s_waitcnt lgkmcnt(12)
  v_mfma_f32_16x16x32_bf16 v[128:131], v[148:151], a[16:19], v[128:131]
  v_cvt_pk_bf16_f32 v28, v28, v29
  v_cvt_pk_bf16_f32 v29, v30, v31
  v_mfma_f32_16x16x32_bf16 v[132:135], v[148:151], a[20:23], v[132:135]
  ds_write_b64 v237, v[28:29] offset:13056
  v_mfma_f32_16x16x32_bf16 v[136:139], v[148:151], a[24:27], v[136:139]
  v_cvt_pk_bf16_f32 v32, v32, v33
  v_cvt_pk_bf16_f32 v33, v34, v35
  v_mfma_f32_16x16x32_bf16 v[140:143], v[148:151], a[28:31], v[140:143]
  ds_write_b64 v238, v[32:33] offset:0
  s_waitcnt lgkmcnt(0)
  s_waitcnt vmcnt(6)
  s_barrier
  v_mfma_f32_16x16x32_bf16 v[80:83], v[152:155], a[32:35], v[80:83]
  ds_read_b64_tr_b16 v[144:145], v204 offset:24576
  v_cvt_pk_bf16_f32 v36, v36, v37
  v_mfma_f32_16x16x32_bf16 v[84:87], v[152:155], a[36:39], v[84:87]
  buffer_load_dwordx4 v219, s[56:59], s38 offen lds
  v_mfma_f32_16x16x32_bf16 v[88:91], v[152:155], a[40:43], v[88:91]
  ds_read_b64_tr_b16 v[146:147], v204 offset:25088
  v_cvt_pk_bf16_f32 v37, v38, v39
  v_mfma_f32_16x16x32_bf16 v[92:95], v[152:155], a[44:47], v[92:95]
  ds_read_b64_tr_b16 v[148:149], v205 offset:24576
  v_mfma_f32_16x16x32_bf16 v[96:99], v[156:159], a[32:35], v[96:99]
  ds_read_b64_tr_b16 v[150:151], v205 offset:25088
  v_mfma_f32_16x16x32_bf16 v[100:103], v[156:159], a[36:39], v[100:103]
  ds_read_b64_tr_b16 v[152:153], v206 offset:24576
  v_mfma_f32_16x16x32_bf16 v[104:107], v[156:159], a[40:43], v[104:107]
  ds_read_b64_tr_b16 v[154:155], v206 offset:25088
  ds_write_b64 v238, v[36:37] offset:4352
  v_mfma_f32_16x16x32_bf16 v[108:111], v[156:159], a[44:47], v[108:111]
  buffer_load_dwordx4 v220, s[56:59], s38 offen offset:1024 lds
  v_mfma_f32_16x16x32_bf16 v[112:115], v[160:163], a[32:35], v[112:115]
  ds_read_b64_tr_b16 v[156:157], v207 offset:24576
  v_cvt_pk_bf16_f32 v40, v40, v41
  v_mfma_f32_16x16x32_bf16 v[116:119], v[160:163], a[36:39], v[116:119]
  v_cvt_pk_bf16_f32 v41, v42, v43
  ds_write_b64 v238, v[40:41] offset:8704
  v_mfma_f32_16x16x32_bf16 v[120:123], v[160:163], a[40:43], v[120:123]
  ds_read_b64_tr_b16 v[158:159], v207 offset:25088
  v_cvt_pk_bf16_f32 v44, v44, v45
  v_mfma_f32_16x16x32_bf16 v[124:127], v[160:163], a[44:47], v[124:127]
  buffer_load_dwordx4 v221, s[56:59], s38 offen offset:2048 lds
  s_add_u32 m0, s25, 3072
  s_add_u32 s38, s4, 3096576
  v_mfma_f32_16x16x32_bf16 v[128:131], v[164:167], a[32:35], v[128:131]
  ds_read_b64_tr_b16 v[160:161], v204 offset:26624
  v_cvt_pk_bf16_f32 v45, v46, v47
  v_mfma_f32_16x16x32_bf16 v[132:135], v[164:167], a[36:39], v[132:135]
  ds_write_b64 v238, v[44:45] offset:13056
  v_mfma_f32_16x16x32_bf16 v[136:139], v[164:167], a[40:43], v[136:139]
  ds_read_b64_tr_b16 v[162:163], v204 offset:27136
  v_cvt_pk_bf16_f32 v48, v48, v49
  v_mfma_f32_16x16x32_bf16 v[140:143], v[164:167], a[44:47], v[140:143]
  v_cvt_pk_bf16_f32 v49, v50, v51
  s_waitcnt lgkmcnt(11)
  v_mfma_f32_16x16x32_bf16 v[80:83], v[144:147], a[48:51], v[80:83]
  ds_read_b64_tr_b16 v[164:165], v205 offset:26624
  ds_write_b64 v239, v[48:49] offset:0
  v_mfma_f32_16x16x32_bf16 v[84:87], v[144:147], a[52:55], v[84:87]
  buffer_load_dwordx4 v219, s[56:59], s38 offen lds
  v_mfma_f32_16x16x32_bf16 v[88:91], v[144:147], a[56:59], v[88:91]
  ds_read_b64_tr_b16 v[166:167], v205 offset:27136
  v_cvt_pk_bf16_f32 v52, v52, v53
  v_mfma_f32_16x16x32_bf16 v[92:95], v[144:147], a[60:63], v[92:95]
  v_cvt_pk_bf16_f32 v53, v54, v55
  ds_write_b64 v239, v[52:53] offset:4352
  s_waitcnt lgkmcnt(13)
  v_mfma_f32_16x16x32_bf16 v[96:99], v[148:151], a[48:51], v[96:99]
  ds_read_b64_tr_b16 v[144:145], v206 offset:26624
  v_cvt_pk_bf16_f32 v56, v56, v57
  v_mfma_f32_16x16x32_bf16 v[100:103], v[148:151], a[52:55], v[100:103]
  buffer_load_dwordx4 v220, s[56:59], s38 offen offset:1024 lds
  v_mfma_f32_16x16x32_bf16 v[104:107], v[148:151], a[56:59], v[104:107]
  ds_read_b64_tr_b16 v[146:147], v206 offset:27136
  v_cvt_pk_bf16_f32 v57, v58, v59
  v_mfma_f32_16x16x32_bf16 v[108:111], v[148:151], a[60:63], v[108:111]
  ds_write_b64 v239, v[56:57] offset:8704
  s_waitcnt lgkmcnt(14)
  v_mfma_f32_16x16x32_bf16 v[112:115], v[152:155], a[48:51], v[112:115]
  ds_read_b64_tr_b16 v[148:149], v207 offset:26624
  v_cvt_pk_bf16_f32 v60, v60, v61
  v_mfma_f32_16x16x32_bf16 v[116:119], v[152:155], a[52:55], v[116:119]
  v_cvt_pk_bf16_f32 v61, v62, v63
  ds_write_b64 v239, v[60:61] offset:13056
  v_mfma_f32_16x16x32_bf16 v[120:123], v[152:155], a[56:59], v[120:123]
  ds_read_b64_tr_b16 v[150:151], v207 offset:27136
  v_cvt_pk_bf16_f32 v64, v64, v65
  v_mfma_f32_16x16x32_bf16 v[124:127], v[152:155], a[60:63], v[124:127]
  buffer_load_dwordx4 v221, s[56:59], s38 offen offset:2048 lds
  s_add_u32 m0, s25, 24576
  s_add_u32 s38, s4, 3538944
  s_waitcnt lgkmcnt(13)
  v_mfma_f32_16x16x32_bf16 v[128:131], v[156:159], a[48:51], v[128:131]
  ds_read_b64_tr_b16 v[152:153], v204 offset:28672
  v_cvt_pk_bf16_f32 v65, v66, v67
  v_mfma_f32_16x16x32_bf16 v[132:135], v[156:159], a[52:55], v[132:135]
  ds_write_b64 v240, v[64:65] offset:0
  v_mfma_f32_16x16x32_bf16 v[136:139], v[156:159], a[56:59], v[136:139]
  ds_read_b64_tr_b16 v[154:155], v204 offset:29184
  v_cvt_pk_bf16_f32 v68, v68, v69
  v_mfma_f32_16x16x32_bf16 v[140:143], v[156:159], a[60:63], v[140:143]
  v_cvt_pk_bf16_f32 v69, v70, v71
  ds_write_b64 v240, v[68:69] offset:4352
  s_waitcnt lgkmcnt(14)
  v_mfma_f32_16x16x32_bf16 v[80:83], v[160:163], a[64:67], v[80:83]
  ds_read_b64_tr_b16 v[156:157], v205 offset:28672
  v_cvt_pk_bf16_f32 v72, v72, v73
  v_mfma_f32_16x16x32_bf16 v[84:87], v[160:163], a[68:71], v[84:87]
  v_cvt_pk_bf16_f32 v73, v74, v75
  v_mfma_f32_16x16x32_bf16 v[88:91], v[160:163], a[72:75], v[88:91]
  ds_read_b64_tr_b16 v[158:159], v205 offset:29184
  ds_write_b64 v240, v[72:73] offset:8704
  v_mfma_f32_16x16x32_bf16 v[92:95], v[160:163], a[76:79], v[92:95]
  v_cvt_pk_bf16_f32 v76, v76, v77
  v_cvt_pk_bf16_f32 v77, v78, v79
  s_waitcnt lgkmcnt(14)
  v_mfma_f32_16x16x32_bf16 v[96:99], v[164:167], a[64:67], v[96:99]
  ds_read_b64_tr_b16 v[160:161], v206 offset:28672
  v_mfma_f32_16x16x32_bf16 v[100:103], v[164:167], a[68:71], v[100:103]
  ds_write_b64 v240, v[76:77] offset:13056
  v_mfma_f32_16x16x32_bf16 v[104:107], v[164:167], a[72:75], v[104:107]
  ds_read_b64_tr_b16 v[162:163], v206 offset:29184
  v_cvt_pk_bf16_f32 v248, v248, v249
  v_mfma_f32_16x16x32_bf16 v[108:111], v[164:167], a[76:79], v[108:111]
  v_cvt_pk_bf16_f32 v249, v250, v251
  s_lshl_b32 s36, s23, 6
  s_add_u32 s36, s36, 16
  s_mul_i32 s36, s36, 272
  v_subrev_u32 v250, s36, v237
  s_waitcnt lgkmcnt(14)
  v_mfma_f32_16x16x32_bf16 v[112:115], v[144:147], a[64:67], v[112:115]
  ds_read_b64_tr_b16 v[164:165], v207 offset:28672
  v_mfma_f32_16x16x32_bf16 v[116:119], v[144:147], a[68:71], v[116:119]
  ds_write_b64 v250, v[248:249]
  v_mfma_f32_16x16x32_bf16 v[120:123], v[144:147], a[72:75], v[120:123]
  ds_read_b64_tr_b16 v[166:167], v207 offset:29184
  v_cvt_pk_bf16_f32 v252, v252, v253
  v_mfma_f32_16x16x32_bf16 v[124:127], v[144:147], a[76:79], v[124:127]
  v_cvt_pk_bf16_f32 v253, v254, v255
  s_lshl_b32 s36, s23, 6
  s_add_u32 s36, s36, 16
  s_mul_i32 s36, s36, 272
  v_subrev_u32 v254, s36, v238
  s_waitcnt lgkmcnt(13)
  v_mfma_f32_16x16x32_bf16 v[128:131], v[148:151], a[64:67], v[128:131]
  ds_write_b64 v254, v[252:253]
  v_mfma_f32_16x16x32_bf16 v[132:135], v[148:151], a[68:71], v[132:135]
  v_mfma_f32_16x16x32_bf16 v[136:139], v[148:151], a[72:75], v[136:139]
  v_mfma_f32_16x16x32_bf16 v[140:143], v[148:151], a[76:79], v[140:143]
  s_waitcnt lgkmcnt(0)
  s_waitcnt vmcnt(6)
  s_barrier
  v_mfma_f32_16x16x32_bf16 v[80:83], v[152:155], a[80:83], v[80:83]
  ds_read_b64_tr_b16 v[144:145], v204 offset:49152
  v_mfma_f32_16x16x32_bf16 v[84:87], v[152:155], a[84:87], v[84:87]
  buffer_load_dwordx4 v219, s[56:59], s38 offen lds
  v_mfma_f32_16x16x32_bf16 v[88:91], v[152:155], a[88:91], v[88:91]
  ds_read_b64_tr_b16 v[146:147], v204 offset:49664
  v_mfma_f32_16x16x32_bf16 v[92:95], v[152:155], a[92:95], v[92:95]
  ds_read_b64_tr_b16 v[148:149], v205 offset:49152
  v_mfma_f32_16x16x32_bf16 v[96:99], v[156:159], a[80:83], v[96:99]
  ds_read_b64_tr_b16 v[150:151], v205 offset:49664
  v_mfma_f32_16x16x32_bf16 v[100:103], v[156:159], a[84:87], v[100:103]
  ds_read_b64_tr_b16 v[152:153], v206 offset:49152
  v_mfma_f32_16x16x32_bf16 v[104:107], v[156:159], a[88:91], v[104:107]
  ds_read_b64_tr_b16 v[154:155], v206 offset:49664
  ds_read_b128 v[16:19], v241 offset:3968
  v_mfma_f32_16x16x32_bf16 v[108:111], v[156:159], a[92:95], v[108:111]
  buffer_load_dwordx4 v220, s[56:59], s38 offen offset:1024 lds
  v_mfma_f32_16x16x32_bf16 v[112:115], v[160:163], a[80:83], v[112:115]
  ds_read_b64_tr_b16 v[156:157], v207 offset:49152
  ds_read_b128 v[20:23], v241 offset:3984
  v_mfma_f32_16x16x32_bf16 v[116:119], v[160:163], a[84:87], v[116:119]
  ds_read_b64 v[24:25], v241 offset:4000
  ds_read_b128 v[28:31], v241 offset:3808
  v_mfma_f32_16x16x32_bf16 v[120:123], v[160:163], a[88:91], v[120:123]
  ds_read_b64_tr_b16 v[158:159], v207 offset:49664
  ds_read_b128 v[32:35], v241 offset:3824
  v_mfma_f32_16x16x32_bf16 v[124:127], v[160:163], a[92:95], v[124:127]
  buffer_load_dwordx4 v221, s[56:59], s38 offen offset:2048 lds
  s_add_u32 m0, s25, 27648
  s_add_u32 s38, s4, 3981312
  v_mfma_f32_16x16x32_bf16 v[128:131], v[164:167], a[80:83], v[128:131]
  ds_read_b64_tr_b16 v[160:161], v204 offset:51200
  ds_read_b64 v[36:37], v241 offset:3840
  v_mfma_f32_16x16x32_bf16 v[132:135], v[164:167], a[84:87], v[132:135]
  ds_read_b128 v[40:43], v241 offset:3264
  ds_read_b128 v[44:47], v241 offset:3280
  v_mfma_f32_16x16x32_bf16 v[136:139], v[164:167], a[88:91], v[136:139]
  ds_read_b64_tr_b16 v[162:163], v204 offset:51712
  ds_read_b64 v[48:49], v241 offset:3296
  v_mfma_f32_16x16x32_bf16 v[140:143], v[164:167], a[92:95], v[140:143]
  ds_read_b128 v[60:63], v241 offset:2720
  s_waitcnt lgkmcnt(15)
  v_mfma_f32_16x16x32_bf16 v[80:83], v[144:147], a[96:99], v[80:83]
  ds_read_b64_tr_b16 v[164:165], v205 offset:51200
  ds_read_b128 v[64:67], v241 offset:2736
  v_mfma_f32_16x16x32_bf16 v[84:87], v[144:147], a[100:103], v[84:87]
  buffer_load_dwordx4 v219, s[56:59], s38 offen lds
  v_mfma_f32_16x16x32_bf16 v[88:91], v[144:147], a[104:107], v[88:91]
  ds_read_b64_tr_b16 v[166:167], v205 offset:51712
  ds_read_b64 v[68:69], v241 offset:2752
  v_mfma_f32_16x16x32_bf16 v[92:95], v[144:147], a[108:111], v[92:95]
  ds_read_b128 v[70:73], v241 offset:2176
  ds_read_b128 v[74:77], v241 offset:2192
  v_mfma_f32_16x16x32_bf16 v[96:99], v[148:151], a[96:99], v[96:99]
  ds_read_b64_tr_b16 v[144:145], v206 offset:51200
  ds_read_b64 v[78:79], v241 offset:2208
  v_mfma_f32_16x16x32_bf16 v[100:103], v[148:151], a[100:103], v[100:103]
  buffer_load_dwordx4 v220, s[56:59], s38 offen offset:1024 lds
  v_mfma_f32_16x16x32_bf16 v[104:107], v[148:151], a[104:107], v[104:107]
  ds_read_b64_tr_b16 v[146:147], v206 offset:51712
  v_mov_b32 v52, 0
  v_mfma_f32_16x16x32_bf16 v[108:111], v[148:151], a[108:111], v[108:111]
  v_cmp_gt_u32 vcc, 32, v1
  s_waitcnt lgkmcnt(15)
  s_nop 0
  v_cndmask_b32 v25, v25, v52, vcc
  v_cndmask_b32 v16, v52, v16, vcc
  v_mfma_f32_16x16x32_bf16 v[112:115], v[152:155], a[96:99], v[112:115]
  ds_read_b64_tr_b16 v[148:149], v207 offset:51200
  v_dot2_f32_bf16 v52, v16, v28, 0
  s_waitcnt lgkmcnt(14)
  v_dot2_f32_bf16 v53, v16, v40, 0
  v_dot2_f32_bf16 v52, v17, v29, v52
  v_dot2_f32_bf16 v53, v17, v41, v53
  v_dot2_f32_bf16 v52, v18, v30, v52
  v_dot2_f32_bf16 v53, v18, v42, v53
  v_dot2_f32_bf16 v52, v19, v31, v52
  v_dot2_f32_bf16 v53, v19, v43, v53
  v_dot2_f32_bf16 v52, v20, v32, v52
  s_waitcnt lgkmcnt(13)
  v_dot2_f32_bf16 v53, v20, v44, v53
  v_dot2_f32_bf16 v52, v21, v33, v52
  v_dot2_f32_bf16 v53, v21, v45, v53
  v_dot2_f32_bf16 v52, v22, v34, v52
  v_dot2_f32_bf16 v53, v22, v46, v53
  v_dot2_f32_bf16 v52, v23, v35, v52
  v_dot2_f32_bf16 v53, v23, v47, v53
  v_dot2_f32_bf16 v52, v24, v36, v52
  s_waitcnt lgkmcnt(11)
  v_dot2_f32_bf16 v53, v24, v48, v53
  v_dot2_f32_bf16 v52, v25, v37, v52
  v_dot2_f32_bf16 v53, v25, v49, v53
  v_mfma_f32_16x16x32_bf16 v[116:119], v[152:155], a[100:103], v[116:119]
  ds_read_b128 v[28:31], v241 offset:1632
  ds_read_b128 v[32:35], v241 offset:1648
  v_mfma_f32_16x16x32_bf16 v[120:123], v[152:155], a[104:107], v[120:123]
  ds_read_b64_tr_b16 v[150:151], v207 offset:51712
  ds_read_b64 v[36:37], v241 offset:1664
  v_mfma_f32_16x16x32_bf16 v[124:127], v[152:155], a[108:111], v[124:127]
  buffer_load_dwordx4 v221, s[56:59], s38 offen offset:2048 lds
  s_add_u32 m0, s25, 49152
  s_add_u32 s38, s4, 4423680
  v_mfma_f32_16x16x32_bf16 v[128:131], v[156:159], a[96:99], v[128:131]
  ds_read_b64_tr_b16 v[152:153], v204 offset:53248
  ds_read_b128 v[40:43], v241 offset:1088
  v_mfma_f32_16x16x32_bf16 v[132:135], v[156:159], a[100:103], v[132:135]
  ds_read_b128 v[44:47], v241 offset:1104
  ds_read_b64 v[48:49], v241 offset:1120
  v_mfma_f32_16x16x32_bf16 v[136:139], v[156:159], a[104:107], v[136:139]
  ds_read_b64_tr_b16 v[154:155], v204 offset:53760
  s_waitcnt lgkmcnt(15)
  v_dot2_f32_bf16 v54, v16, v60, 0
  s_waitcnt lgkmcnt(14)
  v_dot2_f32_bf16 v55, v16, v70, 0
  v_dot2_f32_bf16 v54, v17, v61, v54
  v_dot2_f32_bf16 v55, v17, v71, v55
  v_dot2_f32_bf16 v54, v18, v62, v54
  v_dot2_f32_bf16 v55, v18, v72, v55
  v_dot2_f32_bf16 v54, v19, v63, v54
  v_dot2_f32_bf16 v55, v19, v73, v55
  v_dot2_f32_bf16 v54, v20, v64, v54
  s_waitcnt lgkmcnt(13)
  v_dot2_f32_bf16 v55, v20, v74, v55
  v_dot2_f32_bf16 v54, v21, v65, v54
  v_dot2_f32_bf16 v55, v21, v75, v55
  v_dot2_f32_bf16 v54, v22, v66, v54
  v_dot2_f32_bf16 v55, v22, v76, v55
  v_dot2_f32_bf16 v54, v23, v67, v54
  v_dot2_f32_bf16 v55, v23, v77, v55
  v_dot2_f32_bf16 v54, v24, v68, v54
  s_waitcnt lgkmcnt(11)
  v_dot2_f32_bf16 v55, v24, v78, v55
  v_dot2_f32_bf16 v54, v25, v69, v54
  v_dot2_f32_bf16 v55, v25, v79, v55
  v_mfma_f32_16x16x32_bf16 v[140:143], v[156:159], a[108:111], v[140:143]
  ds_read_b128 v[60:63], v241 offset:544
  v_mfma_f32_16x16x32_bf16 v[80:83], v[160:163], a[112:115], v[80:83]
  ds_read_b64_tr_b16 v[156:157], v205 offset:53248
  ds_read_b128 v[64:67], v241 offset:560
  v_mfma_f32_16x16x32_bf16 v[84:87], v[160:163], a[116:119], v[84:87]
  ds_read_b64 v[68:69], v241 offset:576
  v_mfma_f32_16x16x32_bf16 v[88:91], v[160:163], a[120:123], v[88:91]
  ds_read_b64_tr_b16 v[158:159], v205 offset:53760
  ds_read_b128 v[70:73], v241 offset:0
  v_mfma_f32_16x16x32_bf16 v[92:95], v[160:163], a[124:127], v[92:95]
  ds_read_b128 v[74:77], v241 offset:16
  v_mfma_f32_16x16x32_bf16 v[96:99], v[164:167], a[112:115], v[96:99]
  ds_read_b64_tr_b16 v[160:161], v206 offset:53248
  ds_read_b64 v[78:79], v241 offset:32
  v_mfma_f32_16x16x32_bf16 v[100:103], v[164:167], a[116:119], v[100:103]
  s_waitcnt lgkmcnt(15)
  v_dot2_f32_bf16 v56, v16, v28, 0
  s_waitcnt lgkmcnt(12)
  v_dot2_f32_bf16 v57, v16, v40, 0
  v_dot2_f32_bf16 v56, v17, v29, v56
  v_dot2_f32_bf16 v57, v17, v41, v57
  v_dot2_f32_bf16 v56, v18, v30, v56
  v_dot2_f32_bf16 v57, v18, v42, v57
  v_dot2_f32_bf16 v56, v19, v31, v56
  v_dot2_f32_bf16 v57, v19, v43, v57
  v_dot2_f32_bf16 v56, v20, v32, v56
  s_waitcnt lgkmcnt(11)
  v_dot2_f32_bf16 v57, v20, v44, v57
  v_dot2_f32_bf16 v56, v21, v33, v56
  v_dot2_f32_bf16 v57, v21, v45, v57
  v_dot2_f32_bf16 v56, v22, v34, v56
  v_dot2_f32_bf16 v57, v22, v46, v57
  v_dot2_f32_bf16 v56, v23, v35, v56
  v_dot2_f32_bf16 v57, v23, v47, v57
  v_dot2_f32_bf16 v56, v24, v36, v56
  s_waitcnt lgkmcnt(10)
  v_dot2_f32_bf16 v57, v24, v48, v57
  v_dot2_f32_bf16 v56, v25, v37, v56
  v_dot2_f32_bf16 v57, v25, v49, v57
  v_mfma_f32_16x16x32_bf16 v[104:107], v[164:167], a[120:123], v[104:107]
  ds_read_b64_tr_b16 v[162:163], v206 offset:53760
  ds_read_b128 v[28:31], v241 offset:3888
  v_mfma_f32_16x16x32_bf16 v[108:111], v[164:167], a[124:127], v[108:111]
  ds_read_b128 v[32:35], v241 offset:3904
  v_mfma_f32_16x16x32_bf16 v[112:115], v[144:147], a[112:115], v[112:115]
  ds_read_b64_tr_b16 v[164:165], v207 offset:53248
  ds_read_b64 v[36:37], v241 offset:3920
  v_mfma_f32_16x16x32_bf16 v[116:119], v[144:147], a[116:119], v[116:119]
  ds_read_b128 v[40:43], v241 offset:3344
  v_mfma_f32_16x16x32_bf16 v[120:123], v[144:147], a[120:123], v[120:123]
  ds_read_b64_tr_b16 v[166:167], v207 offset:53760
  ds_read_b128 v[44:47], v241 offset:3360
  v_mfma_f32_16x16x32_bf16 v[124:127], v[144:147], a[124:127], v[124:127]
  ds_read_b64 v[48:49], v241 offset:3376
  v_mfma_f32_16x16x32_bf16 v[128:131], v[148:151], a[112:115], v[128:131]
  s_waitcnt lgkmcnt(15)
  v_dot2_f32_bf16 v58, v16, v60, 0
  s_waitcnt lgkmcnt(12)
  v_dot2_f32_bf16 v59, v16, v70, 0
  v_dot2_f32_bf16 v58, v17, v61, v58
  v_dot2_f32_bf16 v59, v17, v71, v59
  v_dot2_f32_bf16 v58, v18, v62, v58
  v_dot2_f32_bf16 v59, v18, v72, v59
  v_dot2_f32_bf16 v58, v19, v63, v58
  v_dot2_f32_bf16 v59, v19, v73, v59
  v_dot2_f32_bf16 v58, v20, v64, v58
  s_waitcnt lgkmcnt(11)
  v_dot2_f32_bf16 v59, v20, v74, v59
  v_dot2_f32_bf16 v58, v21, v65, v58
  v_dot2_f32_bf16 v59, v21, v75, v59
  v_dot2_f32_bf16 v58, v22, v66, v58
  v_dot2_f32_bf16 v59, v22, v76, v59
  v_dot2_f32_bf16 v58, v23, v67, v58
  v_dot2_f32_bf16 v59, v23, v77, v59
  v_dot2_f32_bf16 v58, v24, v68, v58
  s_waitcnt lgkmcnt(9)
  v_dot2_f32_bf16 v59, v24, v78, v59
  v_dot2_f32_bf16 v58, v25, v69, v58
  v_dot2_f32_bf16 v59, v25, v79, v59
  v_mfma_f32_16x16x32_bf16 v[132:135], v[148:151], a[116:119], v[132:135]
  v_mov_b32 v26, s43
  v_mfma_f32_16x16x32_bf16 v[136:139], v[148:151], a[120:123], v[136:139]
  v_cmp_le_u32 vcc, 2, v244
  s_nop 1
  s_nop 0
  v_cndmask_b32 v53, v26, v53, vcc
  v_mfma_f32_16x16x32_bf16 v[140:143], v[148:151], a[124:127], v[140:143]
  v_cmp_le_u32 vcc, 4, v244
  s_nop 1
  s_nop 0
  v_cndmask_b32 v54, v26, v54, vcc
  s_waitcnt lgkmcnt(2)
  s_waitcnt vmcnt(6)
  s_barrier
  v_mfma_f32_16x16x32_bf16 v[80:83], v[152:155], a[128:131], v[80:83]
  ds_read_b64_tr_b16 v[144:145], v204 offset:0
  v_cmp_le_u32 vcc, 6, v244
  s_nop 1
  s_nop 0
  v_cndmask_b32 v55, v26, v55, vcc
  v_mfma_f32_16x16x32_bf16 v[84:87], v[152:155], a[132:135], v[84:87]
  buffer_load_dwordx4 v219, s[56:59], s38 offen lds
  v_mfma_f32_16x16x32_bf16 v[88:91], v[152:155], a[136:139], v[88:91]
  ds_read_b64_tr_b16 v[146:147], v204 offset:512
  v_cmp_le_u32 vcc, 8, v244
  s_nop 1
  s_nop 0
  v_cndmask_b32 v56, v26, v56, vcc
  v_mfma_f32_16x16x32_bf16 v[92:95], v[152:155], a[140:143], v[92:95]
  ds_read_b64_tr_b16 v[148:149], v205 offset:0
  v_cmp_le_u32 vcc, 10, v244
  s_nop 1
  s_nop 0
  v_cndmask_b32 v57, v26, v57, vcc
  v_mfma_f32_16x16x32_bf16 v[96:99], v[156:159], a[128:131], v[96:99]
  ds_read_b64_tr_b16 v[150:151], v205 offset:512
  v_cmp_le_u32 vcc, 12, v244
  s_nop 1
  s_nop 0
  v_cndmask_b32 v58, v26, v58, vcc
  v_mfma_f32_16x16x32_bf16 v[100:103], v[156:159], a[132:135], v[100:103]
  ds_read_b64_tr_b16 v[152:153], v206 offset:0
  v_cmp_le_u32 vcc, 14, v244
  s_nop 1
  s_nop 0
  v_cndmask_b32 v59, v26, v59, vcc
  v_mfma_f32_16x16x32_bf16 v[104:107], v[156:159], a[136:139], v[104:107]
  ds_read_b64_tr_b16 v[154:155], v206 offset:512
  v_max3_f32 v27, v52, v53, v54
  v_mfma_f32_16x16x32_bf16 v[108:111], v[156:159], a[140:143], v[108:111]
  buffer_load_dwordx4 v220, s[56:59], s38 offen offset:1024 lds
  v_mfma_f32_16x16x32_bf16 v[112:115], v[160:163], a[128:131], v[112:115]
  ds_read_b64_tr_b16 v[156:157], v207 offset:0
  v_max3_f32 v27, v27, v55, v56
  v_mfma_f32_16x16x32_bf16 v[116:119], v[160:163], a[132:135], v[116:119]
  v_max3_f32 v27, v27, v57, v58
  v_max_f32 v27, v27, v59
  v_mfma_f32_16x16x32_bf16 v[120:123], v[160:163], a[136:139], v[120:123]
  ds_read_b64_tr_b16 v[158:159], v207 offset:512
  v_mul_f32 v27, s40, v27
  v_mfma_f32_16x16x32_bf16 v[124:127], v[160:163], a[140:143], v[124:127]
  buffer_load_dwordx4 v221, s[56:59], s38 offen offset:2048 lds
  s_add_u32 m0, s25, 52224
  s_add_u32 s38, s4, 4866048
  v_mfma_f32_16x16x32_bf16 v[128:131], v[164:167], a[128:131], v[128:131]
  ds_read_b64_tr_b16 v[160:161], v204 offset:2048
  v_fma_f32 v52, v52, s40, -v27
  v_mfma_f32_16x16x32_bf16 v[132:135], v[164:167], a[132:135], v[132:135]
  v_fma_f32 v53, v53, s40, -v27
  v_fma_f32 v54, v54, s40, -v27
  v_mfma_f32_16x16x32_bf16 v[136:139], v[164:167], a[136:139], v[136:139]
  ds_read_b64_tr_b16 v[162:163], v204 offset:2560
  v_fma_f32 v55, v55, s40, -v27
  v_mfma_f32_16x16x32_bf16 v[140:143], v[164:167], a[140:143], v[140:143]
  v_fma_f32 v56, v56, s40, -v27
  v_fma_f32 v57, v57, s40, -v27
  s_waitcnt lgkmcnt(8)
  v_mfma_f32_16x16x32_bf16 v[80:83], v[144:147], a[144:147], v[80:83]
  ds_read_b64_tr_b16 v[164:165], v205 offset:2048
  v_fma_f32 v58, v58, s40, -v27
  v_mfma_f32_16x16x32_bf16 v[84:87], v[144:147], a[148:151], v[84:87]
  buffer_load_dwordx4 v219, s[56:59], s38 offen lds
  v_mfma_f32_16x16x32_bf16 v[88:91], v[144:147], a[152:155], v[88:91]
  ds_read_b64_tr_b16 v[166:167], v205 offset:2560
  v_fma_f32 v59, v59, s40, -v27
  v_mfma_f32_16x16x32_bf16 v[92:95], v[144:147], a[156:159], v[92:95]
  v_exp_f32 v52, v52
  s_waitcnt lgkmcnt(8)
  v_mfma_f32_16x16x32_bf16 v[96:99], v[148:151], a[144:147], v[96:99]
  ds_read_b64_tr_b16 v[144:145], v206 offset:2048
  v_exp_f32 v53, v53
  v_mfma_f32_16x16x32_bf16 v[100:103], v[148:151], a[148:151], v[100:103]
  buffer_load_dwordx4 v220, s[56:59], s38 offen offset:1024 lds
  v_mfma_f32_16x16x32_bf16 v[104:107], v[148:151], a[152:155], v[104:107]
  ds_read_b64_tr_b16 v[146:147], v206 offset:2560
  v_exp_f32 v54, v54
  v_mfma_f32_16x16x32_bf16 v[108:111], v[148:151], a[156:159], v[108:111]
  v_exp_f32 v55, v55
  s_waitcnt lgkmcnt(8)
  v_mfma_f32_16x16x32_bf16 v[112:115], v[152:155], a[144:147], v[112:115]
  ds_read_b64_tr_b16 v[148:149], v207 offset:2048
  v_exp_f32 v56, v56
  v_mfma_f32_16x16x32_bf16 v[116:119], v[152:155], a[148:151], v[116:119]
  v_exp_f32 v57, v57
  v_mfma_f32_16x16x32_bf16 v[120:123], v[152:155], a[152:155], v[120:123]
  ds_read_b64_tr_b16 v[150:151], v207 offset:2560
  v_exp_f32 v58, v58
  v_mfma_f32_16x16x32_bf16 v[124:127], v[152:155], a[156:159], v[124:127]
  buffer_load_dwordx4 v221, s[56:59], s38 offen offset:2048 lds
  s_add_u32 m0, s25, 0
  s_add_u32 s38, s5, 0
  s_waitcnt lgkmcnt(8)
  v_mfma_f32_16x16x32_bf16 v[128:131], v[156:159], a[144:147], v[128:131]
  ds_read_b64_tr_b16 v[152:153], v204 offset:4096
  v_exp_f32 v59, v59
  v_mfma_f32_16x16x32_bf16 v[132:135], v[156:159], a[148:151], v[132:135]
  v_add_f32 v26, v52, v53
  v_add_f32 v26, v26, v54
  v_mfma_f32_16x16x32_bf16 v[136:139], v[156:159], a[152:155], v[136:139]
  ds_read_b64_tr_b16 v[154:155], v204 offset:4608
  v_add_f32 v26, v26, v55
  v_mfma_f32_16x16x32_bf16 v[140:143], v[156:159], a[156:159], v[140:143]
  v_add_f32 v26, v26, v56
  v_add_f32 v26, v26, v57
  s_waitcnt lgkmcnt(8)
  v_mfma_f32_16x16x32_bf16 v[80:83], v[160:163], a[160:163], v[80:83]
  ds_read_b64_tr_b16 v[156:157], v205 offset:4096
  v_add_f32 v26, v26, v58
  v_mfma_f32_16x16x32_bf16 v[84:87], v[160:163], a[164:167], v[84:87]
  v_add_f32 v26, v26, v59
  v_rcp_f32 v26, v26
  v_mfma_f32_16x16x32_bf16 v[88:91], v[160:163], a[168:171], v[88:91]
  ds_read_b64_tr_b16 v[158:159], v205 offset:4608
  v_mul_f32 v52, v52, v26
  v_mfma_f32_16x16x32_bf16 v[92:95], v[160:163], a[172:175], v[92:95]
  v_mul_f32 v53, v53, v26
  v_mul_f32 v54, v54, v26
  s_waitcnt lgkmcnt(8)
  v_mfma_f32_16x16x32_bf16 v[96:99], v[164:167], a[160:163], v[96:99]
  ds_read_b64_tr_b16 v[160:161], v206 offset:4096
  v_mul_f32 v55, v55, v26
  v_mfma_f32_16x16x32_bf16 v[100:103], v[164:167], a[164:167], v[100:103]
  v_mul_f32 v56, v56, v26
  v_mul_f32 v57, v57, v26
  v_mfma_f32_16x16x32_bf16 v[104:107], v[164:167], a[168:171], v[104:107]
  ds_read_b64_tr_b16 v[162:163], v206 offset:4608
  v_mul_f32 v58, v58, v26
  v_mfma_f32_16x16x32_bf16 v[108:111], v[164:167], a[172:175], v[108:111]
  v_mul_f32 v59, v59, v26
  v_cvt_pk_bf16_f32 v16, v52, v53
  s_waitcnt lgkmcnt(8)
  v_mfma_f32_16x16x32_bf16 v[112:115], v[144:147], a[160:163], v[112:115]
  ds_read_b64_tr_b16 v[164:165], v207 offset:4096
  v_cvt_pk_bf16_f32 v17, v54, v55
  v_mfma_f32_16x16x32_bf16 v[116:119], v[144:147], a[164:167], v[116:119]
  v_cvt_pk_bf16_f32 v18, v56, v57
  v_cvt_pk_bf16_f32 v19, v58, v59
  v_mfma_f32_16x16x32_bf16 v[120:123], v[144:147], a[168:171], v[120:123]
  ds_read_b64_tr_b16 v[166:167], v207 offset:4608
  v_perm_b32 v4, v40, v28, s41
  v_mfma_f32_16x16x32_bf16 v[124:127], v[144:147], a[172:175], v[124:127]
  v_perm_b32 v5, v40, v28, s42
  v_perm_b32 v6, v41, v29, s41
  s_waitcnt lgkmcnt(8)
  v_mfma_f32_16x16x32_bf16 v[128:131], v[148:151], a[160:163], v[128:131]
  v_perm_b32 v7, v41, v29, s42
  v_perm_b32 v8, v42, v30, s41
  v_mfma_f32_16x16x32_bf16 v[132:135], v[148:151], a[164:167], v[132:135]
  v_perm_b32 v9, v42, v30, s42
  v_perm_b32 v10, v43, v31, s41
  v_mfma_f32_16x16x32_bf16 v[136:139], v[148:151], a[168:171], v[136:139]
  v_perm_b32 v11, v43, v31, s42
  v_perm_b32 v12, v44, v32, s41
  v_mfma_f32_16x16x32_bf16 v[140:143], v[148:151], a[172:175], v[140:143]
  v_perm_b32 v13, v44, v32, s42
  v_perm_b32 v14, v45, v33, s41
  s_waitcnt lgkmcnt(0)
  s_waitcnt vmcnt(6)
  s_barrier
  v_mfma_f32_16x16x32_bf16 v[80:83], v[152:155], a[176:179], v[80:83]
  ds_read_b64_tr_b16 v[144:145], v204 offset:24576
  v_perm_b32 v15, v45, v33, s42
  v_mfma_f32_16x16x32_bf16 v[84:87], v[152:155], a[180:183], v[84:87]
  buffer_load_dwordx4 v219, s[56:59], s38 offen lds
  v_mfma_f32_16x16x32_bf16 v[88:91], v[152:155], a[184:187], v[88:91]
  ds_read_b64_tr_b16 v[146:147], v204 offset:25088
  v_perm_b32 v248, v46, v34, s41
  v_mfma_f32_16x16x32_bf16 v[92:95], v[152:155], a[188:191], v[92:95]
  ds_read_b64_tr_b16 v[148:149], v205 offset:24576
  v_perm_b32 v249, v46, v34, s42
  v_mfma_f32_16x16x32_bf16 v[96:99], v[156:159], a[176:179], v[96:99]
  ds_read_b64_tr_b16 v[150:151], v205 offset:25088
  v_perm_b32 v250, v47, v35, s41
  v_mfma_f32_16x16x32_bf16 v[100:103], v[156:159], a[180:183], v[100:103]
  ds_read_b64_tr_b16 v[152:153], v206 offset:24576
  v_perm_b32 v251, v47, v35, s42
  v_mfma_f32_16x16x32_bf16 v[104:107], v[156:159], a[184:187], v[104:107]
  ds_read_b64_tr_b16 v[154:155], v206 offset:25088
  v_perm_b32 v252, v48, v36, s41
  v_mfma_f32_16x16x32_bf16 v[108:111], v[156:159], a[188:191], v[108:111]
  buffer_load_dwordx4 v220, s[56:59], s38 offen offset:1024 lds
  v_mfma_f32_16x16x32_bf16 v[112:115], v[160:163], a[176:179], v[112:115]
  ds_read_b64_tr_b16 v[156:157], v207 offset:24576
  v_perm_b32 v253, v48, v36, s42
  v_mfma_f32_16x16x32_bf16 v[116:119], v[160:163], a[180:183], v[116:119]
  v_perm_b32 v254, v49, v37, s41
  v_perm_b32 v255, v49, v37, s42
  v_mfma_f32_16x16x32_bf16 v[120:123], v[160:163], a[184:187], v[120:123]
  ds_read_b64_tr_b16 v[158:159], v207 offset:25088
  v_mfma_f32_16x16x32_bf16 v[124:127], v[160:163], a[188:191], v[124:127]
  buffer_load_dwordx4 v221, s[56:59], s38 offen offset:2048 lds
  s_add_u32 m0, s25, 3072
  s_add_u32 s38, s5, 442368
  v_mfma_f32_16x16x32_bf16 v[128:131], v[164:167], a[176:179], v[128:131]
  ds_read_b64_tr_b16 v[160:161], v204 offset:26624
  v_mfma_f32_16x16x32_bf16 v[132:135], v[164:167], a[180:183], v[132:135]
  ds_read_b128 v[28:31], v241 offset:2800
  v_mfma_f32_16x16x32_bf16 v[136:139], v[164:167], a[184:187], v[136:139]
  ds_read_b64_tr_b16 v[162:163], v204 offset:27136
  v_mfma_f32_16x16x32_bf16 v[140:143], v[164:167], a[188:191], v[140:143]
  ds_read_b128 v[32:35], v241 offset:2816
  s_waitcnt lgkmcnt(10)
  v_mfma_f32_16x16x32_bf16 v[80:83], v[144:147], a[192:195], v[80:83]
  ds_read_b64_tr_b16 v[164:165], v205 offset:26624
  v_mfma_f32_16x16x32_bf16 v[84:87], v[144:147], a[196:199], v[84:87]
  buffer_load_dwordx4 v219, s[56:59], s38 offen lds
  v_mfma_f32_16x16x32_bf16 v[88:91], v[144:147], a[200:203], v[88:91]
  ds_read_b64_tr_b16 v[166:167], v205 offset:27136
  v_mfma_f32_16x16x32_bf16 v[92:95], v[144:147], a[204:207], v[92:95]
  ds_read_b64 v[36:37], v241 offset:2832
  s_waitcnt lgkmcnt(11)
  v_mfma_f32_16x16x32_bf16 v[96:99], v[148:151], a[192:195], v[96:99]
  ds_read_b64_tr_b16 v[144:145], v206 offset:26624
  v_mfma_f32_16x16x32_bf16 v[100:103], v[148:151], a[196:199], v[100:103]
  buffer_load_dwordx4 v220, s[56:59], s38 offen offset:1024 lds
  v_mfma_f32_16x16x32_bf16 v[104:107], v[148:151], a[200:203], v[104:107]
  ds_read_b64_tr_b16 v[146:147], v206 offset:27136
  ds_read_b128 v[40:43], v241 offset:2256
  v_mfma_f32_16x16x32_bf16 v[108:111], v[148:151], a[204:207], v[108:111]
  ds_read_b128 v[44:47], v241 offset:2272
  ds_read_b64 v[48:49], v241 offset:2288
  s_waitcnt lgkmcnt(14)
  v_mfma_f32_16x16x32_bf16 v[112:115], v[152:155], a[192:195], v[112:115]
  ds_read_b64_tr_b16 v[148:149], v207 offset:26624
  v_dot2_f32_bf16 v60, v4, v16, 0
  v_dot2_f32_bf16 v61, v5, v16, 0
  v_dot2_f32_bf16 v62, v6, v16, 0
  v_dot2_f32_bf16 v63, v7, v16, 0
  v_dot2_f32_bf16 v64, v8, v16, 0
  v_dot2_f32_bf16 v65, v9, v16, 0
  v_dot2_f32_bf16 v66, v10, v16, 0
  v_dot2_f32_bf16 v67, v11, v16, 0
  v_dot2_f32_bf16 v68, v12, v16, 0
  v_dot2_f32_bf16 v69, v13, v16, 0
  v_dot2_f32_bf16 v70, v14, v16, 0
  v_dot2_f32_bf16 v71, v15, v16, 0
  v_dot2_f32_bf16 v72, v248, v16, 0
  v_dot2_f32_bf16 v73, v249, v16, 0
  v_dot2_f32_bf16 v74, v250, v16, 0
  v_dot2_f32_bf16 v75, v251, v16, 0
  v_dot2_f32_bf16 v76, v252, v16, 0
  v_dot2_f32_bf16 v77, v253, v16, 0
  v_dot2_f32_bf16 v78, v254, v16, 0
  v_dot2_f32_bf16 v79, v255, v16, 0
  v_mfma_f32_16x16x32_bf16 v[116:119], v[152:155], a[196:199], v[116:119]
  s_waitcnt lgkmcnt(3)
  v_perm_b32 v4, v40, v28, s41
  v_perm_b32 v5, v40, v28, s42
  v_mfma_f32_16x16x32_bf16 v[120:123], v[152:155], a[200:203], v[120:123]
  ds_read_b64_tr_b16 v[150:151], v207 offset:27136
  v_perm_b32 v6, v41, v29, s41
  v_mfma_f32_16x16x32_bf16 v[124:127], v[152:155], a[204:207], v[124:127]
  buffer_load_dwordx4 v221, s[56:59], s38 offen offset:2048 lds
  s_add_u32 m0, s25, 24576
  s_add_u32 s38, s5, 884736
  v_mfma_f32_16x16x32_bf16 v[128:131], v[156:159], a[192:195], v[128:131]
  ds_read_b64_tr_b16 v[152:153], v204 offset:28672
  v_perm_b32 v7, v41, v29, s42
  v_mfma_f32_16x16x32_bf16 v[132:135], v[156:159], a[196:199], v[132:135]
  v_perm_b32 v8, v42, v30, s41
  v_perm_b32 v9, v42, v30, s42
  v_mfma_f32_16x16x32_bf16 v[136:139], v[156:159], a[200:203], v[136:139]
  ds_read_b64_tr_b16 v[154:155], v204 offset:29184
  v_perm_b32 v10, v43, v31, s41
  v_mfma_f32_16x16x32_bf16 v[140:143], v[156:159], a[204:207], v[140:143]
  v_perm_b32 v11, v43, v31, s42
  s_waitcnt lgkmcnt(5)
  v_perm_b32 v12, v44, v32, s41
  v_mfma_f32_16x16x32_bf16 v[80:83], v[160:163], a[208:211], v[80:83]
  ds_read_b64_tr_b16 v[156:157], v205 offset:28672
  v_perm_b32 v13, v44, v32, s42
  v_mfma_f32_16x16x32_bf16 v[84:87], v[160:163], a[212:215], v[84:87]
  v_perm_b32 v14, v45, v33, s41
  v_perm_b32 v15, v45, v33, s42
  v_mfma_f32_16x16x32_bf16 v[88:91], v[160:163], a[216:219], v[88:91]
  ds_read_b64_tr_b16 v[158:159], v205 offset:29184
  v_perm_b32 v248, v46, v34, s41
  v_mfma_f32_16x16x32_bf16 v[92:95], v[160:163], a[220:223], v[92:95]
  v_perm_b32 v249, v46, v34, s42
  v_perm_b32 v250, v47, v35, s41
  v_mfma_f32_16x16x32_bf16 v[96:99], v[164:167], a[208:211], v[96:99]
  ds_read_b64_tr_b16 v[160:161], v206 offset:28672
  v_perm_b32 v251, v47, v35, s42
  v_mfma_f32_16x16x32_bf16 v[100:103], v[164:167], a[212:215], v[100:103]
  s_waitcnt lgkmcnt(7)
  v_perm_b32 v252, v48, v36, s41
  v_perm_b32 v253, v48, v36, s42
  v_mfma_f32_16x16x32_bf16 v[104:107], v[164:167], a[216:219], v[104:107]
  ds_read_b64_tr_b16 v[162:163], v206 offset:29184
  v_perm_b32 v254, v49, v37, s41
  v_mfma_f32_16x16x32_bf16 v[108:111], v[164:167], a[220:223], v[108:111]
  v_perm_b32 v255, v49, v37, s42
  ds_read_b128 v[28:31], v241 offset:1712
  v_mfma_f32_16x16x32_bf16 v[112:115], v[144:147], a[208:211], v[112:115]
  ds_read_b64_tr_b16 v[164:165], v207 offset:28672
  v_mfma_f32_16x16x32_bf16 v[116:119], v[144:147], a[212:215], v[116:119]
  ds_read_b128 v[32:35], v241 offset:1728
  v_mfma_f32_16x16x32_bf16 v[120:123], v[144:147], a[216:219], v[120:123]
  ds_read_b64_tr_b16 v[166:167], v207 offset:29184
  v_mfma_f32_16x16x32_bf16 v[124:127], v[144:147], a[220:223], v[124:127]
  ds_read_b64 v[36:37], v241 offset:1744
  s_waitcnt lgkmcnt(11)
  v_mfma_f32_16x16x32_bf16 v[128:131], v[148:151], a[208:211], v[128:131]
  ds_read_b128 v[40:43], v241 offset:1168
  v_mfma_f32_16x16x32_bf16 v[132:135], v[148:151], a[212:215], v[132:135]
  ds_read_b128 v[44:47], v241 offset:1184
  v_mfma_f32_16x16x32_bf16 v[136:139], v[148:151], a[216:219], v[136:139]
  ds_read_b64 v[48:49], v241 offset:1200
  v_mfma_f32_16x16x32_bf16 v[140:143], v[148:151], a[220:223], v[140:143]
  v_dot2_f32_bf16 v60, v4, v17, v60
  v_dot2_f32_bf16 v61, v5, v17, v61
  v_dot2_f32_bf16 v62, v6, v17, v62
  v_dot2_f32_bf16 v63, v7, v17, v63
  v_dot2_f32_bf16 v64, v8, v17, v64
  v_dot2_f32_bf16 v65, v9, v17, v65
  v_dot2_f32_bf16 v66, v10, v17, v66
  v_dot2_f32_bf16 v67, v11, v17, v67
  v_dot2_f32_bf16 v68, v12, v17, v68
  v_dot2_f32_bf16 v69, v13, v17, v69
  v_dot2_f32_bf16 v70, v14, v17, v70
  v_dot2_f32_bf16 v71, v15, v17, v71
  v_dot2_f32_bf16 v72, v248, v17, v72
  v_dot2_f32_bf16 v73, v249, v17, v73
  v_dot2_f32_bf16 v74, v250, v17, v74
  v_dot2_f32_bf16 v75, v251, v17, v75
  v_dot2_f32_bf16 v76, v252, v17, v76
  v_dot2_f32_bf16 v77, v253, v17, v77
  v_dot2_f32_bf16 v78, v254, v17, v78
  v_dot2_f32_bf16 v79, v255, v17, v79
  s_waitcnt lgkmcnt(4)
  s_waitcnt vmcnt(6)
  s_barrier
  v_mfma_f32_16x16x32_bf16 v[80:83], v[152:155], a[224:227], v[80:83]
  ds_read_b64_tr_b16 v[144:145], v204 offset:49152
  s_waitcnt lgkmcnt(3)
  v_perm_b32 v4, v40, v28, s41
  v_mfma_f32_16x16x32_bf16 v[84:87], v[152:155], a[228:231], v[84:87]
  buffer_load_dwordx4 v219, s[56:59], s38 offen lds
  v_mfma_f32_16x16x32_bf16 v[88:91], v[152:155], a[232:235], v[88:91]
  ds_read_b64_tr_b16 v[146:147], v204 offset:49664
  v_perm_b32 v5, v40, v28, s42
  v_mfma_f32_16x16x32_bf16 v[92:95], v[152:155], a[236:239], v[92:95]
  ds_read_b64_tr_b16 v[148:149], v205 offset:49152
  v_perm_b32 v6, v41, v29, s41
  v_mfma_f32_16x16x32_bf16 v[96:99], v[156:159], a[224:227], v[96:99]
  ds_read_b64_tr_b16 v[150:151], v205 offset:49664
  v_perm_b32 v7, v41, v29, s42
  v_mfma_f32_16x16x32_bf16 v[100:103], v[156:159], a[228:231], v[100:103]
  ds_read_b64_tr_b16 v[152:153], v206 offset:49152
  v_perm_b32 v8, v42, v30, s41
  v_mfma_f32_16x16x32_bf16 v[104:107], v[156:159], a[232:235], v[104:107]
  ds_read_b64_tr_b16 v[154:155], v206 offset:49664
  v_perm_b32 v9, v42, v30, s42
  v_mfma_f32_16x16x32_bf16 v[108:111], v[156:159], a[236:239], v[108:111]
  buffer_load_dwordx4 v220, s[56:59], s38 offen offset:1024 lds
  v_mfma_f32_16x16x32_bf16 v[112:115], v[160:163], a[224:227], v[112:115]
  ds_read_b64_tr_b16 v[156:157], v207 offset:49152
  v_perm_b32 v10, v43, v31, s41
  v_mfma_f32_16x16x32_bf16 v[116:119], v[160:163], a[228:231], v[116:119]
  v_perm_b32 v11, v43, v31, s42
  s_waitcnt lgkmcnt(8)
  v_perm_b32 v12, v44, v32, s41
  v_mfma_f32_16x16x32_bf16 v[120:123], v[160:163], a[232:235], v[120:123]
  ds_read_b64_tr_b16 v[158:159], v207 offset:49664
  v_perm_b32 v13, v44, v32, s42
  v_mfma_f32_16x16x32_bf16 v[124:127], v[160:163], a[236:239], v[124:127]
  buffer_load_dwordx4 v221, s[56:59], s38 offen offset:2048 lds
  s_add_u32 m0, s25, 27648
  s_add_u32 s38, s5, 1327104
  v_mfma_f32_16x16x32_bf16 v[128:131], v[164:167], a[224:227], v[128:131]
  ds_read_b64_tr_b16 v[160:161], v204 offset:51200
  v_perm_b32 v14, v45, v33, s41
  v_mfma_f32_16x16x32_bf16 v[132:135], v[164:167], a[228:231], v[132:135]
  v_perm_b32 v15, v45, v33, s42
  v_perm_b32 v248, v46, v34, s41
  v_mfma_f32_16x16x32_bf16 v[136:139], v[164:167], a[232:235], v[136:139]
  ds_read_b64_tr_b16 v[162:163], v204 offset:51712
  v_perm_b32 v249, v46, v34, s42
  v_mfma_f32_16x16x32_bf16 v[140:143], v[164:167], a[236:239], v[140:143]
  v_perm_b32 v250, v47, v35, s41
  v_perm_b32 v251, v47, v35, s42
  s_waitcnt lgkmcnt(8)
  v_mfma_f32_16x16x32_bf16 v[80:83], v[144:147], a[240:243], v[80:83]
  ds_read_b64_tr_b16 v[164:165], v205 offset:51200
  v_perm_b32 v252, v48, v36, s41
  v_mfma_f32_16x16x32_bf16 v[84:87], v[144:147], a[244:247], v[84:87]
  buffer_load_dwordx4 v219, s[56:59], s38 offen lds
  v_mfma_f32_16x16x32_bf16 v[88:91], v[144:147], a[248:251], v[88:91]
  ds_read_b64_tr_b16 v[166:167], v205 offset:51712
  v_perm_b32 v253, v48, v36, s42
  v_mfma_f32_16x16x32_bf16 v[92:95], v[144:147], a[252:255], v[92:95]
  v_perm_b32 v254, v49, v37, s41
  v_perm_b32 v255, v49, v37, s42
  s_waitcnt lgkmcnt(8)
  v_mfma_f32_16x16x32_bf16 v[96:99], v[148:151], a[240:243], v[96:99]
  ds_read_b64_tr_b16 v[144:145], v206 offset:51200
  v_mfma_f32_16x16x32_bf16 v[100:103], v[148:151], a[244:247], v[100:103]
  buffer_load_dwordx4 v220, s[56:59], s38 offen offset:1024 lds
  v_mfma_f32_16x16x32_bf16 v[104:107], v[148:151], a[248:251], v[104:107]
  ds_read_b64_tr_b16 v[146:147], v206 offset:51712
  v_mfma_f32_16x16x32_bf16 v[108:111], v[148:151], a[252:255], v[108:111]
  ds_read_b128 v[28:31], v241 offset:624
  s_waitcnt lgkmcnt(9)
  v_mfma_f32_16x16x32_bf16 v[112:115], v[152:155], a[240:243], v[112:115]
  ds_read_b64_tr_b16 v[148:149], v207 offset:51200
  v_mfma_f32_16x16x32_bf16 v[116:119], v[152:155], a[244:247], v[116:119]
  ds_read_b128 v[32:35], v241 offset:640
  v_mfma_f32_16x16x32_bf16 v[120:123], v[152:155], a[248:251], v[120:123]
  ds_read_b64_tr_b16 v[150:151], v207 offset:51712
  ds_read_b64 v[36:37], v241 offset:656
  v_mfma_f32_16x16x32_bf16 v[124:127], v[152:155], a[252:255], v[124:127]
  buffer_load_dwordx4 v221, s[56:59], s38 offen offset:2048 lds
  s_add_u32 m0, s25, 49152
  s_add_u32 s38, s5, 1769472
  s_waitcnt lgkmcnt(11)
  v_mfma_f32_16x16x32_bf16 v[128:131], v[156:159], a[240:243], v[128:131]
  ds_read_b64_tr_b16 v[152:153], v204 offset:53248
  ds_read_b128 v[40:43], v241 offset:80
  v_mfma_f32_16x16x32_bf16 v[132:135], v[156:159], a[244:247], v[132:135]
  ds_read_b128 v[44:47], v241 offset:96
  ds_read_b64 v[48:49], v241 offset:112
  v_mfma_f32_16x16x32_bf16 v[136:139], v[156:159], a[248:251], v[136:139]
  ds_read_b64_tr_b16 v[154:155], v204 offset:53760
  v_dot2_f32_bf16 v60, v4, v18, v60
  v_dot2_f32_bf16 v61, v5, v18, v61
  v_dot2_f32_bf16 v62, v6, v18, v62
  v_dot2_f32_bf16 v63, v7, v18, v63
  v_dot2_f32_bf16 v64, v8, v18, v64
  v_dot2_f32_bf16 v65, v9, v18, v65
  v_dot2_f32_bf16 v66, v10, v18, v66
  v_dot2_f32_bf16 v67, v11, v18, v67
  v_dot2_f32_bf16 v68, v12, v18, v68
  v_dot2_f32_bf16 v69, v13, v18, v69
  v_dot2_f32_bf16 v70, v14, v18, v70
  v_dot2_f32_bf16 v71, v15, v18, v71
  v_dot2_f32_bf16 v72, v248, v18, v72
  v_dot2_f32_bf16 v73, v249, v18, v73
  v_dot2_f32_bf16 v74, v250, v18, v74
  v_dot2_f32_bf16 v75, v251, v18, v75
  v_dot2_f32_bf16 v76, v252, v18, v76
  v_dot2_f32_bf16 v77, v253, v18, v77
  v_dot2_f32_bf16 v78, v254, v18, v78
  v_dot2_f32_bf16 v79, v255, v18, v79
  v_mfma_f32_16x16x32_bf16 v[140:143], v[156:159], a[252:255], v[140:143]
  s_waitcnt lgkmcnt(3)
  v_perm_b32 v4, v40, v28, s41
  v_perm_b32 v5, v40, v28, s42
  v_mfma_f32_16x16x32_bf16 v[80:83], v[160:163], v[168:171], v[80:83]
  ds_read_b64_tr_b16 v[156:157], v205 offset:53248
  v_perm_b32 v6, v41, v29, s41
  v_mfma_f32_16x16x32_bf16 v[84:87], v[160:163], v[172:175], v[84:87]
  v_perm_b32 v7, v41, v29, s42
  v_perm_b32 v8, v42, v30, s41
  v_mfma_f32_16x16x32_bf16 v[88:91], v[160:163], v[176:179], v[88:91]
  ds_read_b64_tr_b16 v[158:159], v205 offset:53760
  v_perm_b32 v9, v42, v30, s42
  v_mfma_f32_16x16x32_bf16 v[92:95], v[160:163], v[180:183], v[92:95]
  v_perm_b32 v10, v43, v31, s41
  v_perm_b32 v11, v43, v31, s42
  v_mfma_f32_16x16x32_bf16 v[96:99], v[164:167], v[168:171], v[96:99]
  ds_read_b64_tr_b16 v[160:161], v206 offset:53248
  s_waitcnt lgkmcnt(5)
  v_perm_b32 v12, v44, v32, s41
  v_mfma_f32_16x16x32_bf16 v[100:103], v[164:167], v[172:175], v[100:103]
  v_perm_b32 v13, v44, v32, s42
  v_perm_b32 v14, v45, v33, s41
  v_mfma_f32_16x16x32_bf16 v[104:107], v[164:167], v[176:179], v[104:107]
  ds_read_b64_tr_b16 v[162:163], v206 offset:53760
  v_perm_b32 v15, v45, v33, s42
  v_mfma_f32_16x16x32_bf16 v[108:111], v[164:167], v[180:183], v[108:111]
  v_perm_b32 v248, v46, v34, s41
  v_perm_b32 v249, v46, v34, s42
  v_mfma_f32_16x16x32_bf16 v[112:115], v[144:147], v[168:171], v[112:115]
  ds_read_b64_tr_b16 v[164:165], v207 offset:53248
  v_perm_b32 v250, v47, v35, s41
  v_mfma_f32_16x16x32_bf16 v[116:119], v[144:147], v[172:175], v[116:119]
  v_perm_b32 v251, v47, v35, s42
  s_waitcnt lgkmcnt(6)
  v_perm_b32 v252, v48, v36, s41
  v_mfma_f32_16x16x32_bf16 v[120:123], v[144:147], v[176:179], v[120:123]
  ds_read_b64_tr_b16 v[166:167], v207 offset:53760
  v_perm_b32 v253, v48, v36, s42
  v_mfma_f32_16x16x32_bf16 v[124:127], v[144:147], v[180:183], v[124:127]
  v_perm_b32 v254, v49, v37, s41
  v_perm_b32 v255, v49, v37, s42
  v_mfma_f32_16x16x32_bf16 v[128:131], v[148:151], v[168:171], v[128:131]
  v_mfma_f32_16x16x32_bf16 v[132:135], v[148:151], v[172:175], v[132:135]
  v_mfma_f32_16x16x32_bf16 v[136:139], v[148:151], v[176:179], v[136:139]
  v_dot2_f32_bf16 v60, v4, v19, v60
  v_dot2_f32_bf16 v61, v5, v19, v61
  v_dot2_f32_bf16 v62, v6, v19, v62
  v_dot2_f32_bf16 v63, v7, v19, v63
  v_dot2_f32_bf16 v64, v8, v19, v64
  v_dot2_f32_bf16 v65, v9, v19, v65
  v_dot2_f32_bf16 v66, v10, v19, v66
  v_dot2_f32_bf16 v67, v11, v19, v67
  v_dot2_f32_bf16 v68, v12, v19, v68
  v_dot2_f32_bf16 v69, v13, v19, v69
  v_dot2_f32_bf16 v70, v14, v19, v70
  v_dot2_f32_bf16 v71, v15, v19, v71
  v_dot2_f32_bf16 v72, v248, v19, v72
  v_dot2_f32_bf16 v73, v249, v19, v73
  v_dot2_f32_bf16 v74, v250, v19, v74
  v_dot2_f32_bf16 v75, v251, v19, v75
  v_dot2_f32_bf16 v76, v252, v19, v76
  v_dot2_f32_bf16 v77, v253, v19, v77
  v_dot2_f32_bf16 v78, v254, v19, v78
  v_dot2_f32_bf16 v79, v255, v19, v79
  v_mfma_f32_16x16x32_bf16 v[140:143], v[148:151], v[180:183], v[140:143]
  v_cvt_pk_bf16_f32 v28, v60, v61
  v_cvt_pk_bf16_f32 v29, v62, v63
  s_waitcnt lgkmcnt(0)
  s_waitcnt vmcnt(6)
  s_barrier
  v_mfma_f32_16x16x32_bf16 v[80:83], v[152:155], v[184:187], v[80:83]
  ds_read_b64_tr_b16 v[144:145], v204 offset:0
  v_cvt_pk_bf16_f32 v30, v64, v65
  v_mfma_f32_16x16x32_bf16 v[84:87], v[152:155], v[188:191], v[84:87]
  buffer_load_dwordx4 v219, s[56:59], s38 offen lds
  v_mfma_f32_16x16x32_bf16 v[88:91], v[152:155], v[192:195], v[88:91]
  ds_read_b64_tr_b16 v[146:147], v204 offset:512
  v_cvt_pk_bf16_f32 v31, v66, v67
  v_mfma_f32_16x16x32_bf16 v[92:95], v[152:155], v[196:199], v[92:95]
  ds_read_b64_tr_b16 v[148:149], v205 offset:0
  v_cvt_pk_bf16_f32 v32, v68, v69
  v_mfma_f32_16x16x32_bf16 v[96:99], v[156:159], v[184:187], v[96:99]
  ds_read_b64_tr_b16 v[150:151], v205 offset:512
  v_cvt_pk_bf16_f32 v33, v70, v71
  v_mfma_f32_16x16x32_bf16 v[100:103], v[156:159], v[188:191], v[100:103]
  ds_read_b64_tr_b16 v[152:153], v206 offset:0
  v_cvt_pk_bf16_f32 v34, v72, v73
  v_mfma_f32_16x16x32_bf16 v[104:107], v[156:159], v[192:195], v[104:107]
  ds_read_b64_tr_b16 v[154:155], v206 offset:512
  v_cvt_pk_bf16_f32 v35, v74, v75
  v_mfma_f32_16x16x32_bf16 v[108:111], v[156:159], v[196:199], v[108:111]
  buffer_load_dwordx4 v220, s[56:59], s38 offen offset:1024 lds
  v_mfma_f32_16x16x32_bf16 v[112:115], v[160:163], v[184:187], v[112:115]
  ds_read_b64_tr_b16 v[156:157], v207 offset:0
  v_cvt_pk_bf16_f32 v36, v76, v77
  v_mfma_f32_16x16x32_bf16 v[116:119], v[160:163], v[188:191], v[116:119]
  v_cvt_pk_bf16_f32 v37, v78, v79
  v_mfma_f32_16x16x32_bf16 v[120:123], v[160:163], v[192:195], v[120:123]
  ds_read_b64_tr_b16 v[158:159], v207 offset:512
  v_mfma_f32_16x16x32_bf16 v[124:127], v[160:163], v[196:199], v[124:127]
  buffer_load_dwordx4 v221, s[56:59], s38 offen offset:2048 lds
  s_add_u32 m0, s25, 52224
  s_add_u32 s38, s5, 2211840
  v_mfma_f32_16x16x32_bf16 v[128:131], v[164:167], v[184:187], v[128:131]
  ds_read_b64_tr_b16 v[160:161], v204 offset:2048
  v_mfma_f32_16x16x32_bf16 v[132:135], v[164:167], v[188:191], v[132:135]
  ds_write2_b32 v242, v29, v30 offset0:1 offset1:2
  v_mfma_f32_16x16x32_bf16 v[136:139], v[164:167], v[192:195], v[136:139]
  ds_read_b64_tr_b16 v[162:163], v204 offset:2560
  v_mfma_f32_16x16x32_bf16 v[140:143], v[164:167], v[196:199], v[140:143]
  ds_write2_b32 v242, v31, v32 offset0:3 offset1:4
  ds_write2_b32 v242, v33, v34 offset0:5 offset1:6
  ds_write2_b32 v242, v35, v36 offset0:7 offset1:8
  v_add_u32 v4, 36, v242
  v_cmp_gt_u32 vcc, 32, v1
  s_nop 1
  s_nop 0
  v_cndmask_b32 v28, v37, v28, vcc
  v_cndmask_b32 v4, v4, v242, vcc
  ds_write_b32 v4, v28
  s_waitcnt lgkmcnt(13)
  v_mfma_f32_16x16x32_bf16 v[16:19], v[144:147], a[0:3], 0
  ds_read_b64_tr_b16 v[164:165], v205 offset:2048
  v_mfma_f32_16x16x32_bf16 v[20:23], v[144:147], a[4:7], 0
  buffer_load_dwordx4 v219, s[56:59], s38 offen lds
  v_mfma_f32_16x16x32_bf16 v[24:27], v[144:147], a[8:11], 0
  ds_read_b64_tr_b16 v[166:167], v205 offset:2560
  v_mfma_f32_16x16x32_bf16 v[28:31], v[144:147], a[12:15], 0
  s_waitcnt lgkmcnt(13)
  v_mfma_f32_16x16x32_bf16 v[32:35], v[148:151], a[0:3], 0
  ds_read_b64_tr_b16 v[144:145], v206 offset:2048
  v_mfma_f32_16x16x32_bf16 v[36:39], v[148:151], a[4:7], 0
  buffer_load_dwordx4 v220, s[56:59], s38 offen offset:1024 lds
  v_mfma_f32_16x16x32_bf16 v[40:43], v[148:151], a[8:11], 0
  ds_read_b64_tr_b16 v[146:147], v206 offset:2560
  v_mfma_f32_16x16x32_bf16 v[44:47], v[148:151], a[12:15], 0
  s_waitcnt lgkmcnt(13)
  v_mfma_f32_16x16x32_bf16 v[48:51], v[152:155], a[0:3], 0
  ds_read_b64_tr_b16 v[148:149], v207 offset:2048
  v_mfma_f32_16x16x32_bf16 v[52:55], v[152:155], a[4:7], 0
  v_mfma_f32_16x16x32_bf16 v[56:59], v[152:155], a[8:11], 0
  ds_read_b64_tr_b16 v[150:151], v207 offset:2560
  v_mul_f32 v112, v80, v112
  v_mfma_f32_16x16x32_bf16 v[60:63], v[152:155], a[12:15], 0
  buffer_load_dwordx4 v221, s[56:59], s38 offen offset:2048 lds
  s_add_u32 m0, s25, 0
  s_add_u32 s38, s5, 2654208
  s_waitcnt lgkmcnt(13)
  v_mfma_f32_16x16x32_bf16 v[64:67], v[156:159], a[0:3], 0
  ds_read_b64_tr_b16 v[152:153], v204 offset:4096
  v_mul_f32 v113, v81, v113
  v_mfma_f32_16x16x32_bf16 v[68:71], v[156:159], a[4:7], 0
  v_mul_f32 v114, v82, v114
  v_mul_f32 v116, v84, v116
  v_mfma_f32_16x16x32_bf16 v[72:75], v[156:159], a[8:11], 0
  ds_read_b64_tr_b16 v[154:155], v204 offset:4608
  v_mul_f32 v115, v83, v115
  v_mfma_f32_16x16x32_bf16 v[76:79], v[156:159], a[12:15], 0
  v_mul_f32 v80, s39, v80
  v_mul_f32 v117, v85, v117
  s_waitcnt lgkmcnt(12)
  v_mfma_f32_16x16x32_bf16 v[16:19], v[160:163], a[16:19], v[16:19]
  ds_read_b64_tr_b16 v[156:157], v205 offset:4096
  v_mul_f32 v81, s39, v81
  v_mfma_f32_16x16x32_bf16 v[20:23], v[160:163], a[20:23], v[20:23]
  v_mul_f32 v82, s39, v82
  v_mul_f32 v118, v86, v118
  v_mfma_f32_16x16x32_bf16 v[24:27], v[160:163], a[24:27], v[24:27]
  ds_read_b64_tr_b16 v[158:159], v205 offset:4608
  v_mul_f32 v83, s39, v83
  v_mfma_f32_16x16x32_bf16 v[28:31], v[160:163], a[28:31], v[28:31]
  v_mul_f32 v119, v87, v119
  v_mul_f32 v84, s39, v84
  s_waitcnt lgkmcnt(8)
  v_mfma_f32_16x16x32_bf16 v[32:35], v[164:167], a[16:19], v[32:35]
  ds_read_b64_tr_b16 v[160:161], v206 offset:4096
  v_mul_f32 v85, s39, v85
  v_mfma_f32_16x16x32_bf16 v[36:39], v[164:167], a[20:23], v[36:39]
  v_exp_f32 v80, -v80
  v_mfma_f32_16x16x32_bf16 v[40:43], v[164:167], a[24:27], v[40:43]
  ds_read_b64_tr_b16 v[162:163], v206 offset:4608
  v_mul_f32 v86, s39, v86
  v_mfma_f32_16x16x32_bf16 v[44:47], v[164:167], a[28:31], v[44:47]
  v_exp_f32 v81, -v81
  s_waitcnt lgkmcnt(8)
  v_mfma_f32_16x16x32_bf16 v[48:51], v[144:147], a[16:19], v[48:51]
  ds_read_b64_tr_b16 v[164:165], v207 offset:4096
  v_mul_f32 v87, s39, v87
  v_mfma_f32_16x16x32_bf16 v[52:55], v[144:147], a[20:23], v[52:55]
  v_exp_f32 v82, -v82
  v_mfma_f32_16x16x32_bf16 v[56:59], v[144:147], a[24:27], v[56:59]
  ds_read_b64_tr_b16 v[166:167], v207 offset:4608
  v_mfma_f32_16x16x32_bf16 v[60:63], v[144:147], a[28:31], v[60:63]
  v_exp_f32 v84, -v84
  s_waitcnt lgkmcnt(8)
  v_mfma_f32_16x16x32_bf16 v[64:67], v[148:151], a[16:19], v[64:67]
  v_exp_f32 v83, -v83
  v_mfma_f32_16x16x32_bf16 v[68:71], v[148:151], a[20:23], v[68:71]
  v_exp_f32 v85, -v85
  v_mfma_f32_16x16x32_bf16 v[72:75], v[148:151], a[24:27], v[72:75]
  v_add_f32 v80, 1.0, v80
  v_mfma_f32_16x16x32_bf16 v[76:79], v[148:151], a[28:31], v[76:79]
  v_exp_f32 v86, -v86
  s_waitcnt lgkmcnt(0)
  s_waitcnt vmcnt(6)
  s_barrier
  v_mfma_f32_16x16x32_bf16 v[16:19], v[152:155], a[32:35], v[16:19]
  ds_read_b64_tr_b16 v[144:145], v204 offset:24576
  v_mfma_f32_16x16x32_bf16 v[20:23], v[152:155], a[36:39], v[20:23]
  buffer_load_dwordx4 v219, s[56:59], s38 offen lds
  v_mfma_f32_16x16x32_bf16 v[24:27], v[152:155], a[40:43], v[24:27]
  ds_read_b64_tr_b16 v[146:147], v204 offset:25088
  v_add_f32 v81, 1.0, v81
  v_mfma_f32_16x16x32_bf16 v[28:31], v[152:155], a[44:47], v[28:31]
  ds_read_b64_tr_b16 v[148:149], v205 offset:24576
  v_add_f32 v82, 1.0, v82
  v_mfma_f32_16x16x32_bf16 v[32:35], v[156:159], a[32:35], v[32:35]
  ds_read_b64_tr_b16 v[150:151], v205 offset:25088
  v_mfma_f32_16x16x32_bf16 v[36:39], v[156:159], a[36:39], v[36:39]
  ds_read_b64_tr_b16 v[152:153], v206 offset:24576
  v_mfma_f32_16x16x32_bf16 v[40:43], v[156:159], a[40:43], v[40:43]
  ds_read_b64_tr_b16 v[154:155], v206 offset:25088
  v_add_f32 v83, 1.0, v83
  v_mfma_f32_16x16x32_bf16 v[44:47], v[156:159], a[44:47], v[44:47]
  buffer_load_dwordx4 v220, s[56:59], s38 offen offset:1024 lds
  v_mfma_f32_16x16x32_bf16 v[48:51], v[160:163], a[32:35], v[48:51]
  ds_read_b64_tr_b16 v[156:157], v207 offset:24576
  v_mfma_f32_16x16x32_bf16 v[52:55], v[160:163], a[36:39], v[52:55]
  v_rcp_f32 v80, v80
  v_mfma_f32_16x16x32_bf16 v[56:59], v[160:163], a[40:43], v[56:59]
  ds_read_b64_tr_b16 v[158:159], v207 offset:25088
  v_mfma_f32_16x16x32_bf16 v[60:63], v[160:163], a[44:47], v[60:63]
  buffer_load_dwordx4 v221, s[56:59], s38 offen offset:2048 lds
  s_add_u32 m0, s25, 3072
  s_add_u32 s38, s5, 3096576
  v_mfma_f32_16x16x32_bf16 v[64:67], v[164:167], a[32:35], v[64:67]
  ds_read_b64_tr_b16 v[160:161], v204 offset:26624
  v_mfma_f32_16x16x32_bf16 v[68:71], v[164:167], a[36:39], v[68:71]
  v_rcp_f32 v81, v81
  v_mfma_f32_16x16x32_bf16 v[72:75], v[164:167], a[40:43], v[72:75]
  ds_read_b64_tr_b16 v[162:163], v204 offset:27136
  v_mfma_f32_16x16x32_bf16 v[76:79], v[164:167], a[44:47], v[76:79]
  v_rcp_f32 v82, v82
  s_waitcnt lgkmcnt(8)
  v_mfma_f32_16x16x32_bf16 v[16:19], v[144:147], a[48:51], v[16:19]
  ds_read_b64_tr_b16 v[164:165], v205 offset:26624
  v_mfma_f32_16x16x32_bf16 v[20:23], v[144:147], a[52:55], v[20:23]
  buffer_load_dwordx4 v219, s[56:59], s38 offen lds
  v_mfma_f32_16x16x32_bf16 v[24:27], v[144:147], a[56:59], v[24:27]
  ds_read_b64_tr_b16 v[166:167], v205 offset:27136
  v_mfma_f32_16x16x32_bf16 v[28:31], v[144:147], a[60:63], v[28:31]
  v_rcp_f32 v83, v83
  s_waitcnt lgkmcnt(8)
  v_mfma_f32_16x16x32_bf16 v[32:35], v[148:151], a[48:51], v[32:35]
  ds_read_b64_tr_b16 v[144:145], v206 offset:26624
  v_mul_f32 v112, v80, v112
  v_mfma_f32_16x16x32_bf16 v[36:39], v[148:151], a[52:55], v[36:39]
  buffer_load_dwordx4 v220, s[56:59], s38 offen offset:1024 lds
  v_mfma_f32_16x16x32_bf16 v[40:43], v[148:151], a[56:59], v[40:43]
  ds_read_b64_tr_b16 v[146:147], v206 offset:27136
  v_mul_f32 v113, v81, v113
  v_mfma_f32_16x16x32_bf16 v[44:47], v[148:151], a[60:63], v[44:47]
  v_exp_f32 v87, -v87
  s_waitcnt lgkmcnt(8)
  v_mfma_f32_16x16x32_bf16 v[48:51], v[152:155], a[48:51], v[48:51]
  ds_read_b64_tr_b16 v[148:149], v207 offset:26624
  v_mul_f32 v114, v82, v114
  v_mfma_f32_16x16x32_bf16 v[52:55], v[152:155], a[52:55], v[52:55]
  v_add_f32 v84, 1.0, v84
  v_add_f32 v85, 1.0, v85
  v_mfma_f32_16x16x32_bf16 v[56:59], v[152:155], a[56:59], v[56:59]
  ds_read_b64_tr_b16 v[150:151], v207 offset:27136
  v_mul_f32 v115, v83, v115
  v_mfma_f32_16x16x32_bf16 v[60:63], v[152:155], a[60:63], v[60:63]
  buffer_load_dwordx4 v221, s[56:59], s38 offen offset:2048 lds
  s_add_u32 m0, s25, 24576
  s_add_u32 s38, s5, 3538944
  s_waitcnt lgkmcnt(8)
  v_mfma_f32_16x16x32_bf16 v[64:67], v[156:159], a[48:51], v[64:67]
  ds_read_b64_tr_b16 v[152:153], v204 offset:28672
  v_add_f32 v86, 1.0, v86
  v_mfma_f32_16x16x32_bf16 v[68:71], v[156:159], a[52:55], v[68:71]
  v_cvt_pk_bf16_f32 v80, v112, v113
  v_add_f32 v87, 1.0, v87
  v_mfma_f32_16x16x32_bf16 v[72:75], v[156:159], a[56:59], v[72:75]
  ds_read_b64_tr_b16 v[154:155], v204 offset:29184
  v_mfma_f32_16x16x32_bf16 v[76:79], v[156:159], a[60:63], v[76:79]
  v_rcp_f32 v84, v84
  s_waitcnt lgkmcnt(8)
  v_mfma_f32_16x16x32_bf16 v[16:19], v[160:163], a[64:67], v[16:19]
  ds_read_b64_tr_b16 v[156:157], v205 offset:28672
  v_cvt_pk_bf16_f32 v81, v114, v115
  v_mfma_f32_16x16x32_bf16 v[20:23], v[160:163], a[68:71], v[20:23]
  v_rcp_f32 v85, v85
  v_mfma_f32_16x16x32_bf16 v[24:27], v[160:163], a[72:75], v[24:27]
  ds_read_b64_tr_b16 v[158:159], v205 offset:29184
  v_mfma_f32_16x16x32_bf16 v[28:31], v[160:163], a[76:79], v[28:31]
  ds_write_b64 v231, v[80:81] offset:0
  s_waitcnt lgkmcnt(9)
  v_mfma_f32_16x16x32_bf16 v[32:35], v[164:167], a[64:67], v[32:35]
  ds_read_b64_tr_b16 v[160:161], v206 offset:28672
  v_mfma_f32_16x16x32_bf16 v[36:39], v[164:167], a[68:71], v[36:39]
  v_mul_f32 v120, v88, v120
  v_rcp_f32 v86, v86
  v_mfma_f32_16x16x32_bf16 v[40:43], v[164:167], a[72:75], v[40:43]
  ds_read_b64_tr_b16 v[162:163], v206 offset:29184
  v_mfma_f32_16x16x32_bf16 v[44:47], v[164:167], a[76:79], v[44:47]
  v_mul_f32 v121, v89, v121
  v_rcp_f32 v87, v87
  s_waitcnt lgkmcnt(9)
  v_mfma_f32_16x16x32_bf16 v[48:51], v[144:147], a[64:67], v[48:51]
  ds_read_b64_tr_b16 v[164:165], v207 offset:28672
  v_mul_f32 v116, v84, v116
  v_mfma_f32_16x16x32_bf16 v[52:55], v[144:147], a[68:71], v[52:55]
  v_mul_f32 v117, v85, v117
  v_mul_f32 v118, v86, v118
  v_mfma_f32_16x16x32_bf16 v[56:59], v[144:147], a[72:75], v[56:59]
  ds_read_b64_tr_b16 v[166:167], v207 offset:29184
  v_mul_f32 v122, v90, v122
  v_mfma_f32_16x16x32_bf16 v[60:63], v[144:147], a[76:79], v[60:63]
  v_mul_f32 v119, v87, v119
  v_cvt_pk_bf16_f32 v84, v116, v117
  s_waitcnt lgkmcnt(9)
  v_mfma_f32_16x16x32_bf16 v[64:67], v[148:151], a[64:67], v[64:67]
  v_mul_f32 v123, v91, v123
  v_cvt_pk_bf16_f32 v85, v118, v119
  v_mfma_f32_16x16x32_bf16 v[68:71], v[148:151], a[68:71], v[68:71]
  ds_write_b64 v231, v[84:85] offset:2048
  v_mfma_f32_16x16x32_bf16 v[72:75], v[148:151], a[72:75], v[72:75]
  v_mul_f32 v124, v92, v124
  v_mul_f32 v125, v93, v125
  v_mfma_f32_16x16x32_bf16 v[76:79], v[148:151], a[76:79], v[76:79]
  v_mul_f32 v88, s39, v88
  v_mul_f32 v126, v94, v126
  s_waitcnt lgkmcnt(0)
  s_waitcnt vmcnt(6)
  s_barrier
  v_mfma_f32_16x16x32_bf16 v[16:19], v[152:155], a[80:83], v[16:19]
  ds_read_b64_tr_b16 v[144:145], v204 offset:49152
  v_mul_f32 v127, v95, v127
  v_mfma_f32_16x16x32_bf16 v[20:23], v[152:155], a[84:87], v[20:23]
  buffer_load_dwordx4 v219, s[56:59], s38 offen lds
  v_mfma_f32_16x16x32_bf16 v[24:27], v[152:155], a[88:91], v[24:27]
  ds_read_b64_tr_b16 v[146:147], v204 offset:49664
  v_mul_f32 v89, s39, v89
  v_mfma_f32_16x16x32_bf16 v[28:31], v[152:155], a[92:95], v[28:31]
  ds_read_b64_tr_b16 v[148:149], v205 offset:49152
  v_mul_f32 v92, s39, v92
  v_mfma_f32_16x16x32_bf16 v[32:35], v[156:159], a[80:83], v[32:35]
  ds_read_b64_tr_b16 v[150:151], v205 offset:49664
  v_mul_f32 v90, s39, v90
  v_mfma_f32_16x16x32_bf16 v[36:39], v[156:159], a[84:87], v[36:39]
  ds_read_b64_tr_b16 v[152:153], v206 offset:49152
  v_mul_f32 v93, s39, v93
  v_mfma_f32_16x16x32_bf16 v[40:43], v[156:159], a[88:91], v[40:43]
  ds_read_b64_tr_b16 v[154:155], v206 offset:49664
  v_mul_f32 v94, s39, v94
  v_mfma_f32_16x16x32_bf16 v[44:47], v[156:159], a[92:95], v[44:47]
  buffer_load_dwordx4 v220, s[56:59], s38 offen offset:1024 lds
  v_mfma_f32_16x16x32_bf16 v[48:51], v[160:163], a[80:83], v[48:51]
  ds_read_b64_tr_b16 v[156:157], v207 offset:49152
  v_mul_f32 v91, s39, v91
  v_mfma_f32_16x16x32_bf16 v[52:55], v[160:163], a[84:87], v[52:55]
  v_exp_f32 v88, -v88
  v_mfma_f32_16x16x32_bf16 v[56:59], v[160:163], a[88:91], v[56:59]
  ds_read_b64_tr_b16 v[158:159], v207 offset:49664
  v_mul_f32 v95, s39, v95
  v_mfma_f32_16x16x32_bf16 v[60:63], v[160:163], a[92:95], v[60:63]
  buffer_load_dwordx4 v221, s[56:59], s38 offen offset:2048 lds
  s_add_u32 m0, s25, 27648
  s_add_u32 s38, s5, 3981312
  v_mfma_f32_16x16x32_bf16 v[64:67], v[164:167], a[80:83], v[64:67]
  ds_read_b64_tr_b16 v[160:161], v204 offset:51200
  v_mfma_f32_16x16x32_bf16 v[68:71], v[164:167], a[84:87], v[68:71]
  v_exp_f32 v89, -v89
  v_mfma_f32_16x16x32_bf16 v[72:75], v[164:167], a[88:91], v[72:75]
  ds_read_b64_tr_b16 v[162:163], v204 offset:51712
  v_mfma_f32_16x16x32_bf16 v[76:79], v[164:167], a[92:95], v[76:79]
  v_exp_f32 v90, -v90
  s_waitcnt lgkmcnt(8)
  v_mfma_f32_16x16x32_bf16 v[16:19], v[144:147], a[96:99], v[16:19]
  ds_read_b64_tr_b16 v[164:165], v205 offset:51200
  v_mfma_f32_16x16x32_bf16 v[20:23], v[144:147], a[100:103], v[20:23]
  buffer_load_dwordx4 v219, s[56:59], s38 offen lds
  v_mfma_f32_16x16x32_bf16 v[24:27], v[144:147], a[104:107], v[24:27]
  ds_read_b64_tr_b16 v[166:167], v205 offset:51712
  v_mfma_f32_16x16x32_bf16 v[28:31], v[144:147], a[108:111], v[28:31]
  v_exp_f32 v91, -v91
  s_waitcnt lgkmcnt(8)
  v_mfma_f32_16x16x32_bf16 v[32:35], v[148:151], a[96:99], v[32:35]
  ds_read_b64_tr_b16 v[144:145], v206 offset:51200
  v_add_f32 v88, 1.0, v88
  v_mfma_f32_16x16x32_bf16 v[36:39], v[148:151], a[100:103], v[36:39]
  buffer_load_dwordx4 v220, s[56:59], s38 offen offset:1024 lds
  v_mfma_f32_16x16x32_bf16 v[40:43], v[148:151], a[104:107], v[40:43]
  ds_read_b64_tr_b16 v[146:147], v206 offset:51712
  v_add_f32 v89, 1.0, v89
  v_mfma_f32_16x16x32_bf16 v[44:47], v[148:151], a[108:111], v[44:47]
  v_exp_f32 v92, -v92
  s_waitcnt lgkmcnt(8)
  v_mfma_f32_16x16x32_bf16 v[48:51], v[152:155], a[96:99], v[48:51]
  ds_read_b64_tr_b16 v[148:149], v207 offset:51200
  v_mfma_f32_16x16x32_bf16 v[52:55], v[152:155], a[100:103], v[52:55]
  v_add_f32 v90, 1.0, v90
  v_mfma_f32_16x16x32_bf16 v[56:59], v[152:155], a[104:107], v[56:59]
  ds_read_b64_tr_b16 v[150:151], v207 offset:51712
  v_mfma_f32_16x16x32_bf16 v[60:63], v[152:155], a[108:111], v[60:63]
  buffer_load_dwordx4 v221, s[56:59], s38 offen offset:2048 lds
  s_add_u32 m0, s25, 49152
  s_add_u32 s38, s5, 4423680
  s_waitcnt lgkmcnt(8)
  v_mfma_f32_16x16x32_bf16 v[64:67], v[156:159], a[96:99], v[64:67]
  ds_read_b64_tr_b16 v[152:153], v204 offset:53248
  v_add_f32 v91, 1.0, v91
  v_mfma_f32_16x16x32_bf16 v[68:71], v[156:159], a[100:103], v[68:71]
  v_exp_f32 v93, -v93
  v_mfma_f32_16x16x32_bf16 v[72:75], v[156:159], a[104:107], v[72:75]
  ds_read_b64_tr_b16 v[154:155], v204 offset:53760
  v_mfma_f32_16x16x32_bf16 v[76:79], v[156:159], a[108:111], v[76:79]
  v_rcp_f32 v88, v88
  s_waitcnt lgkmcnt(8)
  v_mfma_f32_16x16x32_bf16 v[16:19], v[160:163], a[112:115], v[16:19]
  ds_read_b64_tr_b16 v[156:157], v205 offset:53248
  v_mfma_f32_16x16x32_bf16 v[20:23], v[160:163], a[116:119], v[20:23]
  v_rcp_f32 v89, v89
  v_mfma_f32_16x16x32_bf16 v[24:27], v[160:163], a[120:123], v[24:27]
  ds_read_b64_tr_b16 v[158:159], v205 offset:53760
  v_mfma_f32_16x16x32_bf16 v[28:31], v[160:163], a[124:127], v[28:31]
  v_rcp_f32 v90, v90
  s_waitcnt lgkmcnt(8)
  v_mfma_f32_16x16x32_bf16 v[32:35], v[164:167], a[112:115], v[32:35]
  ds_read_b64_tr_b16 v[160:161], v206 offset:53248
  v_mfma_f32_16x16x32_bf16 v[36:39], v[164:167], a[116:119], v[36:39]
  v_exp_f32 v94, -v94
  v_mfma_f32_16x16x32_bf16 v[40:43], v[164:167], a[120:123], v[40:43]
  ds_read_b64_tr_b16 v[162:163], v206 offset:53760
  v_mfma_f32_16x16x32_bf16 v[44:47], v[164:167], a[124:127], v[44:47]
  v_rcp_f32 v91, v91
  s_waitcnt lgkmcnt(8)
  v_mfma_f32_16x16x32_bf16 v[48:51], v[144:147], a[112:115], v[48:51]
  ds_read_b64_tr_b16 v[164:165], v207 offset:53248
  v_mul_f32 v120, v88, v120
  v_mfma_f32_16x16x32_bf16 v[52:55], v[144:147], a[116:119], v[52:55]
  v_exp_f32 v95, -v95
  v_mfma_f32_16x16x32_bf16 v[56:59], v[144:147], a[120:123], v[56:59]
  ds_read_b64_tr_b16 v[166:167], v207 offset:53760
  v_add_f32 v92, 1.0, v92
  v_mfma_f32_16x16x32_bf16 v[60:63], v[144:147], a[124:127], v[60:63]
  v_mul_f32 v121, v89, v121
  v_add_f32 v93, 1.0, v93
  s_waitcnt lgkmcnt(8)
  v_mfma_f32_16x16x32_bf16 v[64:67], v[148:151], a[112:115], v[64:67]
  v_add_f32 v94, 1.0, v94
  v_add_f32 v95, 1.0, v95
  v_mfma_f32_16x16x32_bf16 v[68:71], v[148:151], a[116:119], v[68:71]
  v_mul_f32 v122, v90, v122
  v_mfma_f32_16x16x32_bf16 v[72:75], v[148:151], a[120:123], v[72:75]
  v_rcp_f32 v92, v92
  v_mfma_f32_16x16x32_bf16 v[76:79], v[148:151], a[124:127], v[76:79]
  v_rcp_f32 v93, v93
  s_waitcnt lgkmcnt(0)
  s_waitcnt vmcnt(6)
  s_barrier
  v_mfma_f32_16x16x32_bf16 v[16:19], v[152:155], a[128:131], v[16:19]
  ds_read_b64_tr_b16 v[144:145], v204 offset:0
  v_mul_f32 v123, v91, v123
  v_mfma_f32_16x16x32_bf16 v[20:23], v[152:155], a[132:135], v[20:23]
  buffer_load_dwordx4 v219, s[56:59], s38 offen lds
  v_mfma_f32_16x16x32_bf16 v[24:27], v[152:155], a[136:139], v[24:27]
  ds_read_b64_tr_b16 v[146:147], v204 offset:512
  v_cvt_pk_bf16_f32 v88, v120, v121
  v_mfma_f32_16x16x32_bf16 v[28:31], v[152:155], a[140:143], v[28:31]
  ds_read_b64_tr_b16 v[148:149], v205 offset:0
  v_mfma_f32_16x16x32_bf16 v[32:35], v[156:159], a[128:131], v[32:35]
  ds_read_b64_tr_b16 v[150:151], v205 offset:512
  v_mfma_f32_16x16x32_bf16 v[36:39], v[156:159], a[132:135], v[36:39]
  ds_read_b64_tr_b16 v[152:153], v206 offset:0
  v_cvt_pk_bf16_f32 v89, v122, v123
  v_mfma_f32_16x16x32_bf16 v[40:43], v[156:159], a[136:139], v[40:43]
  ds_read_b64_tr_b16 v[154:155], v206 offset:512
  v_mfma_f32_16x16x32_bf16 v[44:47], v[156:159], a[140:143], v[44:47]
  buffer_load_dwordx4 v220, s[56:59], s38 offen offset:1024 lds
  v_mfma_f32_16x16x32_bf16 v[48:51], v[160:163], a[128:131], v[48:51]
  ds_read_b64_tr_b16 v[156:157], v207 offset:0
  v_mfma_f32_16x16x32_bf16 v[52:55], v[160:163], a[132:135], v[52:55]
  ds_write_b64 v231, v[88:89] offset:4096
  v_mfma_f32_16x16x32_bf16 v[56:59], v[160:163], a[136:139], v[56:59]
  ds_read_b64_tr_b16 v[158:159], v207 offset:512
  v_mul_f32 v128, v96, v128
  v_mfma_f32_16x16x32_bf16 v[60:63], v[160:163], a[140:143], v[60:63]
  buffer_load_dwordx4 v221, s[56:59], s38 offen offset:2048 lds
  s_add_u32 m0, s25, 52224
  s_add_u32 s38, s5, 4866048
  v_mfma_f32_16x16x32_bf16 v[64:67], v[164:167], a[128:131], v[64:67]
  ds_read_b64_tr_b16 v[160:161], v204 offset:2048
  v_rcp_f32 v94, v94
  v_mfma_f32_16x16x32_bf16 v[68:71], v[164:167], a[132:135], v[68:71]
  v_mul_f32 v129, v97, v129
  v_rcp_f32 v95, v95
  v_mfma_f32_16x16x32_bf16 v[72:75], v[164:167], a[136:139], v[72:75]
  ds_read_b64_tr_b16 v[162:163], v204 offset:2560
  v_mul_f32 v124, v92, v124
  v_mfma_f32_16x16x32_bf16 v[76:79], v[164:167], a[140:143], v[76:79]
  v_mul_f32 v130, v98, v130
  v_mul_f32 v125, v93, v125
  s_waitcnt lgkmcnt(9)
  v_mfma_f32_16x16x32_bf16 v[16:19], v[144:147], a[144:147], v[16:19]
  ds_read_b64_tr_b16 v[164:165], v205 offset:2048
  v_mul_f32 v126, v94, v126
  v_mfma_f32_16x16x32_bf16 v[20:23], v[144:147], a[148:151], v[20:23]
  buffer_load_dwordx4 v219, s[56:59], s38 offen lds
  v_mfma_f32_16x16x32_bf16 v[24:27], v[144:147], a[152:155], v[24:27]
  ds_read_b64_tr_b16 v[166:167], v205 offset:2560
  v_mul_f32 v131, v99, v131
  v_mfma_f32_16x16x32_bf16 v[28:31], v[144:147], a[156:159], v[28:31]
  v_mul_f32 v127, v95, v127
  v_cvt_pk_bf16_f32 v92, v124, v125
  s_waitcnt lgkmcnt(9)
  v_mfma_f32_16x16x32_bf16 v[32:35], v[148:151], a[144:147], v[32:35]
  ds_read_b64_tr_b16 v[144:145], v206 offset:2048
  v_cvt_pk_bf16_f32 v93, v126, v127
  v_mfma_f32_16x16x32_bf16 v[36:39], v[148:151], a[148:151], v[36:39]
  buffer_load_dwordx4 v220, s[56:59], s38 offen offset:1024 lds
  v_mfma_f32_16x16x32_bf16 v[40:43], v[148:151], a[152:155], v[40:43]
  ds_read_b64_tr_b16 v[146:147], v206 offset:2560
  v_mul_f32 v96, s39, v96
  v_mfma_f32_16x16x32_bf16 v[44:47], v[148:151], a[156:159], v[44:47]
  v_mul_f32 v97, s39, v97
  s_waitcnt lgkmcnt(9)
  v_mfma_f32_16x16x32_bf16 v[48:51], v[152:155], a[144:147], v[48:51]
  ds_read_b64_tr_b16 v[148:149], v207 offset:2048
  v_mfma_f32_16x16x32_bf16 v[52:55], v[152:155], a[148:151], v[52:55]
  ds_write_b64 v231, v[92:93] offset:6144
  v_mfma_f32_16x16x32_bf16 v[56:59], v[152:155], a[152:155], v[56:59]
  ds_read_b64_tr_b16 v[150:151], v207 offset:2560
  v_mul_f32 v98, s39, v98
  v_mfma_f32_16x16x32_bf16 v[60:63], v[152:155], a[156:159], v[60:63]
  buffer_load_dwordx4 v221, s[56:59], s38 offen offset:2048 lds
  s_add_u32 m0, s25, 0
  s_add_u32 s38, s6, 0
  s_waitcnt lgkmcnt(9)
  v_mfma_f32_16x16x32_bf16 v[64:67], v[156:159], a[144:147], v[64:67]
  ds_read_b64_tr_b16 v[152:153], v204 offset:4096
  v_mul_f32 v99, s39, v99
  v_mfma_f32_16x16x32_bf16 v[68:71], v[156:159], a[148:151], v[68:71]
  v_mul_f32 v132, v100, v132
  v_mul_f32 v133, v101, v133
  v_mfma_f32_16x16x32_bf16 v[72:75], v[156:159], a[152:155], v[72:75]
  ds_read_b64_tr_b16 v[154:155], v204 offset:4608
  v_mul_f32 v134, v102, v134
  v_mfma_f32_16x16x32_bf16 v[76:79], v[156:159], a[156:159], v[76:79]
  v_exp_f32 v96, -v96
  s_waitcnt lgkmcnt(9)
  v_mfma_f32_16x16x32_bf16 v[16:19], v[160:163], a[160:163], v[16:19]
  ds_read_b64_tr_b16 v[156:157], v205 offset:4096
  v_mul_f32 v135, v103, v135
  v_mfma_f32_16x16x32_bf16 v[20:23], v[160:163], a[164:167], v[20:23]
  v_exp_f32 v97, -v97
  v_mfma_f32_16x16x32_bf16 v[24:27], v[160:163], a[168:171], v[24:27]
  ds_read_b64_tr_b16 v[158:159], v205 offset:4608
  v_mul_f32 v100, s39, v100
  v_mfma_f32_16x16x32_bf16 v[28:31], v[160:163], a[172:175], v[28:31]
  v_mul_f32 v101, s39, v101
  v_mul_f32 v102, s39, v102
  s_waitcnt lgkmcnt(9)
  v_mfma_f32_16x16x32_bf16 v[32:35], v[164:167], a[160:163], v[32:35]
  ds_read_b64_tr_b16 v[160:161], v206 offset:4096
  v_mul_f32 v103, s39, v103
  v_mfma_f32_16x16x32_bf16 v[36:39], v[164:167], a[164:167], v[36:39]
  v_exp_f32 v98, -v98
  v_mfma_f32_16x16x32_bf16 v[40:43], v[164:167], a[168:171], v[40:43]
  ds_read_b64_tr_b16 v[162:163], v206 offset:4608
  v_mfma_f32_16x16x32_bf16 v[44:47], v[164:167], a[172:175], v[44:47]
  v_exp_f32 v99, -v99
  s_waitcnt lgkmcnt(9)
  v_mfma_f32_16x16x32_bf16 v[48:51], v[144:147], a[160:163], v[48:51]
  ds_read_b64_tr_b16 v[164:165], v207 offset:4096
  v_mfma_f32_16x16x32_bf16 v[52:55], v[144:147], a[164:167], v[52:55]
  v_add_f32 v96, 1.0, v96
  v_mfma_f32_16x16x32_bf16 v[56:59], v[144:147], a[168:171], v[56:59]
  ds_read_b64_tr_b16 v[166:167], v207 offset:4608
  v_mfma_f32_16x16x32_bf16 v[60:63], v[144:147], a[172:175], v[60:63]
  v_exp_f32 v100, -v100
  s_waitcnt lgkmcnt(8)
  v_mfma_f32_16x16x32_bf16 v[64:67], v[148:151], a[160:163], v[64:67]
  v_add_f32 v97, 1.0, v97
  v_mfma_f32_16x16x32_bf16 v[68:71], v[148:151], a[164:167], v[68:71]
  v_exp_f32 v101, -v101
  v_mfma_f32_16x16x32_bf16 v[72:75], v[148:151], a[168:171], v[72:75]
  v_add_f32 v98, 1.0, v98
  v_mfma_f32_16x16x32_bf16 v[76:79], v[148:151], a[172:175], v[76:79]
  v_exp_f32 v102, -v102
  s_waitcnt lgkmcnt(0)
  s_waitcnt vmcnt(6)
  s_barrier
  v_mfma_f32_16x16x32_bf16 v[16:19], v[152:155], a[176:179], v[16:19]
  ds_read_b64_tr_b16 v[144:145], v204 offset:24576
  v_mfma_f32_16x16x32_bf16 v[20:23], v[152:155], a[180:183], v[20:23]
  buffer_load_dwordx4 v219, s[56:59], s38 offen lds
  v_mfma_f32_16x16x32_bf16 v[24:27], v[152:155], a[184:187], v[24:27]
  ds_read_b64_tr_b16 v[146:147], v204 offset:25088
  v_add_f32 v99, 1.0, v99
  v_mfma_f32_16x16x32_bf16 v[28:31], v[152:155], a[188:191], v[28:31]
  ds_read_b64_tr_b16 v[148:149], v205 offset:24576
  v_mfma_f32_16x16x32_bf16 v[32:35], v[156:159], a[176:179], v[32:35]
  ds_read_b64_tr_b16 v[150:151], v205 offset:25088
  v_mfma_f32_16x16x32_bf16 v[36:39], v[156:159], a[180:183], v[36:39]
  ds_read_b64_tr_b16 v[152:153], v206 offset:24576
  v_mfma_f32_16x16x32_bf16 v[40:43], v[156:159], a[184:187], v[40:43]
  ds_read_b64_tr_b16 v[154:155], v206 offset:25088
  v_mfma_f32_16x16x32_bf16 v[44:47], v[156:159], a[188:191], v[44:47]
  buffer_load_dwordx4 v220, s[56:59], s38 offen offset:1024 lds
  v_mfma_f32_16x16x32_bf16 v[48:51], v[160:163], a[176:179], v[48:51]
  ds_read_b64_tr_b16 v[156:157], v207 offset:24576
  v_mfma_f32_16x16x32_bf16 v[52:55], v[160:163], a[180:183], v[52:55]
  v_rcp_f32 v96, v96
  v_mfma_f32_16x16x32_bf16 v[56:59], v[160:163], a[184:187], v[56:59]
  ds_read_b64_tr_b16 v[158:159], v207 offset:25088
  v_mfma_f32_16x16x32_bf16 v[60:63], v[160:163], a[188:191], v[60:63]
  buffer_load_dwordx4 v221, s[56:59], s38 offen offset:2048 lds
  s_add_u32 m0, s25, 3072
  s_add_u32 s38, s6, 442368
  v_mfma_f32_16x16x32_bf16 v[64:67], v[164:167], a[176:179], v[64:67]
  ds_read_b64_tr_b16 v[160:161], v204 offset:26624
  v_mfma_f32_16x16x32_bf16 v[68:71], v[164:167], a[180:183], v[68:71]
  v_rcp_f32 v97, v97
  v_mfma_f32_16x16x32_bf16 v[72:75], v[164:167], a[184:187], v[72:75]
  ds_read_b64_tr_b16 v[162:163], v204 offset:27136
  v_exp_f32 v103, -v103
  v_mfma_f32_16x16x32_bf16 v[76:79], v[164:167], a[188:191], v[76:79]
  v_rcp_f32 v98, v98
  s_waitcnt lgkmcnt(8)
  v_mfma_f32_16x16x32_bf16 v[16:19], v[144:147], a[192:195], v[16:19]
  ds_read_b64_tr_b16 v[164:165], v205 offset:26624
  v_add_f32 v100, 1.0, v100
  v_mfma_f32_16x16x32_bf16 v[20:23], v[144:147], a[196:199], v[20:23]
  buffer_load_dwordx4 v219, s[56:59], s38 offen lds
  v_mfma_f32_16x16x32_bf16 v[24:27], v[144:147], a[200:203], v[24:27]
  ds_read_b64_tr_b16 v[166:167], v205 offset:27136
  v_add_f32 v101, 1.0, v101
  v_mfma_f32_16x16x32_bf16 v[28:31], v[144:147], a[204:207], v[28:31]
  v_rcp_f32 v99, v99
  s_waitcnt lgkmcnt(8)
  v_mfma_f32_16x16x32_bf16 v[32:35], v[148:151], a[192:195], v[32:35]
  ds_read_b64_tr_b16 v[144:145], v206 offset:26624
  v_mul_f32 v128, v96, v128
  v_mfma_f32_16x16x32_bf16 v[36:39], v[148:151], a[196:199], v[36:39]
  buffer_load_dwordx4 v220, s[56:59], s38 offen offset:1024 lds
  v_mfma_f32_16x16x32_bf16 v[40:43], v[148:151], a[200:203], v[40:43]
  ds_read_b64_tr_b16 v[146:147], v206 offset:27136
  v_mul_f32 v129, v97, v129
  v_mfma_f32_16x16x32_bf16 v[44:47], v[148:151], a[204:207], v[44:47]
  v_mul_f32 v130, v98, v130
  v_add_f32 v102, 1.0, v102
  s_waitcnt lgkmcnt(8)
  v_mfma_f32_16x16x32_bf16 v[48:51], v[152:155], a[192:195], v[48:51]
  ds_read_b64_tr_b16 v[148:149], v207 offset:26624
  v_mul_f32 v131, v99, v131
  v_mfma_f32_16x16x32_bf16 v[52:55], v[152:155], a[196:199], v[52:55]
  v_cvt_pk_bf16_f32 v96, v128, v129
  v_add_f32 v103, 1.0, v103
  v_mfma_f32_16x16x32_bf16 v[56:59], v[152:155], a[200:203], v[56:59]
  ds_read_b64_tr_b16 v[150:151], v207 offset:27136
  v_mfma_f32_16x16x32_bf16 v[60:63], v[152:155], a[204:207], v[60:63]
  buffer_load_dwordx4 v221, s[56:59], s38 offen offset:2048 lds
  s_add_u32 m0, s25, 24576
  s_add_u32 s38, s6, 884736
  s_waitcnt lgkmcnt(8)
  v_mfma_f32_16x16x32_bf16 v[64:67], v[156:159], a[192:195], v[64:67]
  ds_read_b64_tr_b16 v[152:153], v204 offset:28672
  v_cvt_pk_bf16_f32 v97, v130, v131
  v_mfma_f32_16x16x32_bf16 v[68:71], v[156:159], a[196:199], v[68:71]
  ds_write_b64 v232, v[96:97] offset:0
  v_mfma_f32_16x16x32_bf16 v[72:75], v[156:159], a[200:203], v[72:75]
  ds_read_b64_tr_b16 v[154:155], v204 offset:29184
  v_rcp_f32 v100, v100
  v_mfma_f32_16x16x32_bf16 v[76:79], v[156:159], a[204:207], v[76:79]
  v_rcp_f32 v101, v101
  s_waitcnt lgkmcnt(9)
  v_mfma_f32_16x16x32_bf16 v[16:19], v[160:163], a[208:211], v[16:19]
  ds_read_b64_tr_b16 v[156:157], v205 offset:28672
  v_mul_f32 v136, v104, v136
  v_mfma_f32_16x16x32_bf16 v[20:23], v[160:163], a[212:215], v[20:23]
  v_rcp_f32 v102, v102
  v_mfma_f32_16x16x32_bf16 v[24:27], v[160:163], a[216:219], v[24:27]
  ds_read_b64_tr_b16 v[158:159], v205 offset:29184
  v_mul_f32 v137, v105, v137
  v_mfma_f32_16x16x32_bf16 v[28:31], v[160:163], a[220:223], v[28:31]
  v_rcp_f32 v103, v103
  s_waitcnt lgkmcnt(9)
  v_mfma_f32_16x16x32_bf16 v[32:35], v[164:167], a[208:211], v[32:35]
  ds_read_b64_tr_b16 v[160:161], v206 offset:28672
  v_mul_f32 v132, v100, v132
  v_mfma_f32_16x16x32_bf16 v[36:39], v[164:167], a[212:215], v[36:39]
  v_mul_f32 v138, v106, v138
  v_mul_f32 v133, v101, v133
  v_mfma_f32_16x16x32_bf16 v[40:43], v[164:167], a[216:219], v[40:43]
  ds_read_b64_tr_b16 v[162:163], v206 offset:29184
  v_mul_f32 v134, v102, v134
  v_mfma_f32_16x16x32_bf16 v[44:47], v[164:167], a[220:223], v[44:47]
  v_mul_f32 v139, v107, v139
  v_mul_f32 v135, v103, v135
  s_waitcnt lgkmcnt(9)
  v_mfma_f32_16x16x32_bf16 v[48:51], v[144:147], a[208:211], v[48:51]
  ds_read_b64_tr_b16 v[164:165], v207 offset:28672
  v_cvt_pk_bf16_f32 v100, v132, v133
  v_mfma_f32_16x16x32_bf16 v[52:55], v[144:147], a[212:215], v[52:55]
  v_cvt_pk_bf16_f32 v101, v134, v135
  v_mfma_f32_16x16x32_bf16 v[56:59], v[144:147], a[216:219], v[56:59]
  ds_read_b64_tr_b16 v[166:167], v207 offset:29184
  v_mul_f32 v104, s39, v104
  v_mfma_f32_16x16x32_bf16 v[60:63], v[144:147], a[220:223], v[60:63]
  ds_write_b64 v232, v[100:101] offset:2048
  s_waitcnt lgkmcnt(10)
  v_mfma_f32_16x16x32_bf16 v[64:67], v[148:151], a[208:211], v[64:67]
  v_mul_f32 v140, v108, v140
  v_mul_f32 v141, v109, v141
  v_mfma_f32_16x16x32_bf16 v[68:71], v[148:151], a[212:215], v[68:71]
  v_mul_f32 v105, s39, v105
  v_mul_f32 v142, v110, v142
  v_mfma_f32_16x16x32_bf16 v[72:75], v[148:151], a[216:219], v[72:75]
  v_mul_f32 v143, v111, v143
  v_mul_f32 v108, s39, v108
  v_mfma_f32_16x16x32_bf16 v[76:79], v[148:151], a[220:223], v[76:79]
  v_mul_f32 v106, s39, v106
  v_mul_f32 v109, s39, v109
  s_waitcnt lgkmcnt(0)
  s_waitcnt vmcnt(6)
  s_barrier
  v_mfma_f32_16x16x32_bf16 v[16:19], v[152:155], a[224:227], v[16:19]
  ds_read_b64_tr_b16 v[144:145], v204 offset:49152
  v_mul_f32 v110, s39, v110
  v_mfma_f32_16x16x32_bf16 v[20:23], v[152:155], a[228:231], v[20:23]
  buffer_load_dwordx4 v219, s[56:59], s38 offen lds
  v_mfma_f32_16x16x32_bf16 v[24:27], v[152:155], a[232:235], v[24:27]
  ds_read_b64_tr_b16 v[146:147], v204 offset:49664
  v_mul_f32 v107, s39, v107
  v_mfma_f32_16x16x32_bf16 v[28:31], v[152:155], a[236:239], v[28:31]
  ds_read_b64_tr_b16 v[148:149], v205 offset:49152
  v_mul_f32 v111, s39, v111
  v_mfma_f32_16x16x32_bf16 v[32:35], v[156:159], a[224:227], v[32:35]
  ds_read_b64_tr_b16 v[150:151], v205 offset:49664
  v_mfma_f32_16x16x32_bf16 v[36:39], v[156:159], a[228:231], v[36:39]
  ds_read_b64_tr_b16 v[152:153], v206 offset:49152
  v_mfma_f32_16x16x32_bf16 v[40:43], v[156:159], a[232:235], v[40:43]
  ds_read_b64_tr_b16 v[154:155], v206 offset:49664
  v_mfma_f32_16x16x32_bf16 v[44:47], v[156:159], a[236:239], v[44:47]
  buffer_load_dwordx4 v220, s[56:59], s38 offen offset:1024 lds
  v_mfma_f32_16x16x32_bf16 v[48:51], v[160:163], a[224:227], v[48:51]
  ds_read_b64_tr_b16 v[156:157], v207 offset:49152
  v_mfma_f32_16x16x32_bf16 v[52:55], v[160:163], a[228:231], v[52:55]
  v_exp_f32 v104, -v104
  v_mfma_f32_16x16x32_bf16 v[56:59], v[160:163], a[232:235], v[56:59]
  ds_read_b64_tr_b16 v[158:159], v207 offset:49664
  v_mfma_f32_16x16x32_bf16 v[60:63], v[160:163], a[236:239], v[60:63]
  buffer_load_dwordx4 v221, s[56:59], s38 offen offset:2048 lds
  s_add_u32 m0, s25, 27648
  s_add_u32 s38, s6, 1327104
  v_mfma_f32_16x16x32_bf16 v[64:67], v[164:167], a[224:227], v[64:67]
  ds_read_b64_tr_b16 v[160:161], v204 offset:51200
  v_mfma_f32_16x16x32_bf16 v[68:71], v[164:167], a[228:231], v[68:71]
  v_exp_f32 v105, -v105
  v_mfma_f32_16x16x32_bf16 v[72:75], v[164:167], a[232:235], v[72:75]
  ds_read_b64_tr_b16 v[162:163], v204 offset:51712
  v_mfma_f32_16x16x32_bf16 v[76:79], v[164:167], a[236:239], v[76:79]
  v_exp_f32 v106, -v106
  s_waitcnt lgkmcnt(8)
  v_mfma_f32_16x16x32_bf16 v[16:19], v[144:147], a[240:243], v[16:19]
  ds_read_b64_tr_b16 v[164:165], v205 offset:51200
  v_mfma_f32_16x16x32_bf16 v[20:23], v[144:147], a[244:247], v[20:23]
  buffer_load_dwordx4 v219, s[56:59], s38 offen lds
  v_mfma_f32_16x16x32_bf16 v[24:27], v[144:147], a[248:251], v[24:27]
  ds_read_b64_tr_b16 v[166:167], v205 offset:51712
  v_mfma_f32_16x16x32_bf16 v[28:31], v[144:147], a[252:255], v[28:31]
  v_exp_f32 v107, -v107
  s_waitcnt lgkmcnt(8)
  v_mfma_f32_16x16x32_bf16 v[32:35], v[148:151], a[240:243], v[32:35]
  ds_read_b64_tr_b16 v[144:145], v206 offset:51200
  v_add_f32 v104, 1.0, v104
  v_mfma_f32_16x16x32_bf16 v[36:39], v[148:151], a[244:247], v[36:39]
  buffer_load_dwordx4 v220, s[56:59], s38 offen offset:1024 lds
  v_mfma_f32_16x16x32_bf16 v[40:43], v[148:151], a[248:251], v[40:43]
  ds_read_b64_tr_b16 v[146:147], v206 offset:51712
  v_add_f32 v105, 1.0, v105
  v_mfma_f32_16x16x32_bf16 v[44:47], v[148:151], a[252:255], v[44:47]
  v_add_f32 v106, 1.0, v106
  v_add_f32 v107, 1.0, v107
  s_waitcnt lgkmcnt(8)
  v_mfma_f32_16x16x32_bf16 v[48:51], v[152:155], a[240:243], v[48:51]
  ds_read_b64_tr_b16 v[148:149], v207 offset:51200
  v_mfma_f32_16x16x32_bf16 v[52:55], v[152:155], a[244:247], v[52:55]
  v_rcp_f32 v104, v104
  v_mfma_f32_16x16x32_bf16 v[56:59], v[152:155], a[248:251], v[56:59]
  ds_read_b64_tr_b16 v[150:151], v207 offset:51712
  v_mfma_f32_16x16x32_bf16 v[60:63], v[152:155], a[252:255], v[60:63]
  buffer_load_dwordx4 v221, s[56:59], s38 offen offset:2048 lds
  s_add_u32 m0, s25, 49152
  s_add_u32 s38, s6, 1769472
  s_waitcnt lgkmcnt(8)
  v_mfma_f32_16x16x32_bf16 v[64:67], v[156:159], a[240:243], v[64:67]
  ds_read_b64_tr_b16 v[152:153], v204 offset:53248
  v_exp_f32 v108, -v108
  v_mfma_f32_16x16x32_bf16 v[68:71], v[156:159], a[244:247], v[68:71]
  v_rcp_f32 v105, v105
  v_mfma_f32_16x16x32_bf16 v[72:75], v[156:159], a[248:251], v[72:75]
  ds_read_b64_tr_b16 v[154:155], v204 offset:53760
  v_exp_f32 v109, -v109
  v_mfma_f32_16x16x32_bf16 v[76:79], v[156:159], a[252:255], v[76:79]
  v_rcp_f32 v106, v106
  s_waitcnt lgkmcnt(8)
  v_mfma_f32_16x16x32_bf16 v[16:19], v[160:163], v[168:171], v[16:19]
  ds_read_b64_tr_b16 v[156:157], v205 offset:53248
  v_mfma_f32_16x16x32_bf16 v[20:23], v[160:163], v[172:175], v[20:23]
  v_rcp_f32 v107, v107
  v_mfma_f32_16x16x32_bf16 v[24:27], v[160:163], v[176:179], v[24:27]
  ds_read_b64_tr_b16 v[158:159], v205 offset:53760
  v_exp_f32 v110, -v110
  v_mfma_f32_16x16x32_bf16 v[28:31], v[160:163], v[180:183], v[28:31]
  v_mul_f32 v136, v104, v136
  v_exp_f32 v111, -v111
  s_waitcnt lgkmcnt(8)
  v_mfma_f32_16x16x32_bf16 v[32:35], v[164:167], v[168:171], v[32:35]
  ds_read_b64_tr_b16 v[160:161], v206 offset:53248
  v_add_f32 v108, 1.0, v108
  v_mfma_f32_16x16x32_bf16 v[36:39], v[164:167], v[172:175], v[36:39]
  v_add_f32 v109, 1.0, v109
  v_add_f32 v110, 1.0, v110
  v_mfma_f32_16x16x32_bf16 v[40:43], v[164:167], v[176:179], v[40:43]
  ds_read_b64_tr_b16 v[162:163], v206 offset:53760
  v_mul_f32 v137, v105, v137
  v_mfma_f32_16x16x32_bf16 v[44:47], v[164:167], v[180:183], v[44:47]
  v_add_f32 v111, 1.0, v111
  s_waitcnt lgkmcnt(8)
  v_mfma_f32_16x16x32_bf16 v[48:51], v[144:147], v[168:171], v[48:51]
  ds_read_b64_tr_b16 v[164:165], v207 offset:53248
  v_mul_f32 v138, v106, v138
  v_mfma_f32_16x16x32_bf16 v[52:55], v[144:147], v[172:175], v[52:55]
  v_rcp_f32 v108, v108
  v_mfma_f32_16x16x32_bf16 v[56:59], v[144:147], v[176:179], v[56:59]
  ds_read_b64_tr_b16 v[166:167], v207 offset:53760
  v_mfma_f32_16x16x32_bf16 v[60:63], v[144:147], v[180:183], v[60:63]
  v_mul_f32 v139, v107, v139
  s_waitcnt lgkmcnt(8)
  v_mfma_f32_16x16x32_bf16 v[64:67], v[148:151], v[168:171], v[64:67]
  v_rcp_f32 v109, v109
  v_mfma_f32_16x16x32_bf16 v[68:71], v[148:151], v[172:175], v[68:71]
  v_cvt_pk_bf16_f32 v104, v136, v137
  v_mfma_f32_16x16x32_bf16 v[72:75], v[148:151], v[176:179], v[72:75]
  v_rcp_f32 v110, v110
  v_mfma_f32_16x16x32_bf16 v[76:79], v[148:151], v[180:183], v[76:79]
  v_rcp_f32 v111, v111
  s_waitcnt lgkmcnt(0)
  s_waitcnt vmcnt(6)
  s_barrier
  v_mfma_f32_16x16x32_bf16 v[16:19], v[152:155], v[184:187], v[16:19]
  ds_read_b64_tr_b16 v[144:145], v204 offset:0
  v_cvt_pk_bf16_f32 v105, v138, v139
  v_mfma_f32_16x16x32_bf16 v[20:23], v[152:155], v[188:191], v[20:23]
  buffer_load_dwordx4 v219, s[56:59], s38 offen lds
  v_mfma_f32_16x16x32_bf16 v[24:27], v[152:155], v[192:195], v[24:27]
  ds_read_b64_tr_b16 v[146:147], v204 offset:512
  v_mul_f32 v140, v108, v140
  v_mfma_f32_16x16x32_bf16 v[28:31], v[152:155], v[196:199], v[28:31]
  ds_read_b64_tr_b16 v[148:149], v205 offset:0
  v_mul_f32 v141, v109, v141
  v_mfma_f32_16x16x32_bf16 v[32:35], v[156:159], v[184:187], v[32:35]
  ds_read_b64_tr_b16 v[150:151], v205 offset:512
  v_mul_f32 v142, v110, v142
  v_mfma_f32_16x16x32_bf16 v[36:39], v[156:159], v[188:191], v[36:39]
  ds_read_b64_tr_b16 v[152:153], v206 offset:0
  v_mul_f32 v143, v111, v143
  v_mfma_f32_16x16x32_bf16 v[40:43], v[156:159], v[192:195], v[40:43]
  ds_read_b64_tr_b16 v[154:155], v206 offset:512
  v_cvt_pk_bf16_f32 v108, v140, v141
  v_mfma_f32_16x16x32_bf16 v[44:47], v[156:159], v[196:199], v[44:47]
  buffer_load_dwordx4 v220, s[56:59], s38 offen offset:1024 lds
  v_mfma_f32_16x16x32_bf16 v[48:51], v[160:163], v[184:187], v[48:51]
  ds_read_b64_tr_b16 v[156:157], v207 offset:0
  v_cvt_pk_bf16_f32 v109, v142, v143
  v_mfma_f32_16x16x32_bf16 v[52:55], v[160:163], v[188:191], v[52:55]
  ds_write_b64 v232, v[104:105] offset:4096
  v_mfma_f32_16x16x32_bf16 v[56:59], v[160:163], v[192:195], v[56:59]
  ds_read_b64_tr_b16 v[158:159], v207 offset:512
  v_mfma_f32_16x16x32_bf16 v[60:63], v[160:163], v[196:199], v[60:63]
  buffer_load_dwordx4 v221, s[56:59], s38 offen offset:2048 lds
  s_add_u32 m0, s25, 52224
  s_add_u32 s38, s6, 2211840
  v_mfma_f32_16x16x32_bf16 v[64:67], v[164:167], v[184:187], v[64:67]
  ds_read_b64_tr_b16 v[160:161], v204 offset:2048
  v_mfma_f32_16x16x32_bf16 v[68:71], v[164:167], v[188:191], v[68:71]
  ds_write_b64 v232, v[108:109] offset:6144
  v_mfma_f32_16x16x32_bf16 v[72:75], v[164:167], v[192:195], v[72:75]
  ds_read_b64_tr_b16 v[162:163], v204 offset:2560
  v_mfma_f32_16x16x32_bf16 v[76:79], v[164:167], v[196:199], v[76:79]
  s_waitcnt lgkmcnt(10)
  v_mfma_f32_16x16x32_bf16 v[80:83], v[144:147], a[0:3], 0
  ds_read_b64_tr_b16 v[164:165], v205 offset:2048
  v_mfma_f32_16x16x32_bf16 v[84:87], v[144:147], a[4:7], 0
  buffer_load_dwordx4 v219, s[56:59], s38 offen lds
  v_mfma_f32_16x16x32_bf16 v[88:91], v[144:147], a[8:11], 0
  ds_read_b64_tr_b16 v[166:167], v205 offset:2560
  v_mfma_f32_16x16x32_bf16 v[92:95], v[144:147], a[12:15], 0
  s_waitcnt lgkmcnt(10)
  v_mfma_f32_16x16x32_bf16 v[96:99], v[148:151], a[0:3], 0
  ds_read_b64_tr_b16 v[144:145], v206 offset:2048
  v_mfma_f32_16x16x32_bf16 v[100:103], v[148:151], a[4:7], 0
  buffer_load_dwordx4 v220, s[56:59], s38 offen offset:1024 lds
  v_mfma_f32_16x16x32_bf16 v[104:107], v[148:151], a[8:11], 0
  ds_read_b64_tr_b16 v[146:147], v206 offset:2560
  v_mfma_f32_16x16x32_bf16 v[108:111], v[148:151], a[12:15], 0
  s_waitcnt lgkmcnt(10)
  v_mfma_f32_16x16x32_bf16 v[112:115], v[152:155], a[0:3], 0
  ds_read_b64_tr_b16 v[148:149], v207 offset:2048
  v_mfma_f32_16x16x32_bf16 v[116:119], v[152:155], a[4:7], 0
  v_mfma_f32_16x16x32_bf16 v[120:123], v[152:155], a[8:11], 0
  ds_read_b64_tr_b16 v[150:151], v207 offset:2560
  v_mul_f32 v48, v16, v48
  v_mfma_f32_16x16x32_bf16 v[124:127], v[152:155], a[12:15], 0
  buffer_load_dwordx4 v221, s[56:59], s38 offen offset:2048 lds
  s_add_u32 m0, s25, 0
  s_add_u32 s38, s6, 2654208
  s_waitcnt lgkmcnt(9)
  v_mfma_f32_16x16x32_bf16 v[128:131], v[156:159], a[0:3], 0
  ds_read_b64_tr_b16 v[152:153], v204 offset:4096
  v_mul_f32 v49, v17, v49
  v_mfma_f32_16x16x32_bf16 v[132:135], v[156:159], a[4:7], 0
  v_mul_f32 v50, v18, v50
  v_mul_f32 v52, v20, v52
  v_mfma_f32_16x16x32_bf16 v[136:139], v[156:159], a[8:11], 0
  ds_read_b64_tr_b16 v[154:155], v204 offset:4608
  v_mul_f32 v51, v19, v51
  v_mfma_f32_16x16x32_bf16 v[140:143], v[156:159], a[12:15], 0
  v_mul_f32 v16, s39, v16
  v_mul_f32 v53, v21, v53
  s_waitcnt lgkmcnt(8)
  v_mfma_f32_16x16x32_bf16 v[80:83], v[160:163], a[16:19], v[80:83]
  ds_read_b64_tr_b16 v[156:157], v205 offset:4096
  v_mul_f32 v17, s39, v17
  v_mfma_f32_16x16x32_bf16 v[84:87], v[160:163], a[20:23], v[84:87]
  v_mul_f32 v18, s39, v18
  v_mul_f32 v54, v22, v54
  v_mfma_f32_16x16x32_bf16 v[88:91], v[160:163], a[24:27], v[88:91]
  ds_read_b64_tr_b16 v[158:159], v205 offset:4608
  v_mul_f32 v19, s39, v19
  v_mfma_f32_16x16x32_bf16 v[92:95], v[160:163], a[28:31], v[92:95]
  v_mul_f32 v55, v23, v55
  v_mul_f32 v20, s39, v20
  s_waitcnt lgkmcnt(8)
  v_mfma_f32_16x16x32_bf16 v[96:99], v[164:167], a[16:19], v[96:99]
  ds_read_b64_tr_b16 v[160:161], v206 offset:4096
  v_mul_f32 v21, s39, v21
  v_mfma_f32_16x16x32_bf16 v[100:103], v[164:167], a[20:23], v[100:103]
  v_exp_f32 v16, -v16
  v_mfma_f32_16x16x32_bf16 v[104:107], v[164:167], a[24:27], v[104:107]
  ds_read_b64_tr_b16 v[162:163], v206 offset:4608
  v_mul_f32 v22, s39, v22
  v_mfma_f32_16x16x32_bf16 v[108:111], v[164:167], a[28:31], v[108:111]
  v_exp_f32 v17, -v17
  s_waitcnt lgkmcnt(8)
  v_mfma_f32_16x16x32_bf16 v[112:115], v[144:147], a[16:19], v[112:115]
  ds_read_b64_tr_b16 v[164:165], v207 offset:4096
  v_mul_f32 v23, s39, v23
  v_mfma_f32_16x16x32_bf16 v[116:119], v[144:147], a[20:23], v[116:119]
  v_exp_f32 v18, -v18
  v_mfma_f32_16x16x32_bf16 v[120:123], v[144:147], a[24:27], v[120:123]
  ds_read_b64_tr_b16 v[166:167], v207 offset:4608
  v_mfma_f32_16x16x32_bf16 v[124:127], v[144:147], a[28:31], v[124:127]
  v_exp_f32 v20, -v20
  s_waitcnt lgkmcnt(8)
  v_mfma_f32_16x16x32_bf16 v[128:131], v[148:151], a[16:19], v[128:131]
  v_exp_f32 v19, -v19
  v_mfma_f32_16x16x32_bf16 v[132:135], v[148:151], a[20:23], v[132:135]
  v_exp_f32 v21, -v21
  v_mfma_f32_16x16x32_bf16 v[136:139], v[148:151], a[24:27], v[136:139]
  v_add_f32 v16, 1.0, v16
  v_mfma_f32_16x16x32_bf16 v[140:143], v[148:151], a[28:31], v[140:143]
  v_exp_f32 v22, -v22
  s_waitcnt lgkmcnt(0)
  s_waitcnt vmcnt(6)
  s_barrier
  v_mfma_f32_16x16x32_bf16 v[80:83], v[152:155], a[32:35], v[80:83]
  ds_read_b64_tr_b16 v[144:145], v204 offset:24576
  v_mfma_f32_16x16x32_bf16 v[84:87], v[152:155], a[36:39], v[84:87]
  buffer_load_dwordx4 v219, s[56:59], s38 offen lds
  v_mfma_f32_16x16x32_bf16 v[88:91], v[152:155], a[40:43], v[88:91]
  ds_read_b64_tr_b16 v[146:147], v204 offset:25088
  v_add_f32 v17, 1.0, v17
  v_mfma_f32_16x16x32_bf16 v[92:95], v[152:155], a[44:47], v[92:95]
  ds_read_b64_tr_b16 v[148:149], v205 offset:24576
  v_add_f32 v18, 1.0, v18
  v_mfma_f32_16x16x32_bf16 v[96:99], v[156:159], a[32:35], v[96:99]
  ds_read_b64_tr_b16 v[150:151], v205 offset:25088
  v_mfma_f32_16x16x32_bf16 v[100:103], v[156:159], a[36:39], v[100:103]
  ds_read_b64_tr_b16 v[152:153], v206 offset:24576
  v_mfma_f32_16x16x32_bf16 v[104:107], v[156:159], a[40:43], v[104:107]
  ds_read_b64_tr_b16 v[154:155], v206 offset:25088
  v_add_f32 v19, 1.0, v19
  v_mfma_f32_16x16x32_bf16 v[108:111], v[156:159], a[44:47], v[108:111]
  buffer_load_dwordx4 v220, s[56:59], s38 offen offset:1024 lds
  v_mfma_f32_16x16x32_bf16 v[112:115], v[160:163], a[32:35], v[112:115]
  ds_read_b64_tr_b16 v[156:157], v207 offset:24576
  v_mfma_f32_16x16x32_bf16 v[116:119], v[160:163], a[36:39], v[116:119]
  v_rcp_f32 v16, v16
  v_mfma_f32_16x16x32_bf16 v[120:123], v[160:163], a[40:43], v[120:123]
  ds_read_b64_tr_b16 v[158:159], v207 offset:25088
  v_mfma_f32_16x16x32_bf16 v[124:127], v[160:163], a[44:47], v[124:127]
  buffer_load_dwordx4 v221, s[56:59], s38 offen offset:2048 lds
  s_add_u32 m0, s25, 3072
  s_add_u32 s38, s6, 3096576
  v_mfma_f32_16x16x32_bf16 v[128:131], v[164:167], a[32:35], v[128:131]
  ds_read_b64_tr_b16 v[160:161], v204 offset:26624
  v_mfma_f32_16x16x32_bf16 v[132:135], v[164:167], a[36:39], v[132:135]
  v_rcp_f32 v17, v17
  v_mfma_f32_16x16x32_bf16 v[136:139], v[164:167], a[40:43], v[136:139]
  ds_read_b64_tr_b16 v[162:163], v204 offset:27136
  v_mfma_f32_16x16x32_bf16 v[140:143], v[164:167], a[44:47], v[140:143]
  v_rcp_f32 v18, v18
  s_waitcnt lgkmcnt(8)
  v_mfma_f32_16x16x32_bf16 v[80:83], v[144:147], a[48:51], v[80:83]
  ds_read_b64_tr_b16 v[164:165], v205 offset:26624
  v_mfma_f32_16x16x32_bf16 v[84:87], v[144:147], a[52:55], v[84:87]
  buffer_load_dwordx4 v219, s[56:59], s38 offen lds
  v_mfma_f32_16x16x32_bf16 v[88:91], v[144:147], a[56:59], v[88:91]
  ds_read_b64_tr_b16 v[166:167], v205 offset:27136
  v_mfma_f32_16x16x32_bf16 v[92:95], v[144:147], a[60:63], v[92:95]
  v_rcp_f32 v19, v19
  s_waitcnt lgkmcnt(8)
  v_mfma_f32_16x16x32_bf16 v[96:99], v[148:151], a[48:51], v[96:99]
  ds_read_b64_tr_b16 v[144:145], v206 offset:26624
  v_mul_f32 v48, v16, v48
  v_mfma_f32_16x16x32_bf16 v[100:103], v[148:151], a[52:55], v[100:103]
  buffer_load_dwordx4 v220, s[56:59], s38 offen offset:1024 lds
  v_mfma_f32_16x16x32_bf16 v[104:107], v[148:151], a[56:59], v[104:107]
  ds_read_b64_tr_b16 v[146:147], v206 offset:27136
  v_mul_f32 v49, v17, v49
  v_mfma_f32_16x16x32_bf16 v[108:111], v[148:151], a[60:63], v[108:111]
  v_exp_f32 v23, -v23
  s_waitcnt lgkmcnt(8)
  v_mfma_f32_16x16x32_bf16 v[112:115], v[152:155], a[48:51], v[112:115]
  ds_read_b64_tr_b16 v[148:149], v207 offset:26624
  v_mul_f32 v50, v18, v50
  v_mfma_f32_16x16x32_bf16 v[116:119], v[152:155], a[52:55], v[116:119]
  v_add_f32 v20, 1.0, v20
  v_add_f32 v21, 1.0, v21
  v_mfma_f32_16x16x32_bf16 v[120:123], v[152:155], a[56:59], v[120:123]
  ds_read_b64_tr_b16 v[150:151], v207 offset:27136
  v_mul_f32 v51, v19, v51
  v_mfma_f32_16x16x32_bf16 v[124:127], v[152:155], a[60:63], v[124:127]
  buffer_load_dwordx4 v221, s[56:59], s38 offen offset:2048 lds
  s_add_u32 m0, s25, 24576
  s_add_u32 s38, s6, 3538944
  s_waitcnt lgkmcnt(8)
  v_mfma_f32_16x16x32_bf16 v[128:131], v[156:159], a[48:51], v[128:131]
  ds_read_b64_tr_b16 v[152:153], v204 offset:28672
  v_add_f32 v22, 1.0, v22
  v_mfma_f32_16x16x32_bf16 v[132:135], v[156:159], a[52:55], v[132:135]
  v_cvt_pk_bf16_f32 v16, v48, v49
  v_add_f32 v23, 1.0, v23
  v_mfma_f32_16x16x32_bf16 v[136:139], v[156:159], a[56:59], v[136:139]
  ds_read_b64_tr_b16 v[154:155], v204 offset:29184
  v_mfma_f32_16x16x32_bf16 v[140:143], v[156:159], a[60:63], v[140:143]
  v_rcp_f32 v20, v20
  s_waitcnt lgkmcnt(8)
  v_mfma_f32_16x16x32_bf16 v[80:83], v[160:163], a[64:67], v[80:83]
  ds_read_b64_tr_b16 v[156:157], v205 offset:28672
  v_cvt_pk_bf16_f32 v17, v50, v51
  v_mfma_f32_16x16x32_bf16 v[84:87], v[160:163], a[68:71], v[84:87]
  v_rcp_f32 v21, v21
  v_mfma_f32_16x16x32_bf16 v[88:91], v[160:163], a[72:75], v[88:91]
  ds_read_b64_tr_b16 v[158:159], v205 offset:29184
  v_mfma_f32_16x16x32_bf16 v[92:95], v[160:163], a[76:79], v[92:95]
  ds_write_b64 v231, v[16:17] offset:16384
  s_waitcnt lgkmcnt(9)
  v_mfma_f32_16x16x32_bf16 v[96:99], v[164:167], a[64:67], v[96:99]
  ds_read_b64_tr_b16 v[160:161], v206 offset:28672
  v_mfma_f32_16x16x32_bf16 v[100:103], v[164:167], a[68:71], v[100:103]
  v_mul_f32 v56, v24, v56
  v_rcp_f32 v22, v22
  v_mfma_f32_16x16x32_bf16 v[104:107], v[164:167], a[72:75], v[104:107]
  ds_read_b64_tr_b16 v[162:163], v206 offset:29184
  v_mfma_f32_16x16x32_bf16 v[108:111], v[164:167], a[76:79], v[108:111]
  v_mul_f32 v57, v25, v57
  v_rcp_f32 v23, v23
  s_waitcnt lgkmcnt(9)
  v_mfma_f32_16x16x32_bf16 v[112:115], v[144:147], a[64:67], v[112:115]
  ds_read_b64_tr_b16 v[164:165], v207 offset:28672
  v_mul_f32 v52, v20, v52
  v_mfma_f32_16x16x32_bf16 v[116:119], v[144:147], a[68:71], v[116:119]
  v_mul_f32 v53, v21, v53
  v_mul_f32 v54, v22, v54
  v_mfma_f32_16x16x32_bf16 v[120:123], v[144:147], a[72:75], v[120:123]
  ds_read_b64_tr_b16 v[166:167], v207 offset:29184
  v_mul_f32 v58, v26, v58
  v_mfma_f32_16x16x32_bf16 v[124:127], v[144:147], a[76:79], v[124:127]
  v_mul_f32 v55, v23, v55
  v_cvt_pk_bf16_f32 v20, v52, v53
  s_waitcnt lgkmcnt(9)
  v_mfma_f32_16x16x32_bf16 v[128:131], v[148:151], a[64:67], v[128:131]
  v_mul_f32 v59, v27, v59
  v_cvt_pk_bf16_f32 v21, v54, v55
  v_mfma_f32_16x16x32_bf16 v[132:135], v[148:151], a[68:71], v[132:135]
  ds_write_b64 v231, v[20:21] offset:18432
  v_mfma_f32_16x16x32_bf16 v[136:139], v[148:151], a[72:75], v[136:139]
  v_mul_f32 v60, v28, v60
  v_mul_f32 v61, v29, v61
  v_mfma_f32_16x16x32_bf16 v[140:143], v[148:151], a[76:79], v[140:143]
  v_mul_f32 v24, s39, v24
  v_mul_f32 v62, v30, v62
  s_waitcnt lgkmcnt(0)
  s_waitcnt vmcnt(6)
  s_barrier
  v_mfma_f32_16x16x32_bf16 v[80:83], v[152:155], a[80:83], v[80:83]
  ds_read_b64_tr_b16 v[144:145], v204 offset:49152
  v_mul_f32 v63, v31, v63
  v_mfma_f32_16x16x32_bf16 v[84:87], v[152:155], a[84:87], v[84:87]
  buffer_load_dwordx4 v219, s[56:59], s38 offen lds
  v_mfma_f32_16x16x32_bf16 v[88:91], v[152:155], a[88:91], v[88:91]
  ds_read_b64_tr_b16 v[146:147], v204 offset:49664
  v_mul_f32 v25, s39, v25
  v_mfma_f32_16x16x32_bf16 v[92:95], v[152:155], a[92:95], v[92:95]
  ds_read_b64_tr_b16 v[148:149], v205 offset:49152
  v_mul_f32 v28, s39, v28
  v_mfma_f32_16x16x32_bf16 v[96:99], v[156:159], a[80:83], v[96:99]
  ds_read_b64_tr_b16 v[150:151], v205 offset:49664
  v_mul_f32 v26, s39, v26
  v_mfma_f32_16x16x32_bf16 v[100:103], v[156:159], a[84:87], v[100:103]
  ds_read_b64_tr_b16 v[152:153], v206 offset:49152
  v_mul_f32 v29, s39, v29
  v_mfma_f32_16x16x32_bf16 v[104:107], v[156:159], a[88:91], v[104:107]
  ds_read_b64_tr_b16 v[154:155], v206 offset:49664
  v_mul_f32 v30, s39, v30
  v_mfma_f32_16x16x32_bf16 v[108:111], v[156:159], a[92:95], v[108:111]
  buffer_load_dwordx4 v220, s[56:59], s38 offen offset:1024 lds
  v_mfma_f32_16x16x32_bf16 v[112:115], v[160:163], a[80:83], v[112:115]
  ds_read_b64_tr_b16 v[156:157], v207 offset:49152
  v_mul_f32 v27, s39, v27
  v_mfma_f32_16x16x32_bf16 v[116:119], v[160:163], a[84:87], v[116:119]
  v_exp_f32 v24, -v24
  v_mfma_f32_16x16x32_bf16 v[120:123], v[160:163], a[88:91], v[120:123]
  ds_read_b64_tr_b16 v[158:159], v207 offset:49664
  v_mul_f32 v31, s39, v31
  v_mfma_f32_16x16x32_bf16 v[124:127], v[160:163], a[92:95], v[124:127]
  buffer_load_dwordx4 v221, s[56:59], s38 offen offset:2048 lds
  s_add_u32 m0, s25, 27648
  s_add_u32 s38, s6, 3981312
  v_mfma_f32_16x16x32_bf16 v[128:131], v[164:167], a[80:83], v[128:131]
  ds_read_b64_tr_b16 v[160:161], v204 offset:51200
  v_mfma_f32_16x16x32_bf16 v[132:135], v[164:167], a[84:87], v[132:135]
  v_exp_f32 v25, -v25
  v_mfma_f32_16x16x32_bf16 v[136:139], v[164:167], a[88:91], v[136:139]
  ds_read_b64_tr_b16 v[162:163], v204 offset:51712
  v_mfma_f32_16x16x32_bf16 v[140:143], v[164:167], a[92:95], v[140:143]
  v_exp_f32 v26, -v26
  s_waitcnt lgkmcnt(8)
  v_mfma_f32_16x16x32_bf16 v[80:83], v[144:147], a[96:99], v[80:83]
  ds_read_b64_tr_b16 v[164:165], v205 offset:51200
  v_mfma_f32_16x16x32_bf16 v[84:87], v[144:147], a[100:103], v[84:87]
  buffer_load_dwordx4 v219, s[56:59], s38 offen lds
  v_mfma_f32_16x16x32_bf16 v[88:91], v[144:147], a[104:107], v[88:91]
  ds_read_b64_tr_b16 v[166:167], v205 offset:51712
  v_mfma_f32_16x16x32_bf16 v[92:95], v[144:147], a[108:111], v[92:95]
  v_exp_f32 v27, -v27
  s_waitcnt lgkmcnt(8)
  v_mfma_f32_16x16x32_bf16 v[96:99], v[148:151], a[96:99], v[96:99]
  ds_read_b64_tr_b16 v[144:145], v206 offset:51200
  v_add_f32 v24, 1.0, v24
  v_mfma_f32_16x16x32_bf16 v[100:103], v[148:151], a[100:103], v[100:103]
  buffer_load_dwordx4 v220, s[56:59], s38 offen offset:1024 lds
  v_mfma_f32_16x16x32_bf16 v[104:107], v[148:151], a[104:107], v[104:107]
  ds_read_b64_tr_b16 v[146:147], v206 offset:51712
  v_add_f32 v25, 1.0, v25
  v_mfma_f32_16x16x32_bf16 v[108:111], v[148:151], a[108:111], v[108:111]
  v_exp_f32 v28, -v28
  s_waitcnt lgkmcnt(8)
  v_mfma_f32_16x16x32_bf16 v[112:115], v[152:155], a[96:99], v[112:115]
  ds_read_b64_tr_b16 v[148:149], v207 offset:51200
  v_mfma_f32_16x16x32_bf16 v[116:119], v[152:155], a[100:103], v[116:119]
  v_add_f32 v26, 1.0, v26
  v_mfma_f32_16x16x32_bf16 v[120:123], v[152:155], a[104:107], v[120:123]
  ds_read_b64_tr_b16 v[150:151], v207 offset:51712
  v_mfma_f32_16x16x32_bf16 v[124:127], v[152:155], a[108:111], v[124:127]
  buffer_load_dwordx4 v221, s[56:59], s38 offen offset:2048 lds
  s_add_u32 m0, s25, 49152
  s_add_u32 s38, s6, 4423680
  s_waitcnt lgkmcnt(8)
  v_mfma_f32_16x16x32_bf16 v[128:131], v[156:159], a[96:99], v[128:131]
  ds_read_b64_tr_b16 v[152:153], v204 offset:53248
  v_add_f32 v27, 1.0, v27
  v_mfma_f32_16x16x32_bf16 v[132:135], v[156:159], a[100:103], v[132:135]
  v_exp_f32 v29, -v29
  v_mfma_f32_16x16x32_bf16 v[136:139], v[156:159], a[104:107], v[136:139]
  ds_read_b64_tr_b16 v[154:155], v204 offset:53760
  v_mfma_f32_16x16x32_bf16 v[140:143], v[156:159], a[108:111], v[140:143]
  v_rcp_f32 v24, v24
  s_waitcnt lgkmcnt(8)
  v_mfma_f32_16x16x32_bf16 v[80:83], v[160:163], a[112:115], v[80:83]
  ds_read_b64_tr_b16 v[156:157], v205 offset:53248
  s_and_b32 s34, s22, 7
  s_mul_i32 s34, s34, 41472
  s_mul_i32 s35, s21, 331776
  s_add_u32 s34, s34, s35
  s_mul_i32 s35, s20, 10368
  s_add_u32 s33, s34, s35
  buffer_load_dwordx4 v[4:7], v243, s[60:63], s33 offen
  v_mfma_f32_16x16x32_bf16 v[84:87], v[160:163], a[116:119], v[84:87]
  v_rcp_f32 v25, v25
  v_mfma_f32_16x16x32_bf16 v[88:91], v[160:163], a[120:123], v[88:91]
  ds_read_b64_tr_b16 v[158:159], v205 offset:53760
  buffer_load_dwordx4 v[4:7], v243, s[60:63], s33 offen offset:1024
  v_mfma_f32_16x16x32_bf16 v[92:95], v[160:163], a[124:127], v[92:95]
  v_rcp_f32 v26, v26
  s_waitcnt lgkmcnt(8)
  v_mfma_f32_16x16x32_bf16 v[96:99], v[164:167], a[112:115], v[96:99]
  ds_read_b64_tr_b16 v[160:161], v206 offset:53248
  buffer_load_dwordx4 v[4:7], v243, s[60:63], s33 offen offset:2048
  v_mfma_f32_16x16x32_bf16 v[100:103], v[164:167], a[116:119], v[100:103]
  v_exp_f32 v30, -v30
  v_mfma_f32_16x16x32_bf16 v[104:107], v[164:167], a[120:123], v[104:107]
  ds_read_b64_tr_b16 v[162:163], v206 offset:53760
  buffer_load_dwordx4 v[4:7], v243, s[60:63], s33 offen offset:3072
  v_mfma_f32_16x16x32_bf16 v[108:111], v[164:167], a[124:127], v[108:111]
  v_rcp_f32 v27, v27
  s_waitcnt lgkmcnt(8)
  v_mfma_f32_16x16x32_bf16 v[112:115], v[144:147], a[112:115], v[112:115]
  ds_read_b64_tr_b16 v[164:165], v207 offset:53248
  v_mul_f32 v56, v24, v56
  v_mfma_f32_16x16x32_bf16 v[116:119], v[144:147], a[116:119], v[116:119]
  v_exp_f32 v31, -v31
  v_mfma_f32_16x16x32_bf16 v[120:123], v[144:147], a[120:123], v[120:123]
  ds_read_b64_tr_b16 v[166:167], v207 offset:53760
  v_add_f32 v28, 1.0, v28
  v_mfma_f32_16x16x32_bf16 v[124:127], v[144:147], a[124:127], v[124:127]
  v_mul_f32 v57, v25, v57
  v_add_f32 v29, 1.0, v29
  s_add_u32 s33, s33, 4096
  s_waitcnt lgkmcnt(8)
  v_mfma_f32_16x16x32_bf16 v[128:131], v[148:151], a[112:115], v[128:131]
  v_add_f32 v30, 1.0, v30
  v_add_f32 v31, 1.0, v31
  v_mfma_f32_16x16x32_bf16 v[132:135], v[148:151], a[116:119], v[132:135]
  v_mul_f32 v58, v26, v58
  v_mfma_f32_16x16x32_bf16 v[136:139], v[148:151], a[120:123], v[136:139]
  v_rcp_f32 v28, v28
  v_mfma_f32_16x16x32_bf16 v[140:143], v[148:151], a[124:127], v[140:143]
  v_rcp_f32 v29, v29
  s_waitcnt lgkmcnt(0)
  s_waitcnt vmcnt(10)
  s_barrier
  v_mfma_f32_16x16x32_bf16 v[80:83], v[152:155], a[128:131], v[80:83]
  ds_read_b64_tr_b16 v[144:145], v204 offset:0
  v_mul_f32 v59, v27, v59
  v_mfma_f32_16x16x32_bf16 v[84:87], v[152:155], a[132:135], v[84:87]
  buffer_load_dwordx4 v219, s[56:59], s38 offen lds
  v_mfma_f32_16x16x32_bf16 v[88:91], v[152:155], a[136:139], v[88:91]
  ds_read_b64_tr_b16 v[146:147], v204 offset:512
  v_cvt_pk_bf16_f32 v24, v56, v57
  v_mfma_f32_16x16x32_bf16 v[92:95], v[152:155], a[140:143], v[92:95]
  ds_read_b64_tr_b16 v[148:149], v205 offset:0
  v_mfma_f32_16x16x32_bf16 v[96:99], v[156:159], a[128:131], v[96:99]
  ds_read_b64_tr_b16 v[150:151], v205 offset:512
  v_mfma_f32_16x16x32_bf16 v[100:103], v[156:159], a[132:135], v[100:103]
  ds_read_b64_tr_b16 v[152:153], v206 offset:0
  v_cvt_pk_bf16_f32 v25, v58, v59
  v_mfma_f32_16x16x32_bf16 v[104:107], v[156:159], a[136:139], v[104:107]
  ds_read_b64_tr_b16 v[154:155], v206 offset:512
  v_mfma_f32_16x16x32_bf16 v[108:111], v[156:159], a[140:143], v[108:111]
  buffer_load_dwordx4 v220, s[56:59], s38 offen offset:1024 lds
  v_mfma_f32_16x16x32_bf16 v[112:115], v[160:163], a[128:131], v[112:115]
  ds_read_b64_tr_b16 v[156:157], v207 offset:0
  buffer_load_dwordx4 v[4:7], v243, s[60:63], s33 offen
  v_mfma_f32_16x16x32_bf16 v[116:119], v[160:163], a[132:135], v[116:119]
  ds_write_b64 v231, v[24:25] offset:20480
  v_mfma_f32_16x16x32_bf16 v[120:123], v[160:163], a[136:139], v[120:123]
  ds_read_b64_tr_b16 v[158:159], v207 offset:512
  v_mul_f32 v64, v32, v64
  v_mfma_f32_16x16x32_bf16 v[124:127], v[160:163], a[140:143], v[124:127]
  buffer_load_dwordx4 v221, s[56:59], s38 offen offset:2048 lds
  s_add_u32 m0, s25, 52224
  s_add_u32 s38, s6, 4866048
  v_mfma_f32_16x16x32_bf16 v[128:131], v[164:167], a[128:131], v[128:131]
  ds_read_b64_tr_b16 v[160:161], v204 offset:2048
  v_rcp_f32 v30, v30
  v_mfma_f32_16x16x32_bf16 v[132:135], v[164:167], a[132:135], v[132:135]
  v_mul_f32 v65, v33, v65
  v_rcp_f32 v31, v31
  v_mfma_f32_16x16x32_bf16 v[136:139], v[164:167], a[136:139], v[136:139]
  ds_read_b64_tr_b16 v[162:163], v204 offset:2560
  v_mul_f32 v60, v28, v60
  v_mfma_f32_16x16x32_bf16 v[140:143], v[164:167], a[140:143], v[140:143]
  v_mul_f32 v66, v34, v66
  v_mul_f32 v61, v29, v61
  s_waitcnt lgkmcnt(9)
  v_mfma_f32_16x16x32_bf16 v[80:83], v[144:147], a[144:147], v[80:83]
  ds_read_b64_tr_b16 v[164:165], v205 offset:2048
  v_mul_f32 v62, v30, v62
  v_mfma_f32_16x16x32_bf16 v[84:87], v[144:147], a[148:151], v[84:87]
  buffer_load_dwordx4 v219, s[56:59], s38 offen lds
  v_mfma_f32_16x16x32_bf16 v[88:91], v[144:147], a[152:155], v[88:91]
  ds_read_b64_tr_b16 v[166:167], v205 offset:2560
  v_mul_f32 v67, v35, v67
  v_mfma_f32_16x16x32_bf16 v[92:95], v[144:147], a[156:159], v[92:95]
  v_mul_f32 v63, v31, v63
  buffer_load_dwordx4 v[4:7], v243, s[60:63], s33 offen offset:1024
  s_waitcnt lgkmcnt(9)
  v_mfma_f32_16x16x32_bf16 v[96:99], v[148:151], a[144:147], v[96:99]
  ds_read_b64_tr_b16 v[144:145], v206 offset:2048
  v_cvt_pk_bf16_f32 v28, v60, v61
  v_mfma_f32_16x16x32_bf16 v[100:103], v[148:151], a[148:151], v[100:103]
  buffer_load_dwordx4 v220, s[56:59], s38 offen offset:1024 lds
  v_mfma_f32_16x16x32_bf16 v[104:107], v[148:151], a[152:155], v[104:107]
  ds_read_b64_tr_b16 v[146:147], v206 offset:2560
  v_mul_f32 v32, s39, v32
  v_mfma_f32_16x16x32_bf16 v[108:111], v[148:151], a[156:159], v[108:111]
  v_mul_f32 v33, s39, v33
  v_cvt_pk_bf16_f32 v29, v62, v63
  s_waitcnt lgkmcnt(9)
  v_mfma_f32_16x16x32_bf16 v[112:115], v[152:155], a[144:147], v[112:115]
  ds_read_b64_tr_b16 v[148:149], v207 offset:2048
  v_mfma_f32_16x16x32_bf16 v[116:119], v[152:155], a[148:151], v[116:119]
  ds_write_b64 v231, v[28:29] offset:22528
  v_mfma_f32_16x16x32_bf16 v[120:123], v[152:155], a[152:155], v[120:123]
  ds_read_b64_tr_b16 v[150:151], v207 offset:2560
  v_mul_f32 v34, s39, v34
  v_mfma_f32_16x16x32_bf16 v[124:127], v[152:155], a[156:159], v[124:127]
  buffer_load_dwordx4 v221, s[56:59], s38 offen offset:2048 lds
  s_add_u32 m0, s25, 0
  s_add_u32 s38, s7, 0
  s_waitcnt lgkmcnt(9)
  v_mfma_f32_16x16x32_bf16 v[128:131], v[156:159], a[144:147], v[128:131]
  ds_read_b64_tr_b16 v[152:153], v204 offset:4096
  v_mul_f32 v35, s39, v35
  v_mfma_f32_16x16x32_bf16 v[132:135], v[156:159], a[148:151], v[132:135]
  v_mul_f32 v68, v36, v68
  v_mul_f32 v69, v37, v69
  v_mfma_f32_16x16x32_bf16 v[136:139], v[156:159], a[152:155], v[136:139]
  ds_read_b64_tr_b16 v[154:155], v204 offset:4608
  v_mul_f32 v70, v38, v70
  v_mfma_f32_16x16x32_bf16 v[140:143], v[156:159], a[156:159], v[140:143]
  v_exp_f32 v32, -v32
  s_waitcnt lgkmcnt(9)
  v_mfma_f32_16x16x32_bf16 v[80:83], v[160:163], a[160:163], v[80:83]
  ds_read_b64_tr_b16 v[156:157], v205 offset:4096
  v_mul_f32 v71, v39, v71
  v_mfma_f32_16x16x32_bf16 v[84:87], v[160:163], a[164:167], v[84:87]
  v_exp_f32 v33, -v33
  v_mfma_f32_16x16x32_bf16 v[88:91], v[160:163], a[168:171], v[88:91]
  ds_read_b64_tr_b16 v[158:159], v205 offset:4608
  v_mul_f32 v36, s39, v36
  v_mfma_f32_16x16x32_bf16 v[92:95], v[160:163], a[172:175], v[92:95]
  v_mul_f32 v37, s39, v37
  buffer_load_dwordx4 v[4:7], v243, s[60:63], s33 offen offset:2048
  s_waitcnt lgkmcnt(9)
  v_mfma_f32_16x16x32_bf16 v[96:99], v[164:167], a[160:163], v[96:99]
  ds_read_b64_tr_b16 v[160:161], v206 offset:4096
  v_mul_f32 v38, s39, v38
  v_mfma_f32_16x16x32_bf16 v[100:103], v[164:167], a[164:167], v[100:103]
  v_exp_f32 v34, -v34
  v_mfma_f32_16x16x32_bf16 v[104:107], v[164:167], a[168:171], v[104:107]
  ds_read_b64_tr_b16 v[162:163], v206 offset:4608
  v_mul_f32 v39, s39, v39
  v_mfma_f32_16x16x32_bf16 v[108:111], v[164:167], a[172:175], v[108:111]
  v_exp_f32 v35, -v35
  s_waitcnt lgkmcnt(9)
  v_mfma_f32_16x16x32_bf16 v[112:115], v[144:147], a[160:163], v[112:115]
  ds_read_b64_tr_b16 v[164:165], v207 offset:4096
  v_mfma_f32_16x16x32_bf16 v[116:119], v[144:147], a[164:167], v[116:119]
  v_add_f32 v32, 1.0, v32
  v_mfma_f32_16x16x32_bf16 v[120:123], v[144:147], a[168:171], v[120:123]
  ds_read_b64_tr_b16 v[166:167], v207 offset:4608
  v_mfma_f32_16x16x32_bf16 v[124:127], v[144:147], a[172:175], v[124:127]
  v_exp_f32 v36, -v36
  s_waitcnt lgkmcnt(8)
  v_mfma_f32_16x16x32_bf16 v[128:131], v[148:151], a[160:163], v[128:131]
  v_add_f32 v33, 1.0, v33
  buffer_load_dwordx4 v[4:7], v243, s[60:63], s33 offen offset:3072
  v_mfma_f32_16x16x32_bf16 v[132:135], v[148:151], a[164:167], v[132:135]
  v_exp_f32 v37, -v37
  v_mfma_f32_16x16x32_bf16 v[136:139], v[148:151], a[168:171], v[136:139]
  v_add_f32 v34, 1.0, v34
  v_mfma_f32_16x16x32_bf16 v[140:143], v[148:151], a[172:175], v[140:143]
  v_exp_f32 v38, -v38
  s_waitcnt lgkmcnt(0)
  s_waitcnt vmcnt(14)
  s_barrier
  v_mfma_f32_16x16x32_bf16 v[80:83], v[152:155], a[176:179], v[80:83]
  ds_read_b64_tr_b16 v[144:145], v204 offset:24576
  v_mfma_f32_16x16x32_bf16 v[84:87], v[152:155], a[180:183], v[84:87]
  buffer_load_dwordx4 v219, s[56:59], s38 offen lds
  v_mfma_f32_16x16x32_bf16 v[88:91], v[152:155], a[184:187], v[88:91]
  ds_read_b64_tr_b16 v[146:147], v204 offset:25088
  v_add_f32 v35, 1.0, v35
  v_mfma_f32_16x16x32_bf16 v[92:95], v[152:155], a[188:191], v[92:95]
  ds_read_b64_tr_b16 v[148:149], v205 offset:24576
  v_mfma_f32_16x16x32_bf16 v[96:99], v[156:159], a[176:179], v[96:99]
  ds_read_b64_tr_b16 v[150:151], v205 offset:25088
  v_mfma_f32_16x16x32_bf16 v[100:103], v[156:159], a[180:183], v[100:103]
  ds_read_b64_tr_b16 v[152:153], v206 offset:24576
  v_mfma_f32_16x16x32_bf16 v[104:107], v[156:159], a[184:187], v[104:107]
  ds_read_b64_tr_b16 v[154:155], v206 offset:25088
  s_add_u32 s33, s33, 4096
  v_mfma_f32_16x16x32_bf16 v[108:111], v[156:159], a[188:191], v[108:111]
  buffer_load_dwordx4 v220, s[56:59], s38 offen offset:1024 lds
  v_mfma_f32_16x16x32_bf16 v[112:115], v[160:163], a[176:179], v[112:115]
  ds_read_b64_tr_b16 v[156:157], v207 offset:24576
  v_mfma_f32_16x16x32_bf16 v[116:119], v[160:163], a[180:183], v[116:119]
  v_rcp_f32 v32, v32
  v_mfma_f32_16x16x32_bf16 v[120:123], v[160:163], a[184:187], v[120:123]
  ds_read_b64_tr_b16 v[158:159], v207 offset:25088
  v_mfma_f32_16x16x32_bf16 v[124:127], v[160:163], a[188:191], v[124:127]
  buffer_load_dwordx4 v221, s[56:59], s38 offen offset:2048 lds
  s_add_u32 m0, s25, 3072
  s_add_u32 s38, s7, 442368
  v_mfma_f32_16x16x32_bf16 v[128:131], v[164:167], a[176:179], v[128:131]
  ds_read_b64_tr_b16 v[160:161], v204 offset:26624
  v_mfma_f32_16x16x32_bf16 v[132:135], v[164:167], a[180:183], v[132:135]
  v_rcp_f32 v33, v33
  v_mfma_f32_16x16x32_bf16 v[136:139], v[164:167], a[184:187], v[136:139]
  ds_read_b64_tr_b16 v[162:163], v204 offset:27136
  v_exp_f32 v39, -v39
  v_mfma_f32_16x16x32_bf16 v[140:143], v[164:167], a[188:191], v[140:143]
  v_rcp_f32 v34, v34
  s_waitcnt lgkmcnt(8)
  v_mfma_f32_16x16x32_bf16 v[80:83], v[144:147], a[192:195], v[80:83]
  ds_read_b64_tr_b16 v[164:165], v205 offset:26624
  v_add_f32 v36, 1.0, v36
  v_mfma_f32_16x16x32_bf16 v[84:87], v[144:147], a[196:199], v[84:87]
  buffer_load_dwordx4 v219, s[56:59], s38 offen lds
  v_mfma_f32_16x16x32_bf16 v[88:91], v[144:147], a[200:203], v[88:91]
  ds_read_b64_tr_b16 v[166:167], v205 offset:27136
  v_add_f32 v37, 1.0, v37
  v_mfma_f32_16x16x32_bf16 v[92:95], v[144:147], a[204:207], v[92:95]
  v_rcp_f32 v35, v35
  s_waitcnt lgkmcnt(8)
  v_mfma_f32_16x16x32_bf16 v[96:99], v[148:151], a[192:195], v[96:99]
  ds_read_b64_tr_b16 v[144:145], v206 offset:26624
  v_mul_f32 v64, v32, v64
  v_mfma_f32_16x16x32_bf16 v[100:103], v[148:151], a[196:199], v[100:103]
  buffer_load_dwordx4 v220, s[56:59], s38 offen offset:1024 lds
  v_mfma_f32_16x16x32_bf16 v[104:107], v[148:151], a[200:203], v[104:107]
  ds_read_b64_tr_b16 v[146:147], v206 offset:27136
  v_mul_f32 v65, v33, v65
  v_mfma_f32_16x16x32_bf16 v[108:111], v[148:151], a[204:207], v[108:111]
  v_mul_f32 v66, v34, v66
  v_add_f32 v38, 1.0, v38
  s_waitcnt lgkmcnt(8)
  v_mfma_f32_16x16x32_bf16 v[112:115], v[152:155], a[192:195], v[112:115]
  ds_read_b64_tr_b16 v[148:149], v207 offset:26624
  v_mul_f32 v67, v35, v67
  v_mfma_f32_16x16x32_bf16 v[116:119], v[152:155], a[196:199], v[116:119]
  v_cvt_pk_bf16_f32 v32, v64, v65
  v_add_f32 v39, 1.0, v39
  v_mfma_f32_16x16x32_bf16 v[120:123], v[152:155], a[200:203], v[120:123]
  ds_read_b64_tr_b16 v[150:151], v207 offset:27136
  buffer_load_dwordx4 v[4:7], v243, s[60:63], s33 offen
  v_mfma_f32_16x16x32_bf16 v[124:127], v[152:155], a[204:207], v[124:127]
  buffer_load_dwordx4 v221, s[56:59], s38 offen offset:2048 lds
  s_add_u32 m0, s25, 24576
  s_add_u32 s38, s7, 884736
  s_waitcnt lgkmcnt(8)
  v_mfma_f32_16x16x32_bf16 v[128:131], v[156:159], a[192:195], v[128:131]
  ds_read_b64_tr_b16 v[152:153], v204 offset:28672
  v_cvt_pk_bf16_f32 v33, v66, v67
  v_mfma_f32_16x16x32_bf16 v[132:135], v[156:159], a[196:199], v[132:135]
  ds_write_b64 v232, v[32:33] offset:16384
  v_mfma_f32_16x16x32_bf16 v[136:139], v[156:159], a[200:203], v[136:139]
  ds_read_b64_tr_b16 v[154:155], v204 offset:29184
  v_rcp_f32 v36, v36
  v_mfma_f32_16x16x32_bf16 v[140:143], v[156:159], a[204:207], v[140:143]
  v_rcp_f32 v37, v37
  s_waitcnt lgkmcnt(9)
  v_mfma_f32_16x16x32_bf16 v[80:83], v[160:163], a[208:211], v[80:83]
  ds_read_b64_tr_b16 v[156:157], v205 offset:28672
  v_mul_f32 v72, v40, v72
  v_mfma_f32_16x16x32_bf16 v[84:87], v[160:163], a[212:215], v[84:87]
  v_rcp_f32 v38, v38
  v_mfma_f32_16x16x32_bf16 v[88:91], v[160:163], a[216:219], v[88:91]
  ds_read_b64_tr_b16 v[158:159], v205 offset:29184
  v_mul_f32 v73, v41, v73
  v_mfma_f32_16x16x32_bf16 v[92:95], v[160:163], a[220:223], v[92:95]
  v_rcp_f32 v39, v39
  s_waitcnt lgkmcnt(9)
  v_mfma_f32_16x16x32_bf16 v[96:99], v[164:167], a[208:211], v[96:99]
  ds_read_b64_tr_b16 v[160:161], v206 offset:28672
  v_mul_f32 v68, v36, v68
  v_mfma_f32_16x16x32_bf16 v[100:103], v[164:167], a[212:215], v[100:103]
  v_mul_f32 v74, v42, v74
  v_mul_f32 v69, v37, v69
  v_mfma_f32_16x16x32_bf16 v[104:107], v[164:167], a[216:219], v[104:107]
  ds_read_b64_tr_b16 v[162:163], v206 offset:29184
  v_mul_f32 v70, v38, v70
  v_mfma_f32_16x16x32_bf16 v[108:111], v[164:167], a[220:223], v[108:111]
  v_mul_f32 v75, v43, v75
  v_mul_f32 v71, v39, v71
  s_waitcnt lgkmcnt(9)
  v_mfma_f32_16x16x32_bf16 v[112:115], v[144:147], a[208:211], v[112:115]
  ds_read_b64_tr_b16 v[164:165], v207 offset:28672
  v_cvt_pk_bf16_f32 v36, v68, v69
  v_mfma_f32_16x16x32_bf16 v[116:119], v[144:147], a[212:215], v[116:119]
  v_cvt_pk_bf16_f32 v37, v70, v71
  buffer_load_dwordx4 v[4:7], v243, s[60:63], s33 offen offset:1024
  v_mfma_f32_16x16x32_bf16 v[120:123], v[144:147], a[216:219], v[120:123]
  ds_read_b64_tr_b16 v[166:167], v207 offset:29184
  v_mul_f32 v40, s39, v40
  v_mfma_f32_16x16x32_bf16 v[124:127], v[144:147], a[220:223], v[124:127]
  ds_write_b64 v232, v[36:37] offset:18432
  s_waitcnt lgkmcnt(10)
  v_mfma_f32_16x16x32_bf16 v[128:131], v[148:151], a[208:211], v[128:131]
  v_mul_f32 v76, v44, v76
  buffer_load_dwordx4 v[4:7], v243, s[60:63], s33 offen offset:2048
  v_mfma_f32_16x16x32_bf16 v[132:135], v[148:151], a[212:215], v[132:135]
  v_mul_f32 v41, s39, v41
  v_mul_f32 v77, v45, v77
  v_mfma_f32_16x16x32_bf16 v[136:139], v[148:151], a[216:219], v[136:139]
  v_mul_f32 v78, v46, v78
  v_mul_f32 v79, v47, v79
  v_mfma_f32_16x16x32_bf16 v[140:143], v[148:151], a[220:223], v[140:143]
  v_mul_f32 v42, s39, v42
  v_mul_f32 v44, s39, v44
  s_waitcnt lgkmcnt(0)
  s_waitcnt vmcnt(11)
  s_barrier
  v_mfma_f32_16x16x32_bf16 v[80:83], v[152:155], a[224:227], v[80:83]
  ds_read_b64_tr_b16 v[144:145], v204 offset:49152
  v_mul_f32 v45, s39, v45
  v_mfma_f32_16x16x32_bf16 v[84:87], v[152:155], a[228:231], v[84:87]
  buffer_load_dwordx4 v219, s[56:59], s38 offen lds
  v_mfma_f32_16x16x32_bf16 v[88:91], v[152:155], a[232:235], v[88:91]
  ds_read_b64_tr_b16 v[146:147], v204 offset:49664
  v_mul_f32 v43, s39, v43
  v_mfma_f32_16x16x32_bf16 v[92:95], v[152:155], a[236:239], v[92:95]
  ds_read_b64_tr_b16 v[148:149], v205 offset:49152
  v_mul_f32 v46, s39, v46
  v_mfma_f32_16x16x32_bf16 v[96:99], v[156:159], a[224:227], v[96:99]
  ds_read_b64_tr_b16 v[150:151], v205 offset:49664
  v_mul_f32 v47, s39, v47
  v_mfma_f32_16x16x32_bf16 v[100:103], v[156:159], a[228:231], v[100:103]
  ds_read_b64_tr_b16 v[152:153], v206 offset:49152
  v_mfma_f32_16x16x32_bf16 v[104:107], v[156:159], a[232:235], v[104:107]
  ds_read_b64_tr_b16 v[154:155], v206 offset:49664
  s_and_b32 s34, s22, 7
  s_mul_i32 s34, s34, 5184
  s_add_u32 s34, s34, s16
  s_mul_i32 s35, s20, 1296
  s_add_u32 s33, s34, s35
  v_mfma_f32_16x16x32_bf16 v[108:111], v[156:159], a[236:239], v[108:111]
  buffer_load_dwordx4 v220, s[56:59], s38 offen offset:1024 lds
  v_mfma_f32_16x16x32_bf16 v[112:115], v[160:163], a[224:227], v[112:115]
  ds_read_b64_tr_b16 v[156:157], v207 offset:49152
  v_mfma_f32_16x16x32_bf16 v[116:119], v[160:163], a[228:231], v[116:119]
  v_exp_f32 v40, -v40
  v_mfma_f32_16x16x32_bf16 v[120:123], v[160:163], a[232:235], v[120:123]
  ds_read_b64_tr_b16 v[158:159], v207 offset:49664
  v_mfma_f32_16x16x32_bf16 v[124:127], v[160:163], a[236:239], v[124:127]
  buffer_load_dwordx4 v221, s[56:59], s38 offen offset:2048 lds
  s_add_u32 m0, s25, 27648
  s_add_u32 s38, s7, 1327104
  v_mfma_f32_16x16x32_bf16 v[128:131], v[164:167], a[224:227], v[128:131]
  ds_read_b64_tr_b16 v[160:161], v204 offset:51200
  v_mfma_f32_16x16x32_bf16 v[132:135], v[164:167], a[228:231], v[132:135]
  v_exp_f32 v41, -v41
  v_mfma_f32_16x16x32_bf16 v[136:139], v[164:167], a[232:235], v[136:139]
  ds_read_b64_tr_b16 v[162:163], v204 offset:51712
  v_mfma_f32_16x16x32_bf16 v[140:143], v[164:167], a[236:239], v[140:143]
  v_exp_f32 v42, -v42
  s_waitcnt lgkmcnt(8)
  v_mfma_f32_16x16x32_bf16 v[80:83], v[144:147], a[240:243], v[80:83]
  ds_read_b64_tr_b16 v[164:165], v205 offset:51200
  v_mfma_f32_16x16x32_bf16 v[84:87], v[144:147], a[244:247], v[84:87]
  buffer_load_dwordx4 v219, s[56:59], s38 offen lds
  v_mfma_f32_16x16x32_bf16 v[88:91], v[144:147], a[248:251], v[88:91]
  ds_read_b64_tr_b16 v[166:167], v205 offset:51712
  buffer_load_dwordx4 v[4:7], v243, s[64:67], s33 offen
  v_mfma_f32_16x16x32_bf16 v[92:95], v[144:147], a[252:255], v[92:95]
  v_exp_f32 v43, -v43
  s_waitcnt lgkmcnt(8)
  v_mfma_f32_16x16x32_bf16 v[96:99], v[148:151], a[240:243], v[96:99]
  ds_read_b64_tr_b16 v[144:145], v206 offset:51200
  v_add_f32 v40, 1.0, v40
  v_mfma_f32_16x16x32_bf16 v[100:103], v[148:151], a[244:247], v[100:103]
  buffer_load_dwordx4 v220, s[56:59], s38 offen offset:1024 lds
  v_mfma_f32_16x16x32_bf16 v[104:107], v[148:151], a[248:251], v[104:107]
  ds_read_b64_tr_b16 v[146:147], v206 offset:51712
  v_add_f32 v41, 1.0, v41
  v_mfma_f32_16x16x32_bf16 v[108:111], v[148:151], a[252:255], v[108:111]
  v_add_f32 v42, 1.0, v42
  v_add_f32 v43, 1.0, v43
  s_waitcnt lgkmcnt(8)
  v_mfma_f32_16x16x32_bf16 v[112:115], v[152:155], a[240:243], v[112:115]
  ds_read_b64_tr_b16 v[148:149], v207 offset:51200
  v_mfma_f32_16x16x32_bf16 v[116:119], v[152:155], a[244:247], v[116:119]
  v_rcp_f32 v40, v40
  v_mfma_f32_16x16x32_bf16 v[120:123], v[152:155], a[248:251], v[120:123]
  ds_read_b64_tr_b16 v[150:151], v207 offset:51712
  v_mfma_f32_16x16x32_bf16 v[124:127], v[152:155], a[252:255], v[124:127]
  buffer_load_dwordx4 v221, s[56:59], s38 offen offset:2048 lds
  s_add_u32 m0, s25, 49152
  s_add_u32 s38, s7, 1769472
  s_waitcnt lgkmcnt(8)
  v_mfma_f32_16x16x32_bf16 v[128:131], v[156:159], a[240:243], v[128:131]
  ds_read_b64_tr_b16 v[152:153], v204 offset:53248
  v_exp_f32 v44, -v44
  v_mfma_f32_16x16x32_bf16 v[132:135], v[156:159], a[244:247], v[132:135]
  v_rcp_f32 v41, v41
  v_mfma_f32_16x16x32_bf16 v[136:139], v[156:159], a[248:251], v[136:139]
  ds_read_b64_tr_b16 v[154:155], v204 offset:53760
  v_exp_f32 v45, -v45
  v_mfma_f32_16x16x32_bf16 v[140:143], v[156:159], a[252:255], v[140:143]
  v_rcp_f32 v42, v42
  s_waitcnt lgkmcnt(8)
  v_mfma_f32_16x16x32_bf16 v[80:83], v[160:163], v[168:171], v[80:83]
  ds_read_b64_tr_b16 v[156:157], v205 offset:53248
  buffer_load_dwordx4 v[4:7], v243, s[64:67], s33 offen offset:1024
  v_mfma_f32_16x16x32_bf16 v[84:87], v[160:163], v[172:175], v[84:87]
  v_rcp_f32 v43, v43
  v_mfma_f32_16x16x32_bf16 v[88:91], v[160:163], v[176:179], v[88:91]
  ds_read_b64_tr_b16 v[158:159], v205 offset:53760
  v_exp_f32 v46, -v46
  v_mfma_f32_16x16x32_bf16 v[92:95], v[160:163], v[180:183], v[92:95]
  v_mul_f32 v72, v40, v72
  v_exp_f32 v47, -v47
  s_waitcnt lgkmcnt(8)
  v_mfma_f32_16x16x32_bf16 v[96:99], v[164:167], v[168:171], v[96:99]
  ds_read_b64_tr_b16 v[160:161], v206 offset:53248
  v_add_f32 v44, 1.0, v44
  v_mfma_f32_16x16x32_bf16 v[100:103], v[164:167], v[172:175], v[100:103]
  v_add_f32 v45, 1.0, v45
  v_add_f32 v46, 1.0, v46
  v_mfma_f32_16x16x32_bf16 v[104:107], v[164:167], v[176:179], v[104:107]
  ds_read_b64_tr_b16 v[162:163], v206 offset:53760
  v_mul_f32 v73, v41, v73
  v_mfma_f32_16x16x32_bf16 v[108:111], v[164:167], v[180:183], v[108:111]
  v_add_f32 v47, 1.0, v47
  s_waitcnt lgkmcnt(8)
  v_mfma_f32_16x16x32_bf16 v[112:115], v[144:147], v[168:171], v[112:115]
  ds_read_b64_tr_b16 v[164:165], v207 offset:53248
  v_mul_f32 v74, v42, v74
  v_mfma_f32_16x16x32_bf16 v[116:119], v[144:147], v[172:175], v[116:119]
  v_rcp_f32 v44, v44
  v_mfma_f32_16x16x32_bf16 v[120:123], v[144:147], v[176:179], v[120:123]
  ds_read_b64_tr_b16 v[166:167], v207 offset:53760
  v_mfma_f32_16x16x32_bf16 v[124:127], v[144:147], v[180:183], v[124:127]
  v_mul_f32 v75, v43, v75
  s_waitcnt lgkmcnt(8)
  v_mfma_f32_16x16x32_bf16 v[128:131], v[148:151], v[168:171], v[128:131]
  v_rcp_f32 v45, v45
  v_mfma_f32_16x16x32_bf16 v[132:135], v[148:151], v[172:175], v[132:135]
  v_cvt_pk_bf16_f32 v40, v72, v73
  v_mfma_f32_16x16x32_bf16 v[136:139], v[148:151], v[176:179], v[136:139]
  v_rcp_f32 v46, v46
  v_mfma_f32_16x16x32_bf16 v[140:143], v[148:151], v[180:183], v[140:143]
  v_rcp_f32 v47, v47
  s_waitcnt lgkmcnt(0)
  s_waitcnt vmcnt(10)
  s_barrier
  v_mfma_f32_16x16x32_bf16 v[80:83], v[152:155], v[184:187], v[80:83]
  ds_read_b64_tr_b16 v[144:145], v204 offset:0
  v_cvt_pk_bf16_f32 v41, v74, v75
  v_mfma_f32_16x16x32_bf16 v[84:87], v[152:155], v[188:191], v[84:87]
  buffer_load_dwordx4 v219, s[56:59], s38 offen lds
  v_mfma_f32_16x16x32_bf16 v[88:91], v[152:155], v[192:195], v[88:91]
  ds_read_b64_tr_b16 v[146:147], v204 offset:512
  v_mul_f32 v76, v44, v76
  v_mfma_f32_16x16x32_bf16 v[92:95], v[152:155], v[196:199], v[92:95]
  ds_read_b64_tr_b16 v[148:149], v205 offset:0
  v_mul_f32 v77, v45, v77
  v_mfma_f32_16x16x32_bf16 v[96:99], v[156:159], v[184:187], v[96:99]
  ds_read_b64_tr_b16 v[150:151], v205 offset:512
  v_mul_f32 v78, v46, v78
  v_mfma_f32_16x16x32_bf16 v[100:103], v[156:159], v[188:191], v[100:103]
  ds_read_b64_tr_b16 v[152:153], v206 offset:0
  v_mul_f32 v79, v47, v79
  v_mfma_f32_16x16x32_bf16 v[104:107], v[156:159], v[192:195], v[104:107]
  ds_read_b64_tr_b16 v[154:155], v206 offset:512
  v_cvt_pk_bf16_f32 v44, v76, v77
  v_mfma_f32_16x16x32_bf16 v[108:111], v[156:159], v[196:199], v[108:111]
  buffer_load_dwordx4 v220, s[56:59], s38 offen offset:1024 lds
  v_mfma_f32_16x16x32_bf16 v[112:115], v[160:163], v[184:187], v[112:115]
  ds_read_b64_tr_b16 v[156:157], v207 offset:0
  v_cvt_pk_bf16_f32 v45, v78, v79
  v_mfma_f32_16x16x32_bf16 v[116:119], v[160:163], v[188:191], v[116:119]
  ds_write_b64 v232, v[40:41] offset:20480
  v_mfma_f32_16x16x32_bf16 v[120:123], v[160:163], v[192:195], v[120:123]
  ds_read_b64_tr_b16 v[158:159], v207 offset:512
  v_mfma_f32_16x16x32_bf16 v[124:127], v[160:163], v[196:199], v[124:127]
  buffer_load_dwordx4 v221, s[56:59], s38 offen offset:2048 lds
  s_add_u32 m0, s25, 52224
  s_add_u32 s38, s7, 2211840
  v_mfma_f32_16x16x32_bf16 v[128:131], v[164:167], v[184:187], v[128:131]
  ds_read_b64_tr_b16 v[160:161], v204 offset:2048
  v_mfma_f32_16x16x32_bf16 v[132:135], v[164:167], v[188:191], v[132:135]
  ds_write_b64 v232, v[44:45] offset:22528
  v_mfma_f32_16x16x32_bf16 v[136:139], v[164:167], v[192:195], v[136:139]
  ds_read_b64_tr_b16 v[162:163], v204 offset:2560
  v_mfma_f32_16x16x32_bf16 v[140:143], v[164:167], v[196:199], v[140:143]
  s_waitcnt lgkmcnt(10)
  v_mfma_f32_16x16x32_bf16 v[16:19], v[144:147], a[0:3], 0
  ds_read_b64_tr_b16 v[164:165], v205 offset:2048
  v_mfma_f32_16x16x32_bf16 v[20:23], v[144:147], a[4:7], 0
  buffer_load_dwordx4 v219, s[56:59], s38 offen lds
  v_mfma_f32_16x16x32_bf16 v[24:27], v[144:147], a[8:11], 0
  ds_read_b64_tr_b16 v[166:167], v205 offset:2560
  v_mfma_f32_16x16x32_bf16 v[28:31], v[144:147], a[12:15], 0
  s_waitcnt lgkmcnt(10)
  v_mfma_f32_16x16x32_bf16 v[32:35], v[148:151], a[0:3], 0
  ds_read_b64_tr_b16 v[144:145], v206 offset:2048
  v_mfma_f32_16x16x32_bf16 v[36:39], v[148:151], a[4:7], 0
  buffer_load_dwordx4 v220, s[56:59], s38 offen offset:1024 lds
  v_mfma_f32_16x16x32_bf16 v[40:43], v[148:151], a[8:11], 0
  ds_read_b64_tr_b16 v[146:147], v206 offset:2560
  v_mfma_f32_16x16x32_bf16 v[44:47], v[148:151], a[12:15], 0
  s_waitcnt lgkmcnt(10)
  v_mfma_f32_16x16x32_bf16 v[48:51], v[152:155], a[0:3], 0
  ds_read_b64_tr_b16 v[148:149], v207 offset:2048
  v_mfma_f32_16x16x32_bf16 v[52:55], v[152:155], a[4:7], 0
  v_mfma_f32_16x16x32_bf16 v[56:59], v[152:155], a[8:11], 0
  ds_read_b64_tr_b16 v[150:151], v207 offset:2560
  v_mul_f32 v112, v80, v112
  v_mfma_f32_16x16x32_bf16 v[60:63], v[152:155], a[12:15], 0
  buffer_load_dwordx4 v221, s[56:59], s38 offen offset:2048 lds
  s_add_u32 m0, s25, 0
  s_add_u32 s38, s7, 2654208
  s_waitcnt lgkmcnt(9)
  v_mfma_f32_16x16x32_bf16 v[64:67], v[156:159], a[0:3], 0
  ds_read_b64_tr_b16 v[152:153], v204 offset:4096
  v_mul_f32 v113, v81, v113
  v_mfma_f32_16x16x32_bf16 v[68:71], v[156:159], a[4:7], 0
  v_mul_f32 v114, v82, v114
  v_mul_f32 v116, v84, v116
  v_mfma_f32_16x16x32_bf16 v[72:75], v[156:159], a[8:11], 0
  ds_read_b64_tr_b16 v[154:155], v204 offset:4608
  v_mul_f32 v115, v83, v115
  v_mfma_f32_16x16x32_bf16 v[76:79], v[156:159], a[12:15], 0
  v_mul_f32 v80, s39, v80
  v_mul_f32 v117, v85, v117
  s_waitcnt lgkmcnt(8)
  v_mfma_f32_16x16x32_bf16 v[16:19], v[160:163], a[16:19], v[16:19]
  ds_read_b64_tr_b16 v[156:157], v205 offset:4096
  v_mul_f32 v81, s39, v81
  v_mfma_f32_16x16x32_bf16 v[20:23], v[160:163], a[20:23], v[20:23]
  v_mul_f32 v82, s39, v82
  v_mul_f32 v118, v86, v118
  v_mfma_f32_16x16x32_bf16 v[24:27], v[160:163], a[24:27], v[24:27]
  ds_read_b64_tr_b16 v[158:159], v205 offset:4608
  v_mul_f32 v83, s39, v83
  v_mfma_f32_16x16x32_bf16 v[28:31], v[160:163], a[28:31], v[28:31]
  v_mul_f32 v119, v87, v119
  v_mul_f32 v84, s39, v84
  s_waitcnt lgkmcnt(8)
  v_mfma_f32_16x16x32_bf16 v[32:35], v[164:167], a[16:19], v[32:35]
  ds_read_b64_tr_b16 v[160:161], v206 offset:4096
  v_mul_f32 v85, s39, v85
  v_mfma_f32_16x16x32_bf16 v[36:39], v[164:167], a[20:23], v[36:39]
  v_exp_f32 v80, -v80
  v_mfma_f32_16x16x32_bf16 v[40:43], v[164:167], a[24:27], v[40:43]
  ds_read_b64_tr_b16 v[162:163], v206 offset:4608
  v_mul_f32 v86, s39, v86
  v_mfma_f32_16x16x32_bf16 v[44:47], v[164:167], a[28:31], v[44:47]
  v_exp_f32 v81, -v81
  s_waitcnt lgkmcnt(8)
  v_mfma_f32_16x16x32_bf16 v[48:51], v[144:147], a[16:19], v[48:51]
  ds_read_b64_tr_b16 v[164:165], v207 offset:4096
  v_mul_f32 v87, s39, v87
  v_mfma_f32_16x16x32_bf16 v[52:55], v[144:147], a[20:23], v[52:55]
  v_exp_f32 v82, -v82
  v_mfma_f32_16x16x32_bf16 v[56:59], v[144:147], a[24:27], v[56:59]
  ds_read_b64_tr_b16 v[166:167], v207 offset:4608
  v_mfma_f32_16x16x32_bf16 v[60:63], v[144:147], a[28:31], v[60:63]
  v_exp_f32 v84, -v84
  s_waitcnt lgkmcnt(8)
  v_mfma_f32_16x16x32_bf16 v[64:67], v[148:151], a[16:19], v[64:67]
  v_exp_f32 v83, -v83
  v_mfma_f32_16x16x32_bf16 v[68:71], v[148:151], a[20:23], v[68:71]
  v_exp_f32 v85, -v85
  v_mfma_f32_16x16x32_bf16 v[72:75], v[148:151], a[24:27], v[72:75]
  v_add_f32 v80, 1.0, v80
  v_mfma_f32_16x16x32_bf16 v[76:79], v[148:151], a[28:31], v[76:79]
  v_exp_f32 v86, -v86
  s_waitcnt lgkmcnt(0)
  s_waitcnt vmcnt(7)
  s_barrier
  v_mfma_f32_16x16x32_bf16 v[16:19], v[152:155], a[32:35], v[16:19]
  ds_read_b64_tr_b16 v[144:145], v204 offset:24576
  v_mfma_f32_16x16x32_bf16 v[20:23], v[152:155], a[36:39], v[20:23]
  buffer_load_dwordx4 v219, s[56:59], s38 offen lds
  v_mfma_f32_16x16x32_bf16 v[24:27], v[152:155], a[40:43], v[24:27]
  ds_read_b64_tr_b16 v[146:147], v204 offset:25088
  v_add_f32 v81, 1.0, v81
  v_mfma_f32_16x16x32_bf16 v[28:31], v[152:155], a[44:47], v[28:31]
  ds_read_b64_tr_b16 v[148:149], v205 offset:24576
  v_add_f32 v82, 1.0, v82
  v_mfma_f32_16x16x32_bf16 v[32:35], v[156:159], a[32:35], v[32:35]
  ds_read_b64_tr_b16 v[150:151], v205 offset:25088
  v_mfma_f32_16x16x32_bf16 v[36:39], v[156:159], a[36:39], v[36:39]
  ds_read_b64_tr_b16 v[152:153], v206 offset:24576
  v_mfma_f32_16x16x32_bf16 v[40:43], v[156:159], a[40:43], v[40:43]
  ds_read_b64_tr_b16 v[154:155], v206 offset:25088
  v_add_f32 v83, 1.0, v83
  v_mfma_f32_16x16x32_bf16 v[44:47], v[156:159], a[44:47], v[44:47]
  buffer_load_dwordx4 v220, s[56:59], s38 offen offset:1024 lds
  v_mfma_f32_16x16x32_bf16 v[48:51], v[160:163], a[32:35], v[48:51]
  ds_read_b64_tr_b16 v[156:157], v207 offset:24576
  v_mfma_f32_16x16x32_bf16 v[52:55], v[160:163], a[36:39], v[52:55]
  v_rcp_f32 v80, v80
  v_mfma_f32_16x16x32_bf16 v[56:59], v[160:163], a[40:43], v[56:59]
  ds_read_b64_tr_b16 v[158:159], v207 offset:25088
  v_mfma_f32_16x16x32_bf16 v[60:63], v[160:163], a[44:47], v[60:63]
  buffer_load_dwordx4 v221, s[56:59], s38 offen offset:2048 lds
  s_add_u32 m0, s25, 3072
  s_add_u32 s38, s7, 3096576
  v_mfma_f32_16x16x32_bf16 v[64:67], v[164:167], a[32:35], v[64:67]
  ds_read_b64_tr_b16 v[160:161], v204 offset:26624
  v_mfma_f32_16x16x32_bf16 v[68:71], v[164:167], a[36:39], v[68:71]
  v_rcp_f32 v81, v81
  v_mfma_f32_16x16x32_bf16 v[72:75], v[164:167], a[40:43], v[72:75]
  ds_read_b64_tr_b16 v[162:163], v204 offset:27136
  v_mfma_f32_16x16x32_bf16 v[76:79], v[164:167], a[44:47], v[76:79]
  v_rcp_f32 v82, v82
  s_waitcnt lgkmcnt(8)
  v_mfma_f32_16x16x32_bf16 v[16:19], v[144:147], a[48:51], v[16:19]
  ds_read_b64_tr_b16 v[164:165], v205 offset:26624
  v_mfma_f32_16x16x32_bf16 v[20:23], v[144:147], a[52:55], v[20:23]
  buffer_load_dwordx4 v219, s[56:59], s38 offen lds
  v_mfma_f32_16x16x32_bf16 v[24:27], v[144:147], a[56:59], v[24:27]
  ds_read_b64_tr_b16 v[166:167], v205 offset:27136
  v_mfma_f32_16x16x32_bf16 v[28:31], v[144:147], a[60:63], v[28:31]
  v_rcp_f32 v83, v83
  s_waitcnt lgkmcnt(8)
  v_mfma_f32_16x16x32_bf16 v[32:35], v[148:151], a[48:51], v[32:35]
  ds_read_b64_tr_b16 v[144:145], v206 offset:26624
  v_mul_f32 v112, v80, v112
  v_mfma_f32_16x16x32_bf16 v[36:39], v[148:151], a[52:55], v[36:39]
  buffer_load_dwordx4 v220, s[56:59], s38 offen offset:1024 lds
  v_mfma_f32_16x16x32_bf16 v[40:43], v[148:151], a[56:59], v[40:43]
  ds_read_b64_tr_b16 v[146:147], v206 offset:27136
  v_mul_f32 v113, v81, v113
  v_mfma_f32_16x16x32_bf16 v[44:47], v[148:151], a[60:63], v[44:47]
  v_exp_f32 v87, -v87
  s_waitcnt lgkmcnt(8)
  v_mfma_f32_16x16x32_bf16 v[48:51], v[152:155], a[48:51], v[48:51]
  ds_read_b64_tr_b16 v[148:149], v207 offset:26624
  v_mul_f32 v114, v82, v114
  v_mfma_f32_16x16x32_bf16 v[52:55], v[152:155], a[52:55], v[52:55]
  v_add_f32 v84, 1.0, v84
  v_add_f32 v85, 1.0, v85
  v_mfma_f32_16x16x32_bf16 v[56:59], v[152:155], a[56:59], v[56:59]
  ds_read_b64_tr_b16 v[150:151], v207 offset:27136
  v_mul_f32 v115, v83, v115
  v_mfma_f32_16x16x32_bf16 v[60:63], v[152:155], a[60:63], v[60:63]
  buffer_load_dwordx4 v221, s[56:59], s38 offen offset:2048 lds
  s_add_u32 m0, s25, 24576
  s_add_u32 s38, s7, 3538944
  s_waitcnt lgkmcnt(8)
  v_mfma_f32_16x16x32_bf16 v[64:67], v[156:159], a[48:51], v[64:67]
  ds_read_b64_tr_b16 v[152:153], v204 offset:28672
  v_add_f32 v86, 1.0, v86
  v_mfma_f32_16x16x32_bf16 v[68:71], v[156:159], a[52:55], v[68:71]
  v_cvt_pk_bf16_f32 v80, v112, v113
  v_add_f32 v87, 1.0, v87
  v_mfma_f32_16x16x32_bf16 v[72:75], v[156:159], a[56:59], v[72:75]
  ds_read_b64_tr_b16 v[154:155], v204 offset:29184
  v_mfma_f32_16x16x32_bf16 v[76:79], v[156:159], a[60:63], v[76:79]
  v_rcp_f32 v84, v84
  s_waitcnt lgkmcnt(8)
  v_mfma_f32_16x16x32_bf16 v[16:19], v[160:163], a[64:67], v[16:19]
  ds_read_b64_tr_b16 v[156:157], v205 offset:28672
  v_cvt_pk_bf16_f32 v81, v114, v115
  v_mfma_f32_16x16x32_bf16 v[20:23], v[160:163], a[68:71], v[20:23]
  v_rcp_f32 v85, v85
  v_mfma_f32_16x16x32_bf16 v[24:27], v[160:163], a[72:75], v[24:27]
  ds_read_b64_tr_b16 v[158:159], v205 offset:29184
  v_mfma_f32_16x16x32_bf16 v[28:31], v[160:163], a[76:79], v[28:31]
  ds_write_b64 v231, v[80:81] offset:32768
  s_waitcnt lgkmcnt(9)
  v_mfma_f32_16x16x32_bf16 v[32:35], v[164:167], a[64:67], v[32:35]
  ds_read_b64_tr_b16 v[160:161], v206 offset:28672
  v_mfma_f32_16x16x32_bf16 v[36:39], v[164:167], a[68:71], v[36:39]
  v_mul_f32 v120, v88, v120
  v_rcp_f32 v86, v86
  v_mfma_f32_16x16x32_bf16 v[40:43], v[164:167], a[72:75], v[40:43]
  ds_read_b64_tr_b16 v[162:163], v206 offset:29184
  v_mfma_f32_16x16x32_bf16 v[44:47], v[164:167], a[76:79], v[44:47]
  v_mul_f32 v121, v89, v121
  v_rcp_f32 v87, v87
  s_waitcnt lgkmcnt(9)
  v_mfma_f32_16x16x32_bf16 v[48:51], v[144:147], a[64:67], v[48:51]
  ds_read_b64_tr_b16 v[164:165], v207 offset:28672
  v_mul_f32 v116, v84, v116
  v_mfma_f32_16x16x32_bf16 v[52:55], v[144:147], a[68:71], v[52:55]
  v_mul_f32 v117, v85, v117
  v_mul_f32 v118, v86, v118
  v_mfma_f32_16x16x32_bf16 v[56:59], v[144:147], a[72:75], v[56:59]
  ds_read_b64_tr_b16 v[166:167], v207 offset:29184
  v_mul_f32 v122, v90, v122
  v_mfma_f32_16x16x32_bf16 v[60:63], v[144:147], a[76:79], v[60:63]
  v_mul_f32 v119, v87, v119
  v_cvt_pk_bf16_f32 v84, v116, v117
  s_waitcnt lgkmcnt(9)
  v_mfma_f32_16x16x32_bf16 v[64:67], v[148:151], a[64:67], v[64:67]
  v_mul_f32 v123, v91, v123
  v_cvt_pk_bf16_f32 v85, v118, v119
  v_mfma_f32_16x16x32_bf16 v[68:71], v[148:151], a[68:71], v[68:71]
  ds_write_b64 v231, v[84:85] offset:34816
  v_mfma_f32_16x16x32_bf16 v[72:75], v[148:151], a[72:75], v[72:75]
  v_mul_f32 v124, v92, v124
  v_mul_f32 v125, v93, v125
  v_mfma_f32_16x16x32_bf16 v[76:79], v[148:151], a[76:79], v[76:79]
  v_mul_f32 v88, s39, v88
  v_mul_f32 v126, v94, v126
  s_waitcnt lgkmcnt(0)
  s_waitcnt vmcnt(6)
  s_barrier
  v_mfma_f32_16x16x32_bf16 v[16:19], v[152:155], a[80:83], v[16:19]
  ds_read_b64_tr_b16 v[144:145], v204 offset:49152
  v_mul_f32 v127, v95, v127
  v_mfma_f32_16x16x32_bf16 v[20:23], v[152:155], a[84:87], v[20:23]
  buffer_load_dwordx4 v219, s[56:59], s38 offen lds
  v_mfma_f32_16x16x32_bf16 v[24:27], v[152:155], a[88:91], v[24:27]
  ds_read_b64_tr_b16 v[146:147], v204 offset:49664
  v_mul_f32 v89, s39, v89
  v_mfma_f32_16x16x32_bf16 v[28:31], v[152:155], a[92:95], v[28:31]
  ds_read_b64_tr_b16 v[148:149], v205 offset:49152
  v_mul_f32 v92, s39, v92
  v_mfma_f32_16x16x32_bf16 v[32:35], v[156:159], a[80:83], v[32:35]
  ds_read_b64_tr_b16 v[150:151], v205 offset:49664
  v_mul_f32 v90, s39, v90
  v_mfma_f32_16x16x32_bf16 v[36:39], v[156:159], a[84:87], v[36:39]
  ds_read_b64_tr_b16 v[152:153], v206 offset:49152
  v_mul_f32 v93, s39, v93
  v_mfma_f32_16x16x32_bf16 v[40:43], v[156:159], a[88:91], v[40:43]
  ds_read_b64_tr_b16 v[154:155], v206 offset:49664
  v_mul_f32 v94, s39, v94
  v_mfma_f32_16x16x32_bf16 v[44:47], v[156:159], a[92:95], v[44:47]
  buffer_load_dwordx4 v220, s[56:59], s38 offen offset:1024 lds
  v_mfma_f32_16x16x32_bf16 v[48:51], v[160:163], a[80:83], v[48:51]
  ds_read_b64_tr_b16 v[156:157], v207 offset:49152
  v_mul_f32 v91, s39, v91
  v_mfma_f32_16x16x32_bf16 v[52:55], v[160:163], a[84:87], v[52:55]
  v_exp_f32 v88, -v88
  v_mfma_f32_16x16x32_bf16 v[56:59], v[160:163], a[88:91], v[56:59]
  ds_read_b64_tr_b16 v[158:159], v207 offset:49664
  v_mul_f32 v95, s39, v95
  v_mfma_f32_16x16x32_bf16 v[60:63], v[160:163], a[92:95], v[60:63]
  buffer_load_dwordx4 v221, s[56:59], s38 offen offset:2048 lds
  s_add_u32 m0, s25, 27648
  s_add_u32 s38, s7, 3981312
  v_mfma_f32_16x16x32_bf16 v[64:67], v[164:167], a[80:83], v[64:67]
  ds_read_b64_tr_b16 v[160:161], v204 offset:51200
  v_mfma_f32_16x16x32_bf16 v[68:71], v[164:167], a[84:87], v[68:71]
  v_exp_f32 v89, -v89
  v_mfma_f32_16x16x32_bf16 v[72:75], v[164:167], a[88:91], v[72:75]
  ds_read_b64_tr_b16 v[162:163], v204 offset:51712
  v_mfma_f32_16x16x32_bf16 v[76:79], v[164:167], a[92:95], v[76:79]
  v_exp_f32 v90, -v90
  s_waitcnt lgkmcnt(8)
  v_mfma_f32_16x16x32_bf16 v[16:19], v[144:147], a[96:99], v[16:19]
  ds_read_b64_tr_b16 v[164:165], v205 offset:51200
  v_mfma_f32_16x16x32_bf16 v[20:23], v[144:147], a[100:103], v[20:23]
  buffer_load_dwordx4 v219, s[56:59], s38 offen lds
  v_mfma_f32_16x16x32_bf16 v[24:27], v[144:147], a[104:107], v[24:27]
  ds_read_b64_tr_b16 v[166:167], v205 offset:51712
  v_mfma_f32_16x16x32_bf16 v[28:31], v[144:147], a[108:111], v[28:31]
  v_exp_f32 v91, -v91
  s_waitcnt lgkmcnt(8)
  v_mfma_f32_16x16x32_bf16 v[32:35], v[148:151], a[96:99], v[32:35]
  ds_read_b64_tr_b16 v[144:145], v206 offset:51200
  v_add_f32 v88, 1.0, v88
  v_mfma_f32_16x16x32_bf16 v[36:39], v[148:151], a[100:103], v[36:39]
  buffer_load_dwordx4 v220, s[56:59], s38 offen offset:1024 lds
  v_mfma_f32_16x16x32_bf16 v[40:43], v[148:151], a[104:107], v[40:43]
  ds_read_b64_tr_b16 v[146:147], v206 offset:51712
  v_add_f32 v89, 1.0, v89
  v_mfma_f32_16x16x32_bf16 v[44:47], v[148:151], a[108:111], v[44:47]
  v_exp_f32 v92, -v92
  s_waitcnt lgkmcnt(8)
  v_mfma_f32_16x16x32_bf16 v[48:51], v[152:155], a[96:99], v[48:51]
  ds_read_b64_tr_b16 v[148:149], v207 offset:51200
  v_mfma_f32_16x16x32_bf16 v[52:55], v[152:155], a[100:103], v[52:55]
  v_add_f32 v90, 1.0, v90
  v_mfma_f32_16x16x32_bf16 v[56:59], v[152:155], a[104:107], v[56:59]
  ds_read_b64_tr_b16 v[150:151], v207 offset:51712
  v_mfma_f32_16x16x32_bf16 v[60:63], v[152:155], a[108:111], v[60:63]
  buffer_load_dwordx4 v221, s[56:59], s38 offen offset:2048 lds
  s_add_u32 m0, s25, 49152
  s_add_u32 s38, s7, 4423680
  s_waitcnt lgkmcnt(8)
  v_mfma_f32_16x16x32_bf16 v[64:67], v[156:159], a[96:99], v[64:67]
  ds_read_b64_tr_b16 v[152:153], v204 offset:53248
  v_add_f32 v91, 1.0, v91
  v_mfma_f32_16x16x32_bf16 v[68:71], v[156:159], a[100:103], v[68:71]
  v_exp_f32 v93, -v93
  v_mfma_f32_16x16x32_bf16 v[72:75], v[156:159], a[104:107], v[72:75]
  ds_read_b64_tr_b16 v[154:155], v204 offset:53760
  v_mfma_f32_16x16x32_bf16 v[76:79], v[156:159], a[108:111], v[76:79]
  v_rcp_f32 v88, v88
  s_waitcnt lgkmcnt(8)
  v_mfma_f32_16x16x32_bf16 v[16:19], v[160:163], a[112:115], v[16:19]
  ds_read_b64_tr_b16 v[156:157], v205 offset:53248
  v_mfma_f32_16x16x32_bf16 v[20:23], v[160:163], a[116:119], v[20:23]
  v_rcp_f32 v89, v89
  v_mfma_f32_16x16x32_bf16 v[24:27], v[160:163], a[120:123], v[24:27]
  ds_read_b64_tr_b16 v[158:159], v205 offset:53760
  v_mfma_f32_16x16x32_bf16 v[28:31], v[160:163], a[124:127], v[28:31]
  v_rcp_f32 v90, v90
  s_waitcnt lgkmcnt(8)
  v_mfma_f32_16x16x32_bf16 v[32:35], v[164:167], a[112:115], v[32:35]
  ds_read_b64_tr_b16 v[160:161], v206 offset:53248
  v_mfma_f32_16x16x32_bf16 v[36:39], v[164:167], a[116:119], v[36:39]
  v_exp_f32 v94, -v94
  v_mfma_f32_16x16x32_bf16 v[40:43], v[164:167], a[120:123], v[40:43]
  ds_read_b64_tr_b16 v[162:163], v206 offset:53760
  v_mfma_f32_16x16x32_bf16 v[44:47], v[164:167], a[124:127], v[44:47]
  v_rcp_f32 v91, v91
  s_waitcnt lgkmcnt(8)
  v_mfma_f32_16x16x32_bf16 v[48:51], v[144:147], a[112:115], v[48:51]
  ds_read_b64_tr_b16 v[164:165], v207 offset:53248
  v_mul_f32 v120, v88, v120
  v_mfma_f32_16x16x32_bf16 v[52:55], v[144:147], a[116:119], v[52:55]
  v_exp_f32 v95, -v95
  v_mfma_f32_16x16x32_bf16 v[56:59], v[144:147], a[120:123], v[56:59]
  ds_read_b64_tr_b16 v[166:167], v207 offset:53760
  v_add_f32 v92, 1.0, v92
  v_mfma_f32_16x16x32_bf16 v[60:63], v[144:147], a[124:127], v[60:63]
  v_mul_f32 v121, v89, v121
  v_add_f32 v93, 1.0, v93
  s_waitcnt lgkmcnt(8)
  v_mfma_f32_16x16x32_bf16 v[64:67], v[148:151], a[112:115], v[64:67]
  v_add_f32 v94, 1.0, v94
  v_add_f32 v95, 1.0, v95
  v_mfma_f32_16x16x32_bf16 v[68:71], v[148:151], a[116:119], v[68:71]
  v_mul_f32 v122, v90, v122
  v_mfma_f32_16x16x32_bf16 v[72:75], v[148:151], a[120:123], v[72:75]
  v_rcp_f32 v92, v92
  v_mfma_f32_16x16x32_bf16 v[76:79], v[148:151], a[124:127], v[76:79]
  v_rcp_f32 v93, v93
  s_waitcnt lgkmcnt(0)
  s_waitcnt vmcnt(6)
  s_barrier
  v_mfma_f32_16x16x32_bf16 v[16:19], v[152:155], a[128:131], v[16:19]
  ds_read_b64_tr_b16 v[144:145], v204 offset:0
  v_mul_f32 v123, v91, v123
  v_mfma_f32_16x16x32_bf16 v[20:23], v[152:155], a[132:135], v[20:23]
  buffer_load_dwordx4 v219, s[56:59], s38 offen lds
  v_mfma_f32_16x16x32_bf16 v[24:27], v[152:155], a[136:139], v[24:27]
  ds_read_b64_tr_b16 v[146:147], v204 offset:512
  v_cvt_pk_bf16_f32 v88, v120, v121
  v_mfma_f32_16x16x32_bf16 v[28:31], v[152:155], a[140:143], v[28:31]
  ds_read_b64_tr_b16 v[148:149], v205 offset:0
  v_mfma_f32_16x16x32_bf16 v[32:35], v[156:159], a[128:131], v[32:35]
  ds_read_b64_tr_b16 v[150:151], v205 offset:512
  v_mfma_f32_16x16x32_bf16 v[36:39], v[156:159], a[132:135], v[36:39]
  ds_read_b64_tr_b16 v[152:153], v206 offset:0
  v_cvt_pk_bf16_f32 v89, v122, v123
  v_mfma_f32_16x16x32_bf16 v[40:43], v[156:159], a[136:139], v[40:43]
  ds_read_b64_tr_b16 v[154:155], v206 offset:512
  v_mfma_f32_16x16x32_bf16 v[44:47], v[156:159], a[140:143], v[44:47]
  buffer_load_dwordx4 v220, s[56:59], s38 offen offset:1024 lds
  v_mfma_f32_16x16x32_bf16 v[48:51], v[160:163], a[128:131], v[48:51]
  ds_read_b64_tr_b16 v[156:157], v207 offset:0
  v_mfma_f32_16x16x32_bf16 v[52:55], v[160:163], a[132:135], v[52:55]
  ds_write_b64 v231, v[88:89] offset:36864
  v_mfma_f32_16x16x32_bf16 v[56:59], v[160:163], a[136:139], v[56:59]
  ds_read_b64_tr_b16 v[158:159], v207 offset:512
  v_mul_f32 v128, v96, v128
  v_mfma_f32_16x16x32_bf16 v[60:63], v[160:163], a[140:143], v[60:63]
  buffer_load_dwordx4 v221, s[56:59], s38 offen offset:2048 lds
  s_add_u32 m0, s25, 52224
  s_add_u32 s38, s7, 4866048
  v_mfma_f32_16x16x32_bf16 v[64:67], v[164:167], a[128:131], v[64:67]
  ds_read_b64_tr_b16 v[160:161], v204 offset:2048
  v_rcp_f32 v94, v94
  v_mfma_f32_16x16x32_bf16 v[68:71], v[164:167], a[132:135], v[68:71]
  v_mul_f32 v129, v97, v129
  v_rcp_f32 v95, v95
  v_mfma_f32_16x16x32_bf16 v[72:75], v[164:167], a[136:139], v[72:75]
  ds_read_b64_tr_b16 v[162:163], v204 offset:2560
  v_mul_f32 v124, v92, v124
  v_mfma_f32_16x16x32_bf16 v[76:79], v[164:167], a[140:143], v[76:79]
  v_mul_f32 v130, v98, v130
  v_mul_f32 v125, v93, v125
  s_waitcnt lgkmcnt(9)
  v_mfma_f32_16x16x32_bf16 v[16:19], v[144:147], a[144:147], v[16:19]
  ds_read_b64_tr_b16 v[164:165], v205 offset:2048
  v_mul_f32 v126, v94, v126
  v_mfma_f32_16x16x32_bf16 v[20:23], v[144:147], a[148:151], v[20:23]
  buffer_load_dwordx4 v219, s[56:59], s38 offen lds
  v_mfma_f32_16x16x32_bf16 v[24:27], v[144:147], a[152:155], v[24:27]
  ds_read_b64_tr_b16 v[166:167], v205 offset:2560
  v_mul_f32 v131, v99, v131
  v_mfma_f32_16x16x32_bf16 v[28:31], v[144:147], a[156:159], v[28:31]
  v_mul_f32 v127, v95, v127
  v_cvt_pk_bf16_f32 v92, v124, v125
  s_waitcnt lgkmcnt(9)
  v_mfma_f32_16x16x32_bf16 v[32:35], v[148:151], a[144:147], v[32:35]
  ds_read_b64_tr_b16 v[144:145], v206 offset:2048
  v_cvt_pk_bf16_f32 v93, v126, v127
  v_mfma_f32_16x16x32_bf16 v[36:39], v[148:151], a[148:151], v[36:39]
  buffer_load_dwordx4 v220, s[56:59], s38 offen offset:1024 lds
  v_mfma_f32_16x16x32_bf16 v[40:43], v[148:151], a[152:155], v[40:43]
  ds_read_b64_tr_b16 v[146:147], v206 offset:2560
  v_mul_f32 v96, s39, v96
  v_mfma_f32_16x16x32_bf16 v[44:47], v[148:151], a[156:159], v[44:47]
  v_mul_f32 v97, s39, v97
  s_waitcnt lgkmcnt(9)
  v_mfma_f32_16x16x32_bf16 v[48:51], v[152:155], a[144:147], v[48:51]
  ds_read_b64_tr_b16 v[148:149], v207 offset:2048
  v_mfma_f32_16x16x32_bf16 v[52:55], v[152:155], a[148:151], v[52:55]
  ds_write_b64 v231, v[92:93] offset:38912
  v_mfma_f32_16x16x32_bf16 v[56:59], v[152:155], a[152:155], v[56:59]
  ds_read_b64_tr_b16 v[150:151], v207 offset:2560
  v_mul_f32 v98, s39, v98
  v_mfma_f32_16x16x32_bf16 v[60:63], v[152:155], a[156:159], v[60:63]
  buffer_load_dwordx4 v221, s[56:59], s38 offen offset:2048 lds
  s_add_u32 m0, s25, 0
  s_add_u32 s38, s8, 0
  s_waitcnt lgkmcnt(9)
  v_mfma_f32_16x16x32_bf16 v[64:67], v[156:159], a[144:147], v[64:67]
  ds_read_b64_tr_b16 v[152:153], v204 offset:4096
  v_mul_f32 v99, s39, v99
  v_mfma_f32_16x16x32_bf16 v[68:71], v[156:159], a[148:151], v[68:71]
  v_mul_f32 v132, v100, v132
  v_mul_f32 v133, v101, v133
  v_mfma_f32_16x16x32_bf16 v[72:75], v[156:159], a[152:155], v[72:75]
  ds_read_b64_tr_b16 v[154:155], v204 offset:4608
  v_mul_f32 v134, v102, v134
  v_mfma_f32_16x16x32_bf16 v[76:79], v[156:159], a[156:159], v[76:79]
  v_exp_f32 v96, -v96
  s_waitcnt lgkmcnt(9)
  v_mfma_f32_16x16x32_bf16 v[16:19], v[160:163], a[160:163], v[16:19]
  ds_read_b64_tr_b16 v[156:157], v205 offset:4096
  v_mul_f32 v135, v103, v135
  v_mfma_f32_16x16x32_bf16 v[20:23], v[160:163], a[164:167], v[20:23]
  v_exp_f32 v97, -v97
  v_mfma_f32_16x16x32_bf16 v[24:27], v[160:163], a[168:171], v[24:27]
  ds_read_b64_tr_b16 v[158:159], v205 offset:4608
  v_mul_f32 v100, s39, v100
  v_mfma_f32_16x16x32_bf16 v[28:31], v[160:163], a[172:175], v[28:31]
  v_mul_f32 v101, s39, v101
  v_mul_f32 v102, s39, v102
  s_waitcnt lgkmcnt(9)
  v_mfma_f32_16x16x32_bf16 v[32:35], v[164:167], a[160:163], v[32:35]
  ds_read_b64_tr_b16 v[160:161], v206 offset:4096
  v_mul_f32 v103, s39, v103
  v_mfma_f32_16x16x32_bf16 v[36:39], v[164:167], a[164:167], v[36:39]
  v_exp_f32 v98, -v98
  v_mfma_f32_16x16x32_bf16 v[40:43], v[164:167], a[168:171], v[40:43]
  ds_read_b64_tr_b16 v[162:163], v206 offset:4608
  v_mfma_f32_16x16x32_bf16 v[44:47], v[164:167], a[172:175], v[44:47]
  v_exp_f32 v99, -v99
  s_waitcnt lgkmcnt(9)
  v_mfma_f32_16x16x32_bf16 v[48:51], v[144:147], a[160:163], v[48:51]
  ds_read_b64_tr_b16 v[164:165], v207 offset:4096
  v_mfma_f32_16x16x32_bf16 v[52:55], v[144:147], a[164:167], v[52:55]
  v_add_f32 v96, 1.0, v96
  v_mfma_f32_16x16x32_bf16 v[56:59], v[144:147], a[168:171], v[56:59]
  ds_read_b64_tr_b16 v[166:167], v207 offset:4608
  v_mfma_f32_16x16x32_bf16 v[60:63], v[144:147], a[172:175], v[60:63]
  v_exp_f32 v100, -v100
  s_waitcnt lgkmcnt(8)
  v_mfma_f32_16x16x32_bf16 v[64:67], v[148:151], a[160:163], v[64:67]
  v_add_f32 v97, 1.0, v97
  v_mfma_f32_16x16x32_bf16 v[68:71], v[148:151], a[164:167], v[68:71]
  v_exp_f32 v101, -v101
  v_mfma_f32_16x16x32_bf16 v[72:75], v[148:151], a[168:171], v[72:75]
  v_add_f32 v98, 1.0, v98
  v_mfma_f32_16x16x32_bf16 v[76:79], v[148:151], a[172:175], v[76:79]
  v_exp_f32 v102, -v102
  s_waitcnt lgkmcnt(0)
  s_waitcnt vmcnt(6)
  s_barrier
  v_mfma_f32_16x16x32_bf16 v[16:19], v[152:155], a[176:179], v[16:19]
  ds_read_b64_tr_b16 v[144:145], v204 offset:24576
  v_mfma_f32_16x16x32_bf16 v[20:23], v[152:155], a[180:183], v[20:23]
  buffer_load_dwordx4 v222, s[56:59], s38 offen lds
  v_mfma_f32_16x16x32_bf16 v[24:27], v[152:155], a[184:187], v[24:27]
  ds_read_b64_tr_b16 v[146:147], v204 offset:25088
  v_add_f32 v99, 1.0, v99
  v_mfma_f32_16x16x32_bf16 v[28:31], v[152:155], a[188:191], v[28:31]
  ds_read_b64_tr_b16 v[148:149], v205 offset:24576
  v_mfma_f32_16x16x32_bf16 v[32:35], v[156:159], a[176:179], v[32:35]
  ds_read_b64_tr_b16 v[150:151], v205 offset:25088
  v_mfma_f32_16x16x32_bf16 v[36:39], v[156:159], a[180:183], v[36:39]
  ds_read_b64_tr_b16 v[152:153], v206 offset:24576
  v_mfma_f32_16x16x32_bf16 v[40:43], v[156:159], a[184:187], v[40:43]
  ds_read_b64_tr_b16 v[154:155], v206 offset:25088
  v_mfma_f32_16x16x32_bf16 v[44:47], v[156:159], a[188:191], v[44:47]
  buffer_load_dwordx4 v223, s[56:59], s38 offen offset:1024 lds
  v_mfma_f32_16x16x32_bf16 v[48:51], v[160:163], a[176:179], v[48:51]
  ds_read_b64_tr_b16 v[156:157], v207 offset:24576
  v_mfma_f32_16x16x32_bf16 v[52:55], v[160:163], a[180:183], v[52:55]
  v_rcp_f32 v96, v96
  v_mfma_f32_16x16x32_bf16 v[56:59], v[160:163], a[184:187], v[56:59]
  ds_read_b64_tr_b16 v[158:159], v207 offset:25088
  v_mfma_f32_16x16x32_bf16 v[60:63], v[160:163], a[188:191], v[60:63]
  buffer_load_dwordx4 v224, s[56:59], s38 offen offset:2048 lds
  s_add_u32 m0, s25, 3072
  s_add_u32 s38, s8, 884736
  v_mfma_f32_16x16x32_bf16 v[64:67], v[164:167], a[176:179], v[64:67]
  ds_read_b64_tr_b16 v[160:161], v204 offset:26624
  v_mfma_f32_16x16x32_bf16 v[68:71], v[164:167], a[180:183], v[68:71]
  v_rcp_f32 v97, v97
  v_mfma_f32_16x16x32_bf16 v[72:75], v[164:167], a[184:187], v[72:75]
  ds_read_b64_tr_b16 v[162:163], v204 offset:27136
  v_exp_f32 v103, -v103
  v_mfma_f32_16x16x32_bf16 v[76:79], v[164:167], a[188:191], v[76:79]
  v_rcp_f32 v98, v98
  s_waitcnt lgkmcnt(8)
  v_mfma_f32_16x16x32_bf16 v[16:19], v[144:147], a[192:195], v[16:19]
  ds_read_b64_tr_b16 v[164:165], v205 offset:26624
  v_add_f32 v100, 1.0, v100
  v_mfma_f32_16x16x32_bf16 v[20:23], v[144:147], a[196:199], v[20:23]
  buffer_load_dwordx4 v222, s[56:59], s38 offen lds
  v_mfma_f32_16x16x32_bf16 v[24:27], v[144:147], a[200:203], v[24:27]
  ds_read_b64_tr_b16 v[166:167], v205 offset:27136
  v_add_f32 v101, 1.0, v101
  v_mfma_f32_16x16x32_bf16 v[28:31], v[144:147], a[204:207], v[28:31]
  v_rcp_f32 v99, v99
  s_waitcnt lgkmcnt(8)
  v_mfma_f32_16x16x32_bf16 v[32:35], v[148:151], a[192:195], v[32:35]
  ds_read_b64_tr_b16 v[144:145], v206 offset:26624
  v_mul_f32 v128, v96, v128
  v_mfma_f32_16x16x32_bf16 v[36:39], v[148:151], a[196:199], v[36:39]
  buffer_load_dwordx4 v223, s[56:59], s38 offen offset:1024 lds
  v_mfma_f32_16x16x32_bf16 v[40:43], v[148:151], a[200:203], v[40:43]
  ds_read_b64_tr_b16 v[146:147], v206 offset:27136
  v_mul_f32 v129, v97, v129
  v_mfma_f32_16x16x32_bf16 v[44:47], v[148:151], a[204:207], v[44:47]
  v_mul_f32 v130, v98, v130
  v_add_f32 v102, 1.0, v102
  s_waitcnt lgkmcnt(8)
  v_mfma_f32_16x16x32_bf16 v[48:51], v[152:155], a[192:195], v[48:51]
  ds_read_b64_tr_b16 v[148:149], v207 offset:26624
  v_mul_f32 v131, v99, v131
  v_mfma_f32_16x16x32_bf16 v[52:55], v[152:155], a[196:199], v[52:55]
  v_cvt_pk_bf16_f32 v96, v128, v129
  v_add_f32 v103, 1.0, v103
  v_mfma_f32_16x16x32_bf16 v[56:59], v[152:155], a[200:203], v[56:59]
  ds_read_b64_tr_b16 v[150:151], v207 offset:27136
  v_mfma_f32_16x16x32_bf16 v[60:63], v[152:155], a[204:207], v[60:63]
  buffer_load_dwordx4 v224, s[56:59], s38 offen offset:2048 lds
  s_add_u32 m0, s25, 24576
  s_add_u32 s38, s8, 1769472
  s_waitcnt lgkmcnt(8)
  v_mfma_f32_16x16x32_bf16 v[64:67], v[156:159], a[192:195], v[64:67]
  ds_read_b64_tr_b16 v[152:153], v204 offset:28672
  v_cvt_pk_bf16_f32 v97, v130, v131
  v_mfma_f32_16x16x32_bf16 v[68:71], v[156:159], a[196:199], v[68:71]
  ds_write_b64 v232, v[96:97] offset:32768
  v_mfma_f32_16x16x32_bf16 v[72:75], v[156:159], a[200:203], v[72:75]
  ds_read_b64_tr_b16 v[154:155], v204 offset:29184
  v_rcp_f32 v100, v100
  v_mfma_f32_16x16x32_bf16 v[76:79], v[156:159], a[204:207], v[76:79]
  v_rcp_f32 v101, v101
  s_waitcnt lgkmcnt(9)
  v_mfma_f32_16x16x32_bf16 v[16:19], v[160:163], a[208:211], v[16:19]
  ds_read_b64_tr_b16 v[156:157], v205 offset:28672
  v_mul_f32 v136, v104, v136
  v_mfma_f32_16x16x32_bf16 v[20:23], v[160:163], a[212:215], v[20:23]
  v_rcp_f32 v102, v102
  v_mfma_f32_16x16x32_bf16 v[24:27], v[160:163], a[216:219], v[24:27]
  ds_read_b64_tr_b16 v[158:159], v205 offset:29184
  v_mul_f32 v137, v105, v137
  v_mfma_f32_16x16x32_bf16 v[28:31], v[160:163], a[220:223], v[28:31]
  v_rcp_f32 v103, v103
  s_waitcnt lgkmcnt(9)
  v_mfma_f32_16x16x32_bf16 v[32:35], v[164:167], a[208:211], v[32:35]
  ds_read_b64_tr_b16 v[160:161], v206 offset:28672
  v_mul_f32 v132, v100, v132
  v_mfma_f32_16x16x32_bf16 v[36:39], v[164:167], a[212:215], v[36:39]
  v_mul_f32 v138, v106, v138
  v_mul_f32 v133, v101, v133
  v_mfma_f32_16x16x32_bf16 v[40:43], v[164:167], a[216:219], v[40:43]
  ds_read_b64_tr_b16 v[162:163], v206 offset:29184
  v_mul_f32 v134, v102, v134
  v_mfma_f32_16x16x32_bf16 v[44:47], v[164:167], a[220:223], v[44:47]
  v_mul_f32 v139, v107, v139
  v_mul_f32 v135, v103, v135
  s_waitcnt lgkmcnt(9)
  v_mfma_f32_16x16x32_bf16 v[48:51], v[144:147], a[208:211], v[48:51]
  ds_read_b64_tr_b16 v[164:165], v207 offset:28672
  v_cvt_pk_bf16_f32 v100, v132, v133
  v_mfma_f32_16x16x32_bf16 v[52:55], v[144:147], a[212:215], v[52:55]
  v_cvt_pk_bf16_f32 v101, v134, v135
  v_mfma_f32_16x16x32_bf16 v[56:59], v[144:147], a[216:219], v[56:59]
  ds_read_b64_tr_b16 v[166:167], v207 offset:29184
  v_mul_f32 v104, s39, v104
  v_mfma_f32_16x16x32_bf16 v[60:63], v[144:147], a[220:223], v[60:63]
  ds_write_b64 v232, v[100:101] offset:34816
  s_waitcnt lgkmcnt(10)
  v_mfma_f32_16x16x32_bf16 v[64:67], v[148:151], a[208:211], v[64:67]
  v_mul_f32 v140, v108, v140
  v_mul_f32 v141, v109, v141
  v_mfma_f32_16x16x32_bf16 v[68:71], v[148:151], a[212:215], v[68:71]
  v_mul_f32 v105, s39, v105
  v_mul_f32 v142, v110, v142
  v_mfma_f32_16x16x32_bf16 v[72:75], v[148:151], a[216:219], v[72:75]
  v_mul_f32 v143, v111, v143
  v_mul_f32 v108, s39, v108
  v_mfma_f32_16x16x32_bf16 v[76:79], v[148:151], a[220:223], v[76:79]
  v_mul_f32 v106, s39, v106
  v_mul_f32 v109, s39, v109
  s_waitcnt lgkmcnt(0)
  s_waitcnt vmcnt(6)
  s_barrier
  v_mfma_f32_16x16x32_bf16 v[16:19], v[152:155], a[224:227], v[16:19]
  ds_read_b64_tr_b16 v[144:145], v204 offset:49152
  v_mul_f32 v110, s39, v110
  v_mfma_f32_16x16x32_bf16 v[20:23], v[152:155], a[228:231], v[20:23]
  buffer_load_dwordx4 v222, s[56:59], s38 offen lds
  v_mfma_f32_16x16x32_bf16 v[24:27], v[152:155], a[232:235], v[24:27]
  ds_read_b64_tr_b16 v[146:147], v204 offset:49664
  v_mul_f32 v107, s39, v107
  v_mfma_f32_16x16x32_bf16 v[28:31], v[152:155], a[236:239], v[28:31]
  ds_read_b64_tr_b16 v[148:149], v205 offset:49152
  v_mul_f32 v111, s39, v111
  v_mfma_f32_16x16x32_bf16 v[32:35], v[156:159], a[224:227], v[32:35]
  ds_read_b64_tr_b16 v[150:151], v205 offset:49664
  v_mfma_f32_16x16x32_bf16 v[36:39], v[156:159], a[228:231], v[36:39]
  ds_read_b64_tr_b16 v[152:153], v206 offset:49152
  v_mfma_f32_16x16x32_bf16 v[40:43], v[156:159], a[232:235], v[40:43]
  ds_read_b64_tr_b16 v[154:155], v206 offset:49664
  v_mfma_f32_16x16x32_bf16 v[44:47], v[156:159], a[236:239], v[44:47]
  buffer_load_dwordx4 v223, s[56:59], s38 offen offset:1024 lds
  v_mfma_f32_16x16x32_bf16 v[48:51], v[160:163], a[224:227], v[48:51]
  ds_read_b64_tr_b16 v[156:157], v207 offset:49152
  v_mfma_f32_16x16x32_bf16 v[52:55], v[160:163], a[228:231], v[52:55]
  v_exp_f32 v104, -v104
  v_mfma_f32_16x16x32_bf16 v[56:59], v[160:163], a[232:235], v[56:59]
  ds_read_b64_tr_b16 v[158:159], v207 offset:49664
  v_mfma_f32_16x16x32_bf16 v[60:63], v[160:163], a[236:239], v[60:63]
  buffer_load_dwordx4 v224, s[56:59], s38 offen offset:2048 lds
  s_add_u32 m0, s25, 27648
  s_add_u32 s38, s8, 2654208
  v_mfma_f32_16x16x32_bf16 v[64:67], v[164:167], a[224:227], v[64:67]
  ds_read_b64_tr_b16 v[160:161], v204 offset:51200
  v_mfma_f32_16x16x32_bf16 v[68:71], v[164:167], a[228:231], v[68:71]
  v_exp_f32 v105, -v105
  v_mfma_f32_16x16x32_bf16 v[72:75], v[164:167], a[232:235], v[72:75]
  ds_read_b64_tr_b16 v[162:163], v204 offset:51712
  v_mfma_f32_16x16x32_bf16 v[76:79], v[164:167], a[236:239], v[76:79]
  v_exp_f32 v106, -v106
  s_waitcnt lgkmcnt(8)
  v_mfma_f32_16x16x32_bf16 v[16:19], v[144:147], a[240:243], v[16:19]
  ds_read_b64_tr_b16 v[164:165], v205 offset:51200
  v_mfma_f32_16x16x32_bf16 v[20:23], v[144:147], a[244:247], v[20:23]
  buffer_load_dwordx4 v222, s[56:59], s38 offen lds
  v_mfma_f32_16x16x32_bf16 v[24:27], v[144:147], a[248:251], v[24:27]
  ds_read_b64_tr_b16 v[166:167], v205 offset:51712
  v_mfma_f32_16x16x32_bf16 v[28:31], v[144:147], a[252:255], v[28:31]
  v_exp_f32 v107, -v107
  s_waitcnt lgkmcnt(8)
  v_mfma_f32_16x16x32_bf16 v[32:35], v[148:151], a[240:243], v[32:35]
  ds_read_b64_tr_b16 v[144:145], v206 offset:51200
  v_add_f32 v104, 1.0, v104
  v_mfma_f32_16x16x32_bf16 v[36:39], v[148:151], a[244:247], v[36:39]
  buffer_load_dwordx4 v223, s[56:59], s38 offen offset:1024 lds
  v_mfma_f32_16x16x32_bf16 v[40:43], v[148:151], a[248:251], v[40:43]
  ds_read_b64_tr_b16 v[146:147], v206 offset:51712
  v_add_f32 v105, 1.0, v105
  v_mfma_f32_16x16x32_bf16 v[44:47], v[148:151], a[252:255], v[44:47]
  v_add_f32 v106, 1.0, v106
  v_add_f32 v107, 1.0, v107
  s_waitcnt lgkmcnt(8)
  v_mfma_f32_16x16x32_bf16 v[48:51], v[152:155], a[240:243], v[48:51]
  ds_read_b64_tr_b16 v[148:149], v207 offset:51200
  v_mfma_f32_16x16x32_bf16 v[52:55], v[152:155], a[244:247], v[52:55]
  v_rcp_f32 v104, v104
  v_mfma_f32_16x16x32_bf16 v[56:59], v[152:155], a[248:251], v[56:59]
  ds_read_b64_tr_b16 v[150:151], v207 offset:51712
  v_mfma_f32_16x16x32_bf16 v[60:63], v[152:155], a[252:255], v[60:63]
  buffer_load_dwordx4 v224, s[56:59], s38 offen offset:2048 lds
  s_add_u32 m0, s25, 49152
  s_add_u32 s38, s8, 3538944
  s_waitcnt lgkmcnt(8)
  v_mfma_f32_16x16x32_bf16 v[64:67], v[156:159], a[240:243], v[64:67]
  ds_read_b64_tr_b16 v[152:153], v204 offset:53248
  v_exp_f32 v108, -v108
  v_mfma_f32_16x16x32_bf16 v[68:71], v[156:159], a[244:247], v[68:71]
  v_rcp_f32 v105, v105
  v_mfma_f32_16x16x32_bf16 v[72:75], v[156:159], a[248:251], v[72:75]
  ds_read_b64_tr_b16 v[154:155], v204 offset:53760
  v_exp_f32 v109, -v109
  v_mfma_f32_16x16x32_bf16 v[76:79], v[156:159], a[252:255], v[76:79]
  v_rcp_f32 v106, v106
  s_waitcnt lgkmcnt(8)
  v_mfma_f32_16x16x32_bf16 v[16:19], v[160:163], v[168:171], v[16:19]
  ds_read_b64_tr_b16 v[156:157], v205 offset:53248
  v_mfma_f32_16x16x32_bf16 v[20:23], v[160:163], v[172:175], v[20:23]
  v_rcp_f32 v107, v107
  v_mfma_f32_16x16x32_bf16 v[24:27], v[160:163], v[176:179], v[24:27]
  ds_read_b64_tr_b16 v[158:159], v205 offset:53760
  v_exp_f32 v110, -v110
  v_mfma_f32_16x16x32_bf16 v[28:31], v[160:163], v[180:183], v[28:31]
  v_mul_f32 v136, v104, v136
  v_exp_f32 v111, -v111
  s_waitcnt lgkmcnt(8)
  v_mfma_f32_16x16x32_bf16 v[32:35], v[164:167], v[168:171], v[32:35]
  ds_read_b64_tr_b16 v[160:161], v206 offset:53248
  v_add_f32 v108, 1.0, v108
  v_mfma_f32_16x16x32_bf16 v[36:39], v[164:167], v[172:175], v[36:39]
  v_add_f32 v109, 1.0, v109
  v_add_f32 v110, 1.0, v110
  v_mfma_f32_16x16x32_bf16 v[40:43], v[164:167], v[176:179], v[40:43]
  ds_read_b64_tr_b16 v[162:163], v206 offset:53760
  v_mul_f32 v137, v105, v137
  v_mfma_f32_16x16x32_bf16 v[44:47], v[164:167], v[180:183], v[44:47]
  v_add_f32 v111, 1.0, v111
  s_waitcnt lgkmcnt(8)
  v_mfma_f32_16x16x32_bf16 v[48:51], v[144:147], v[168:171], v[48:51]
  ds_read_b64_tr_b16 v[164:165], v207 offset:53248
  v_mul_f32 v138, v106, v138
  v_mfma_f32_16x16x32_bf16 v[52:55], v[144:147], v[172:175], v[52:55]
  v_rcp_f32 v108, v108
  v_mfma_f32_16x16x32_bf16 v[56:59], v[144:147], v[176:179], v[56:59]
  ds_read_b64_tr_b16 v[166:167], v207 offset:53760
  v_mfma_f32_16x16x32_bf16 v[60:63], v[144:147], v[180:183], v[60:63]
  v_mul_f32 v139, v107, v139
  s_waitcnt lgkmcnt(8)
  v_mfma_f32_16x16x32_bf16 v[64:67], v[148:151], v[168:171], v[64:67]
  v_rcp_f32 v109, v109
  v_mfma_f32_16x16x32_bf16 v[68:71], v[148:151], v[172:175], v[68:71]
  v_cvt_pk_bf16_f32 v104, v136, v137
  v_mfma_f32_16x16x32_bf16 v[72:75], v[148:151], v[176:179], v[72:75]
  v_rcp_f32 v110, v110
  v_mfma_f32_16x16x32_bf16 v[76:79], v[148:151], v[180:183], v[76:79]
  v_rcp_f32 v111, v111
  s_waitcnt lgkmcnt(0)
  s_waitcnt vmcnt(6)
  s_barrier
  v_mfma_f32_16x16x32_bf16 v[16:19], v[152:155], v[184:187], v[16:19]
  ds_read_b64_tr_b16 v[144:145], v208 offset:0
  v_cvt_pk_bf16_f32 v105, v138, v139
  v_mfma_f32_16x16x32_bf16 v[20:23], v[152:155], v[188:191], v[20:23]
  buffer_load_dwordx4 v222, s[56:59], s38 offen lds
  v_mfma_f32_16x16x32_bf16 v[24:27], v[152:155], v[192:195], v[24:27]
  ds_read_b64_tr_b16 v[146:147], v208 offset:256
  v_mul_f32 v140, v108, v140
  v_mfma_f32_16x16x32_bf16 v[28:31], v[152:155], v[196:199], v[28:31]
  ds_read_b64_tr_b16 v[148:149], v209 offset:0
  v_mul_f32 v141, v109, v141
  v_mfma_f32_16x16x32_bf16 v[32:35], v[156:159], v[184:187], v[32:35]
  ds_read_b64_tr_b16 v[150:151], v209 offset:256
  v_mul_f32 v142, v110, v142
  v_mfma_f32_16x16x32_bf16 v[36:39], v[156:159], v[188:191], v[36:39]
  ds_read_b64_tr_b16 v[152:153], v208 offset:1024
  v_mul_f32 v143, v111, v143
  v_mfma_f32_16x16x32_bf16 v[40:43], v[156:159], v[192:195], v[40:43]
  ds_read_b64_tr_b16 v[154:155], v208 offset:1280
  v_cvt_pk_bf16_f32 v108, v140, v141
  v_mfma_f32_16x16x32_bf16 v[44:47], v[156:159], v[196:199], v[44:47]
  buffer_load_dwordx4 v223, s[56:59], s38 offen offset:1024 lds
  v_mfma_f32_16x16x32_bf16 v[48:51], v[160:163], v[184:187], v[48:51]
  ds_read_b64_tr_b16 v[156:157], v209 offset:1024
  v_cvt_pk_bf16_f32 v109, v142, v143
  v_mfma_f32_16x16x32_bf16 v[52:55], v[160:163], v[188:191], v[52:55]
  ds_write_b64 v232, v[104:105] offset:36864
  v_mfma_f32_16x16x32_bf16 v[56:59], v[160:163], v[192:195], v[56:59]
  ds_read_b64_tr_b16 v[158:159], v209 offset:1280
  v_mfma_f32_16x16x32_bf16 v[60:63], v[160:163], v[196:199], v[60:63]
  buffer_load_dwordx4 v224, s[56:59], s38 offen offset:2048 lds
  s_add_u32 m0, s25, 52224
  s_add_u32 s38, s8, 4423680
  v_mfma_f32_16x16x32_bf16 v[64:67], v[164:167], v[184:187], v[64:67]
  ds_read_b64_tr_b16 v[160:161], v208 offset:2048
  v_mfma_f32_16x16x32_bf16 v[68:71], v[164:167], v[188:191], v[68:71]
  ds_write_b64 v232, v[108:109] offset:38912
  v_mfma_f32_16x16x32_bf16 v[72:75], v[164:167], v[192:195], v[72:75]
  ds_read_b64_tr_b16 v[162:163], v208 offset:2304
  v_mfma_f32_16x16x32_bf16 v[76:79], v[164:167], v[196:199], v[76:79]
  s_waitcnt lgkmcnt(10)
  v_mfma_f32_16x16x32_bf16 v[80:83], v[144:147], a[0:3], 0
  ds_read_b64_tr_b16 v[164:165], v209 offset:2048
  v_mfma_f32_16x16x32_bf16 v[84:87], v[144:147], a[4:7], 0
  buffer_load_dwordx4 v222, s[56:59], s38 offen lds
  v_mfma_f32_16x16x32_bf16 v[88:91], v[144:147], a[8:11], 0
  ds_read_b64_tr_b16 v[166:167], v209 offset:2304
  s_lshl_b32 s34, s21, 4
  s_add_u32 s34, s34, s22
  s_lshl_b32 s35, s20, 13
  s_lshl_b32 s18, s34, 16
  s_add_u32 s18, s18, s35
  s_add_u32 s18, s18, 20971520
  s_xor_b32 s19, s18, 1048576
  s_lshl_b32 s44, s34, 14
  s_lshl_b32 s35, s20, 12
  v_mfma_f32_16x16x32_bf16 v[92:95], v[144:147], a[12:15], 0
  s_add_u32 s44, s44, s35
  s_add_u32 s44, s44, 16777216
  s_lshr_b32 s34, s21, 1
  s_lshl_b32 s34, s34, 4
  s_add_u32 s34, s34, s22
  s_waitcnt lgkmcnt(10)
  v_mfma_f32_16x16x32_bf16 v[96:99], v[148:151], a[0:3], 0
  ds_read_b64_tr_b16 v[144:145], v208 offset:3072
  s_lshl_b32 s17, s34, 17
  s_lshl_b32 s35, s20, 13
  s_add_u32 s17, s17, s35
  s_lshl_b32 s27, s2, 7
  v_mfma_f32_16x16x32_bf16 v[100:103], v[148:151], a[4:7], 0
  buffer_load_dwordx4 v223, s[56:59], s38 offen offset:1024 lds
  s_add_u32 s27, s27, 37748736
  s_xor_b32 s26, s27, 1024
  s_lshl_b32 s35, s20, 2
  s_add_u32 s27, s27, s35
  s_mov_b32 s43, 0xffff0000
  v_mfma_f32_16x16x32_bf16 v[104:107], v[148:151], a[8:11], 0
  ds_read_b64_tr_b16 v[146:147], v208 offset:3328
  v_mfma_f32_16x16x32_bf16 v[108:111], v[148:151], a[12:15], 0
  s_waitcnt lgkmcnt(10)
  v_mfma_f32_16x16x32_bf16 v[80:83], v[152:155], a[16:19], v[80:83]
  ds_read_b64_tr_b16 v[148:149], v209 offset:3072
  v_mfma_f32_16x16x32_bf16 v[84:87], v[152:155], a[20:23], v[84:87]
  ds_read_b128 a[0:3], v234 offset:0
  v_mfma_f32_16x16x32_bf16 v[88:91], v[152:155], a[24:27], v[88:91]
  ds_read_b64_tr_b16 v[150:151], v209 offset:3328
  v_mul_f32 v48, v16, v48
  v_mfma_f32_16x16x32_bf16 v[92:95], v[152:155], a[28:31], v[92:95]
  ds_read_b128 a[4:7], v234 offset:2048
  v_mul_f32 v49, v17, v49
  s_waitcnt lgkmcnt(11)
  v_mfma_f32_16x16x32_bf16 v[96:99], v[156:159], a[16:19], v[96:99]
  ds_read_b64_tr_b16 v[152:153], v208 offset:4096
  v_mul_f32 v50, v18, v50
  v_mfma_f32_16x16x32_bf16 v[100:103], v[156:159], a[20:23], v[100:103]
  ds_read_b128 a[8:11], v234 offset:4096
  buffer_load_dwordx4 v224, s[56:59], s38 offen offset:2048 lds
  s_add_u32 m0, s25, 0
  s_add_u32 s38, s9, 0
  s_add_u32 s38, s38, s28
  v_mfma_f32_16x16x32_bf16 v[104:107], v[156:159], a[24:27], v[104:107]
  ds_read_b64_tr_b16 v[154:155], v208 offset:4352
  v_mul_f32 v51, v19, v51
  v_mfma_f32_16x16x32_bf16 v[108:111], v[156:159], a[28:31], v[108:111]
  ds_read_b128 a[12:15], v234 offset:6144
  v_mul_f32 v16, s39, v16
  s_waitcnt lgkmcnt(12)
  v_mfma_f32_16x16x32_bf16 v[80:83], v[160:163], a[32:35], v[80:83]
  ds_read_b64_tr_b16 v[156:157], v209 offset:4096
  v_mul_f32 v17, s39, v17
  v_mfma_f32_16x16x32_bf16 v[84:87], v[160:163], a[36:39], v[84:87]
  ds_read_b128 a[16:19], v235 offset:0
  v_mul_f32 v18, s39, v18
  v_mfma_f32_16x16x32_bf16 v[88:91], v[160:163], a[40:43], v[88:91]
  ds_read_b64_tr_b16 v[158:159], v209 offset:4352
  v_mul_f32 v19, s39, v19
  v_mfma_f32_16x16x32_bf16 v[92:95], v[160:163], a[44:47], v[92:95]
  ds_read_b128 a[20:23], v235 offset:2048
  v_mul_f32 v52, v20, v52
  s_waitcnt lgkmcnt(14)
  v_mfma_f32_16x16x32_bf16 v[96:99], v[164:167], a[32:35], v[96:99]
  ds_read_b64_tr_b16 v[160:161], v208 offset:5120
  v_mul_f32 v53, v21, v53
  v_mfma_f32_16x16x32_bf16 v[100:103], v[164:167], a[36:39], v[100:103]
  ds_read_b128 a[24:27], v235 offset:4096
  v_mul_f32 v54, v22, v54
  v_mfma_f32_16x16x32_bf16 v[104:107], v[164:167], a[40:43], v[104:107]
  ds_read_b64_tr_b16 v[162:163], v208 offset:5376
  v_mul_f32 v55, v23, v55
  v_mfma_f32_16x16x32_bf16 v[108:111], v[164:167], a[44:47], v[108:111]
  ds_read_b128 a[28:31], v235 offset:6144
  v_mul_f32 v20, s39, v20
  s_waitcnt lgkmcnt(15)
  v_mfma_f32_16x16x32_bf16 v[80:83], v[144:147], a[48:51], v[80:83]
  ds_read_b64_tr_b16 v[164:165], v209 offset:5120
  v_mul_f32 v21, s39, v21
  v_mfma_f32_16x16x32_bf16 v[84:87], v[144:147], a[52:55], v[84:87]
  ds_read_b128 a[32:35], v234 offset:16384
  v_mul_f32 v22, s39, v22
  v_mfma_f32_16x16x32_bf16 v[88:91], v[144:147], a[56:59], v[88:91]
  ds_read_b64_tr_b16 v[166:167], v209 offset:5376
  v_exp_f32 v16, -v16
  v_mfma_f32_16x16x32_bf16 v[92:95], v[144:147], a[60:63], v[92:95]
  ds_read_b128 a[36:39], v234 offset:18432
  v_exp_f32 v17, -v17
  s_waitcnt lgkmcnt(15)
  v_mfma_f32_16x16x32_bf16 v[96:99], v[148:151], a[48:51], v[96:99]
  ds_read_b128 a[40:43], v234 offset:20480
  v_exp_f32 v18, -v18
  v_mfma_f32_16x16x32_bf16 v[100:103], v[148:151], a[52:55], v[100:103]
  ds_read_b128 a[44:47], v234 offset:22528
  v_exp_f32 v19, -v19
  v_mfma_f32_16x16x32_bf16 v[104:107], v[148:151], a[56:59], v[104:107]
  v_add_f32 v16, 1.0, v16
  v_mul_f32 v23, s39, v23
  v_mfma_f32_16x16x32_bf16 v[108:111], v[148:151], a[60:63], v[108:111]
  v_add_f32 v17, 1.0, v17
  v_exp_f32 v20, -v20
  s_waitcnt lgkmcnt(0)
  s_waitcnt vmcnt(6)
  s_barrier
  v_mfma_f32_16x16x32_bf16 v[80:83], v[152:155], a[64:67], v[80:83]
  ds_read_b64_tr_b16 v[144:145], v208 offset:24576
  v_add_f32 v18, 1.0, v18
  v_mfma_f32_16x16x32_bf16 v[84:87], v[152:155], a[68:71], v[84:87]
  ds_read_b128 a[48:51], v235 offset:16384
  v_add_f32 v19, 1.0, v19
  v_mfma_f32_16x16x32_bf16 v[88:91], v[152:155], a[72:75], v[88:91]
  ds_read_b64_tr_b16 v[146:147], v208 offset:24832
  v_exp_f32 v21, -v21
  v_mfma_f32_16x16x32_bf16 v[92:95], v[152:155], a[76:79], v[92:95]
  ds_read_b64_tr_b16 v[148:149], v209 offset:24576
  v_exp_f32 v22, -v22
  v_mfma_f32_16x16x32_bf16 v[96:99], v[156:159], a[64:67], v[96:99]
  ds_read_b64_tr_b16 v[150:151], v209 offset:24832
  buffer_load_dwordx4 v225, s[60:63], s38 offen lds
  v_mfma_f32_16x16x32_bf16 v[100:103], v[156:159], a[68:71], v[100:103]
  ds_read_b64_tr_b16 v[152:153], v208 offset:25600
  v_rcp_f32 v16, v16
  v_mfma_f32_16x16x32_bf16 v[104:107], v[156:159], a[72:75], v[104:107]
  ds_read_b64_tr_b16 v[154:155], v208 offset:25856
  v_rcp_f32 v17, v17
  v_mfma_f32_16x16x32_bf16 v[108:111], v[156:159], a[76:79], v[108:111]
  ds_read_b128 a[52:55], v235 offset:18432
  v_rcp_f32 v18, v18
  v_mfma_f32_16x16x32_bf16 v[80:83], v[160:163], a[80:83], v[80:83]
  ds_read_b64_tr_b16 v[156:157], v209 offset:25600
  v_rcp_f32 v19, v19
  v_mfma_f32_16x16x32_bf16 v[84:87], v[160:163], a[84:87], v[84:87]
  ds_read_b128 a[56:59], v235 offset:20480
  buffer_load_dwordx4 v226, s[60:63], s38 offen offset:1024 lds
  v_mfma_f32_16x16x32_bf16 v[88:91], v[160:163], a[88:91], v[88:91]
  ds_read_b64_tr_b16 v[158:159], v209 offset:25856
  v_mul_f32 v48, v16, v48
  v_mfma_f32_16x16x32_bf16 v[92:95], v[160:163], a[92:95], v[92:95]
  ds_read_b128 a[60:63], v235 offset:22528
  v_mul_f32 v49, v17, v49
  v_mfma_f32_16x16x32_bf16 v[96:99], v[164:167], a[80:83], v[96:99]
  ds_read_b64_tr_b16 v[160:161], v208 offset:26624
  v_mul_f32 v50, v18, v50
  v_mfma_f32_16x16x32_bf16 v[100:103], v[164:167], a[84:87], v[100:103]
  ds_read_b128 a[64:67], v234 offset:32768
  v_mul_f32 v51, v19, v51
  v_mfma_f32_16x16x32_bf16 v[104:107], v[164:167], a[88:91], v[104:107]
  ds_read_b64_tr_b16 v[162:163], v208 offset:26880
  buffer_load_dwordx4 v227, s[60:63], s38 offen offset:2048 lds
  s_add_u32 m0, s25, 3072
  s_add_u32 s38, s9, 55296
  s_add_u32 s38, s38, s28
  v_mfma_f32_16x16x32_bf16 v[108:111], v[164:167], a[92:95], v[108:111]
  ds_read_b128 a[68:71], v234 offset:34816
  v_cvt_pk_bf16_f32 v16, v48, v49
  s_waitcnt lgkmcnt(13)
  v_mfma_f32_16x16x32_bf16 v[80:83], v[144:147], a[96:99], v[80:83]
  ds_read_b64_tr_b16 v[164:165], v209 offset:26624
  v_cvt_pk_bf16_f32 v17, v50, v51
  v_mfma_f32_16x16x32_bf16 v[84:87], v[144:147], a[100:103], v[84:87]
  ds_read_b128 a[72:75], v234 offset:36864
  ds_write_b64 v231, v[16:17] offset:49152
  v_mfma_f32_16x16x32_bf16 v[88:91], v[144:147], a[104:107], v[88:91]
  ds_read_b64_tr_b16 v[166:167], v209 offset:26880
  v_mul_f32 v56, v24, v56
  v_mfma_f32_16x16x32_bf16 v[92:95], v[144:147], a[108:111], v[92:95]
  ds_read_b128 a[76:79], v234 offset:38912
  buffer_load_dwordx4 v225, s[60:63], s38 offen lds
  s_add_u32 m0, s25, 4096
  s_add_u32 s38, s10, 0
  s_add_u32 s38, s38, s28
  s_waitcnt lgkmcnt(15)
  v_mfma_f32_16x16x32_bf16 v[96:99], v[148:151], a[96:99], v[96:99]
  ds_read_b64_tr_b16 v[144:145], v208 offset:27648
  v_mul_f32 v57, v25, v57
  v_mfma_f32_16x16x32_bf16 v[100:103], v[148:151], a[100:103], v[100:103]
  ds_read_b128 a[80:83], v235 offset:32768
  v_mul_f32 v58, v26, v58
  v_mfma_f32_16x16x32_bf16 v[104:107], v[148:151], a[104:107], v[104:107]
  ds_read_b64_tr_b16 v[146:147], v208 offset:27904
  v_mul_f32 v59, v27, v59
  v_mfma_f32_16x16x32_bf16 v[108:111], v[148:151], a[108:111], v[108:111]
  ds_read_b128 a[84:87], v235 offset:34816
  v_mul_f32 v24, s39, v24
  s_waitcnt lgkmcnt(15)
  v_mfma_f32_16x16x32_bf16 v[80:83], v[152:155], a[112:115], v[80:83]
  ds_read_b64_tr_b16 v[148:149], v209 offset:27648
  buffer_load_dwordx4 v225, s[60:63], s38 offen lds
  v_mfma_f32_16x16x32_bf16 v[84:87], v[152:155], a[116:119], v[84:87]
  ds_read_b128 a[88:91], v235 offset:36864
  v_mul_f32 v25, s39, v25
  v_mfma_f32_16x16x32_bf16 v[88:91], v[152:155], a[120:123], v[88:91]
  ds_read_b64_tr_b16 v[150:151], v209 offset:27904
  v_mul_f32 v26, s39, v26
  v_mfma_f32_16x16x32_bf16 v[92:95], v[152:155], a[124:127], v[92:95]
  ds_read_b128 a[92:95], v235 offset:38912
  v_mul_f32 v27, s39, v27
  s_waitcnt lgkmcnt(15)
  v_mfma_f32_16x16x32_bf16 v[96:99], v[156:159], a[112:115], v[96:99]
  ds_read_b64_tr_b16 v[152:153], v208 offset:28672
  v_exp_f32 v24, -v24
  v_mfma_f32_16x16x32_bf16 v[100:103], v[156:159], a[116:119], v[100:103]
  ds_read_b128 a[96:99], v236 offset:64
  buffer_load_dwordx4 v226, s[60:63], s38 offen offset:1024 lds
  s_add_u32 m0, s25, 24576
  s_add_u32 s38, s10, 36864
  s_add_u32 s38, s38, s28
  v_mfma_f32_16x16x32_bf16 v[104:107], v[156:159], a[120:123], v[104:107]
  ds_read_b64_tr_b16 v[154:155], v208 offset:28928
  v_exp_f32 v25, -v25
  v_mfma_f32_16x16x32_bf16 v[108:111], v[156:159], a[124:127], v[108:111]
  ds_read_b128 a[100:103], v236 offset:2368
  v_exp_f32 v26, -v26
  s_waitcnt lgkmcnt(15)
  v_mfma_f32_16x16x32_bf16 v[80:83], v[160:163], a[128:131], v[80:83]
  ds_read_b64_tr_b16 v[156:157], v209 offset:28672
  v_exp_f32 v27, -v27
  v_mfma_f32_16x16x32_bf16 v[84:87], v[160:163], a[132:135], v[84:87]
  ds_read_b128 a[104:107], v236 offset:4672
  v_add_f32 v24, 1.0, v24
  v_mfma_f32_16x16x32_bf16 v[88:91], v[160:163], a[136:139], v[88:91]
  ds_read_b64_tr_b16 v[158:159], v209 offset:28928
  v_add_f32 v25, 1.0, v25
  v_mfma_f32_16x16x32_bf16 v[92:95], v[160:163], a[140:143], v[92:95]
  ds_read_b128 a[108:111], v236 offset:6976
  v_add_f32 v26, 1.0, v26
  s_waitcnt lgkmcnt(15)
  v_mfma_f32_16x16x32_bf16 v[96:99], v[164:167], a[128:131], v[96:99]
  ds_read_b64_tr_b16 v[160:161], v208 offset:29696
  v_accvgpr_write_b32 a112, 0
  v_mfma_f32_16x16x32_bf16 v[100:103], v[164:167], a[132:135], v[100:103]
  v_accvgpr_write_b32 a113, 0
  v_add_f32 v27, 1.0, v27
  v_mfma_f32_16x16x32_bf16 v[104:107], v[164:167], a[136:139], v[104:107]
  ds_read_b64_tr_b16 v[162:163], v208 offset:29952
  v_accvgpr_write_b32 a114, 0
  v_mfma_f32_16x16x32_bf16 v[108:111], v[164:167], a[140:143], v[108:111]
  v_accvgpr_write_b32 a115, 0
  v_rcp_f32 v24, v24
  s_waitcnt lgkmcnt(15)
  v_mfma_f32_16x16x32_bf16 v[80:83], v[144:147], a[144:147], v[80:83]
  ds_read_b64_tr_b16 v[164:165], v209 offset:29696
  v_accvgpr_write_b32 a116, 0
  v_mfma_f32_16x16x32_bf16 v[84:87], v[144:147], a[148:151], v[84:87]
  v_accvgpr_write_b32 a117, 0
  v_rcp_f32 v25, v25
  v_mfma_f32_16x16x32_bf16 v[88:91], v[144:147], a[152:155], v[88:91]
  ds_read_b64_tr_b16 v[166:167], v209 offset:29952
  v_accvgpr_write_b32 a118, 0
  v_mfma_f32_16x16x32_bf16 v[92:95], v[144:147], a[156:159], v[92:95]
  v_accvgpr_write_b32 a119, 0
  v_rcp_f32 v26, v26
  s_waitcnt lgkmcnt(13)
  v_mfma_f32_16x16x32_bf16 v[96:99], v[148:151], a[144:147], v[96:99]
  v_accvgpr_write_b32 a120, 0
  v_rcp_f32 v27, v27
  v_mfma_f32_16x16x32_bf16 v[100:103], v[148:151], a[148:151], v[100:103]
  v_accvgpr_write_b32 a121, 0
  v_mul_f32 v56, v24, v56
  v_mfma_f32_16x16x32_bf16 v[104:107], v[148:151], a[152:155], v[104:107]
  v_accvgpr_write_b32 a122, 0
  v_mul_f32 v57, v25, v57
  v_mfma_f32_16x16x32_bf16 v[108:111], v[148:151], a[156:159], v[108:111]
  v_accvgpr_write_b32 a123, 0
  v_mul_f32 v58, v26, v58
  s_waitcnt lgkmcnt(0)
  s_waitcnt vmcnt(6)
  s_barrier
  v_mfma_f32_16x16x32_bf16 v[80:83], v[152:155], a[160:163], v[80:83]
  ds_read_b64_tr_b16 v[144:145], v208 offset:49152
  v_accvgpr_write_b32 a124, 0
  v_mfma_f32_16x16x32_bf16 v[84:87], v[152:155], a[164:167], v[84:87]
  v_accvgpr_write_b32 a125, 0
  v_mul_f32 v59, v27, v59
  v_mfma_f32_16x16x32_bf16 v[88:91], v[152:155], a[168:171], v[88:91]
  ds_read_b64_tr_b16 v[146:147], v208 offset:49408
  v_accvgpr_write_b32 a126, 0
  v_mfma_f32_16x16x32_bf16 v[92:95], v[152:155], a[172:175], v[92:95]
  ds_read_b64_tr_b16 v[148:149], v209 offset:49152
  v_accvgpr_write_b32 a127, 0
  v_mfma_f32_16x16x32_bf16 v[96:99], v[156:159], a[160:163], v[96:99]
  ds_read_b64_tr_b16 v[150:151], v209 offset:49408
  buffer_load_dwordx4 v225, s[60:63], s38 offen lds
  v_mfma_f32_16x16x32_bf16 v[100:103], v[156:159], a[164:167], v[100:103]
  ds_read_b64_tr_b16 v[152:153], v208 offset:50176
  v_cvt_pk_bf16_f32 v24, v56, v57
  v_mfma_f32_16x16x32_bf16 v[104:107], v[156:159], a[168:171], v[104:107]
  ds_read_b64_tr_b16 v[154:155], v208 offset:50432
  v_cvt_pk_bf16_f32 v25, v58, v59
  v_mfma_f32_16x16x32_bf16 v[108:111], v[156:159], a[172:175], v[108:111]
  s_mov_b64 exec, 0xffff
  ds_read_b128 a[112:115], v236 offset:128
  ds_read_b128 a[116:119], v236 offset:2432
  ds_read_b128 a[120:123], v236 offset:4736
  ds_read_b128 a[124:127], v236 offset:7040
  s_mov_b64 exec, -1
  ds_write_b64 v231, v[24:25] offset:53248
  v_mfma_f32_16x16x32_bf16 v[80:83], v[160:163], a[176:179], v[80:83]
  ds_read_b64_tr_b16 v[156:157], v209 offset:50176
  v_mul_f32 v64, v32, v64
  v_mfma_f32_16x16x32_bf16 v[84:87], v[160:163], a[180:183], v[84:87]
  buffer_load_dwordx4 v226, s[60:63], s38 offen offset:1024 lds
  s_add_u32 m0, s25, 26624
  s_add_u32 s38, s11, 0
  s_add_u32 s38, s38, s28
  v_mfma_f32_16x16x32_bf16 v[88:91], v[160:163], a[184:187], v[88:91]
  ds_read_b64_tr_b16 v[158:159], v209 offset:50432
  v_mul_f32 v65, v33, v65
  v_mfma_f32_16x16x32_bf16 v[92:95], v[160:163], a[188:191], v[92:95]
  buffer_load_dwordx4 v225, s[60:63], s38 offen lds
  v_mfma_f32_16x16x32_bf16 v[96:99], v[164:167], a[176:179], v[96:99]
  ds_read_b64_tr_b16 v[160:161], v208 offset:51200
  v_mul_f32 v66, v34, v66
  v_mfma_f32_16x16x32_bf16 v[100:103], v[164:167], a[180:183], v[100:103]
  v_mul_f32 v67, v35, v67
  v_exp_f32 v23, -v23
  v_mfma_f32_16x16x32_bf16 v[104:107], v[164:167], a[184:187], v[104:107]
  ds_read_b64_tr_b16 v[162:163], v208 offset:51456
  v_mul_f32 v32, s39, v32
  v_mfma_f32_16x16x32_bf16 v[108:111], v[164:167], a[188:191], v[108:111]
  v_mul_f32 v33, s39, v33
  v_add_f32 v20, 1.0, v20
  s_waitcnt lgkmcnt(13)
  v_mfma_f32_16x16x32_bf16 v[80:83], v[144:147], a[192:195], v[80:83]
  ds_read_b64_tr_b16 v[164:165], v209 offset:51200
  v_mul_f32 v34, s39, v34
  v_mfma_f32_16x16x32_bf16 v[84:87], v[144:147], a[196:199], v[84:87]
  buffer_load_dwordx4 v226, s[60:63], s38 offen offset:1024 lds
  v_mfma_f32_16x16x32_bf16 v[88:91], v[144:147], a[200:203], v[88:91]
  ds_read_b64_tr_b16 v[166:167], v209 offset:51456
  v_mul_f32 v35, s39, v35
  v_mfma_f32_16x16x32_bf16 v[92:95], v[144:147], a[204:207], v[92:95]
  v_exp_f32 v32, -v32
  s_waitcnt lgkmcnt(13)
  v_mfma_f32_16x16x32_bf16 v[96:99], v[148:151], a[192:195], v[96:99]
  ds_read_b64_tr_b16 v[144:145], v208 offset:52224
  v_exp_f32 v33, -v33
  v_mfma_f32_16x16x32_bf16 v[100:103], v[148:151], a[196:199], v[100:103]
  buffer_load_dwordx4 v227, s[60:63], s38 offen offset:2048 lds
  s_add_u32 m0, s25, 29696
  s_add_u32 s38, s11, 55296
  s_add_u32 s38, s38, s28
  v_mfma_f32_16x16x32_bf16 v[104:107], v[148:151], a[200:203], v[104:107]
  ds_read_b64_tr_b16 v[146:147], v208 offset:52480
  v_exp_f32 v34, -v34
  v_mfma_f32_16x16x32_bf16 v[108:111], v[148:151], a[204:207], v[108:111]
  v_exp_f32 v35, -v35
  s_waitcnt lgkmcnt(13)
  v_mfma_f32_16x16x32_bf16 v[80:83], v[152:155], a[208:211], v[80:83]
  ds_read_b64_tr_b16 v[148:149], v209 offset:52224
  v_add_f32 v32, 1.0, v32
  v_mfma_f32_16x16x32_bf16 v[84:87], v[152:155], a[212:215], v[84:87]
  v_add_f32 v33, 1.0, v33
  v_add_f32 v21, 1.0, v21
  v_mfma_f32_16x16x32_bf16 v[88:91], v[152:155], a[216:219], v[88:91]
  ds_read_b64_tr_b16 v[150:151], v209 offset:52480
  v_add_f32 v34, 1.0, v34
  v_mfma_f32_16x16x32_bf16 v[92:95], v[152:155], a[220:223], v[92:95]
  buffer_load_dwordx4 v225, s[60:63], s38 offen lds
  s_add_u32 m0, s25, 49152
  s_add_u32 s38, s16, 0
  s_add_u32 s38, s38, s28
  s_waitcnt lgkmcnt(8)
  v_mfma_f32_16x16x32_bf16 v[96:99], v[156:159], a[208:211], v[96:99]
  ds_read_b64_tr_b16 v[152:153], v208 offset:53248
  v_add_f32 v35, 1.0, v35
  v_mfma_f32_16x16x32_bf16 v[100:103], v[156:159], a[212:215], v[100:103]
  v_rcp_f32 v32, v32
  v_mfma_f32_16x16x32_bf16 v[104:107], v[156:159], a[216:219], v[104:107]
  ds_read_b64_tr_b16 v[154:155], v208 offset:53504
  v_rcp_f32 v33, v33
  v_mfma_f32_16x16x32_bf16 v[108:111], v[156:159], a[220:223], v[108:111]
  v_rcp_f32 v34, v34
  s_waitcnt lgkmcnt(8)
  v_mfma_f32_16x16x32_bf16 v[80:83], v[160:163], a[224:227], v[80:83]
  ds_read_b64_tr_b16 v[156:157], v209 offset:53248
  v_rcp_f32 v35, v35
  v_mfma_f32_16x16x32_bf16 v[84:87], v[160:163], a[228:231], v[84:87]
  v_mul_f32 v64, v32, v64
  v_add_f32 v22, 1.0, v22
  v_mfma_f32_16x16x32_bf16 v[88:91], v[160:163], a[232:235], v[88:91]
  ds_read_b64_tr_b16 v[158:159], v209 offset:53504
  v_mul_f32 v65, v33, v65
  v_mfma_f32_16x16x32_bf16 v[92:95], v[160:163], a[236:239], v[92:95]
  v_mul_f32 v66, v34, v66
  v_add_f32 v23, 1.0, v23
  s_waitcnt lgkmcnt(8)
  v_mfma_f32_16x16x32_bf16 v[96:99], v[164:167], a[224:227], v[96:99]
  ds_read_b64_tr_b16 v[160:161], v208 offset:54272
  v_mul_f32 v67, v35, v67
  v_mfma_f32_16x16x32_bf16 v[100:103], v[164:167], a[228:231], v[100:103]
  v_cvt_pk_bf16_f32 v32, v64, v65
  v_rcp_f32 v20, v20
  v_mfma_f32_16x16x32_bf16 v[104:107], v[164:167], a[232:235], v[104:107]
  ds_read_b64_tr_b16 v[162:163], v208 offset:54528
  v_cvt_pk_bf16_f32 v33, v66, v67
  v_mfma_f32_16x16x32_bf16 v[108:111], v[164:167], a[236:239], v[108:111]
  ds_write_b64 v232, v[32:33] offset:49152
  s_waitcnt lgkmcnt(9)
  v_mfma_f32_16x16x32_bf16 v[80:83], v[144:147], a[240:243], v[80:83]
  ds_read_b64_tr_b16 v[164:165], v209 offset:54272
  v_mul_f32 v72, v40, v72
  v_mfma_f32_16x16x32_bf16 v[84:87], v[144:147], a[244:247], v[84:87]
  v_mul_f32 v73, v41, v73
  v_rcp_f32 v21, v21
  v_mfma_f32_16x16x32_bf16 v[88:91], v[144:147], a[248:251], v[88:91]
  ds_read_b64_tr_b16 v[166:167], v209 offset:54528
  v_mul_f32 v74, v42, v74
  v_mfma_f32_16x16x32_bf16 v[92:95], v[144:147], a[252:255], v[92:95]
  v_mul_f32 v75, v43, v75
  v_rcp_f32 v22, v22
  s_waitcnt lgkmcnt(9)
  v_mfma_f32_16x16x32_bf16 v[96:99], v[148:151], a[240:243], v[96:99]
  v_mul_f32 v40, s39, v40
  v_rcp_f32 v23, v23
  v_mfma_f32_16x16x32_bf16 v[100:103], v[148:151], a[244:247], v[100:103]
  v_mul_f32 v41, s39, v41
  v_mul_f32 v52, v20, v52
  v_mfma_f32_16x16x32_bf16 v[104:107], v[148:151], a[248:251], v[104:107]
  v_mul_f32 v42, s39, v42
  v_mul_f32 v53, v21, v53
  v_mfma_f32_16x16x32_bf16 v[108:111], v[148:151], a[252:255], v[108:111]
  v_mul_f32 v43, s39, v43
  v_mul_f32 v54, v22, v54
  s_waitcnt lgkmcnt(0)
  s_waitcnt vmcnt(6)
  s_barrier
  v_mfma_f32_16x16x32_bf16 v[80:83], v[152:155], v[168:171], v[80:83]
  ds_read_b64_tr_b16 v[144:145], v210 offset:0
  v_exp_f32 v40, -v40
  v_mfma_f32_16x16x32_bf16 v[84:87], v[152:155], v[172:175], v[84:87]
  buffer_load_dwordx4 v225, s[64:67], s38 offen lds
  v_mfma_f32_16x16x32_bf16 v[88:91], v[152:155], v[176:179], v[88:91]
  ds_read_b64_tr_b16 v[146:147], v210 offset:6144
  v_exp_f32 v41, -v41
  v_mfma_f32_16x16x32_bf16 v[92:95], v[152:155], v[180:183], v[92:95]
  ds_read_b64_tr_b16 v[148:149], v211 offset:0
  v_exp_f32 v42, -v42
  v_mfma_f32_16x16x32_bf16 v[96:99], v[156:159], v[168:171], v[96:99]
  ds_read_b64_tr_b16 v[150:151], v211 offset:6144
  v_exp_f32 v43, -v43
  v_mfma_f32_16x16x32_bf16 v[100:103], v[156:159], v[172:175], v[100:103]
  ds_read_b64_tr_b16 v[152:153], v212 offset:0
  v_add_f32 v40, 1.0, v40
  v_mfma_f32_16x16x32_bf16 v[104:107], v[156:159], v[176:179], v[104:107]
  ds_read_b64_tr_b16 v[154:155], v212 offset:6144
  v_add_f32 v41, 1.0, v41
  v_mfma_f32_16x16x32_bf16 v[108:111], v[156:159], v[180:183], v[108:111]
  buffer_load_dwordx4 v226, s[64:67], s38 offen offset:1024 lds
  v_mfma_f32_16x16x32_bf16 v[80:83], v[160:163], v[184:187], v[80:83]
  ds_read_b64_tr_b16 v[156:157], v213 offset:0
  v_add_f32 v42, 1.0, v42
  v_mfma_f32_16x16x32_bf16 v[84:87], v[160:163], v[188:191], v[84:87]
  v_add_f32 v43, 1.0, v43
  v_mul_f32 v55, v23, v55
  v_mfma_f32_16x16x32_bf16 v[88:91], v[160:163], v[192:195], v[88:91]
  ds_read_b64_tr_b16 v[158:159], v213 offset:6144
  v_rcp_f32 v40, v40
  v_mfma_f32_16x16x32_bf16 v[92:95], v[160:163], v[196:199], v[92:95]
  buffer_load_dwordx4 v227, s[64:67], s38 offen offset:2048 lds
  s_add_u32 m0, s25, 52224
  s_add_u32 s38, s16, 55296
  s_add_u32 s38, s38, s28
  v_mfma_f32_16x16x32_bf16 v[96:99], v[164:167], v[184:187], v[96:99]
  ds_read_b64_tr_b16 v[160:161], v210 offset:2048
  v_rcp_f32 v41, v41
  v_mfma_f32_16x16x32_bf16 v[100:103], v[164:167], v[188:191], v[100:103]
  v_rcp_f32 v42, v42
  v_mfma_f32_16x16x32_bf16 v[104:107], v[164:167], v[192:195], v[104:107]
  ds_read_b64_tr_b16 v[162:163], v210 offset:8192
  v_rcp_f32 v43, v43
  v_mfma_f32_16x16x32_bf16 v[108:111], v[164:167], v[196:199], v[108:111]
  v_mul_f32 v72, v40, v72
  v_cvt_pk_bf16_f32 v20, v52, v53
  v_mul_f32 v73, v41, v73
  v_cvt_pk_bf16_f32 v21, v54, v55
  v_mul_f32 v74, v42, v74
  ds_write_b64 v231, v[20:21] offset:51200
  v_mul_f32 v75, v43, v75
  v_mul_f32 v60, v28, v60
  v_cvt_pk_bf16_f32 v40, v72, v73
  v_mul_f32 v61, v29, v61
  v_cvt_pk_bf16_f32 v41, v74, v75
  v_mul_f32 v62, v30, v62
  ds_write_b64 v232, v[40:41] offset:53248
  v_mul_f32 v63, v31, v63
  v_mul_f32 v28, s39, v28
  v_mul_f32 v29, s39, v29
  v_mul_f32 v30, s39, v30
  v_mul_f32 v31, s39, v31
  v_exp_f32 v28, -v28
  v_exp_f32 v29, -v29
  v_exp_f32 v30, -v30
  v_exp_f32 v31, -v31
  v_add_f32 v28, 1.0, v28
  v_add_f32 v29, 1.0, v29
  v_add_f32 v30, 1.0, v30
  v_add_f32 v31, 1.0, v31
  v_rcp_f32 v28, v28
  v_rcp_f32 v29, v29
  v_rcp_f32 v30, v30
  v_rcp_f32 v31, v31
  v_mul_f32 v60, v28, v60
  v_mul_f32 v61, v29, v61
  v_mul_f32 v62, v30, v62
  v_mul_f32 v63, v31, v63
  v_cvt_pk_bf16_f32 v28, v60, v61
  v_cvt_pk_bf16_f32 v29, v62, v63
  ds_write_b64 v231, v[28:29] offset:55296
  v_mul_f32 v68, v36, v68
  v_mul_f32 v69, v37, v69
  v_mul_f32 v70, v38, v70
  v_mul_f32 v71, v39, v71
  v_mul_f32 v36, s39, v36
  v_mul_f32 v37, s39, v37
  v_mul_f32 v38, s39, v38
  v_mul_f32 v39, s39, v39
  v_exp_f32 v36, -v36
  v_exp_f32 v37, -v37
  v_exp_f32 v38, -v38
  v_exp_f32 v39, -v39
  v_add_f32 v36, 1.0, v36
  v_add_f32 v37, 1.0, v37
  v_add_f32 v38, 1.0, v38
  v_add_f32 v39, 1.0, v39
  v_rcp_f32 v36, v36
  v_rcp_f32 v37, v37
  v_rcp_f32 v38, v38
  v_rcp_f32 v39, v39
  v_mul_f32 v68, v36, v68
  v_mul_f32 v69, v37, v69
  v_mul_f32 v70, v38, v70
  v_mul_f32 v71, v39, v71
  v_cvt_pk_bf16_f32 v36, v68, v69
  v_cvt_pk_bf16_f32 v37, v70, v71
  ds_write_b64 v232, v[36:37] offset:51200
  v_mul_f32 v76, v44, v76
  v_mul_f32 v77, v45, v77
  v_mul_f32 v78, v46, v78
  v_mul_f32 v79, v47, v79
  v_mul_f32 v44, s39, v44
  v_mul_f32 v45, s39, v45
  v_mul_f32 v46, s39, v46
  v_mul_f32 v47, s39, v47
  v_exp_f32 v44, -v44
  v_exp_f32 v45, -v45
  v_exp_f32 v46, -v46
  v_exp_f32 v47, -v47
  v_add_f32 v44, 1.0, v44
  v_add_f32 v45, 1.0, v45
  v_add_f32 v46, 1.0, v46
  v_add_f32 v47, 1.0, v47
  v_rcp_f32 v44, v44
  v_rcp_f32 v45, v45
  v_rcp_f32 v46, v46
  v_rcp_f32 v47, v47
  v_mul_f32 v76, v44, v76
  v_mul_f32 v77, v45, v77
  v_mul_f32 v78, v46, v78
  v_mul_f32 v79, v47, v79
  v_cvt_pk_bf16_f32 v44, v76, v77
  v_cvt_pk_bf16_f32 v45, v78, v79
  ds_write_b64 v232, v[44:45] offset:55296
  s_waitcnt lgkmcnt(13)
  v_mfma_f32_16x16x32_bf16 v[16:19], v[144:147], a[0:3], 0
  ds_read_b64_tr_b16 v[164:165], v211 offset:2048
  v_mfma_f32_16x16x32_bf16 v[20:23], v[144:147], a[4:7], 0
  buffer_load_dwordx4 v225, s[64:67], s38 offen lds
  s_add_u32 m0, s25, 53248
  s_add_u32 s38, s12, 0
  s_add_u32 s38, s38, s28
  v_mfma_f32_16x16x32_bf16 v[24:27], v[144:147], a[8:11], 0
  ds_read_b64_tr_b16 v[166:167], v211 offset:8192
  v_add_u32 v168, 73728, v210
  v_mfma_f32_16x16x32_bf16 v[28:31], v[144:147], a[12:15], 0
  v_add_u32 v169, 73728, v211
  v_add_u32 v170, 73728, v212
  s_waitcnt lgkmcnt(13)
  v_mfma_f32_16x16x32_bf16 v[32:35], v[148:151], a[0:3], 0
  ds_read_b64_tr_b16 v[144:145], v212 offset:2048
  v_add_u32 v171, 73728, v213
  v_mfma_f32_16x16x32_bf16 v[36:39], v[148:151], a[4:7], 0
  buffer_load_dwordx4 v225, s[60:63], s38 offen lds
  v_mfma_f32_16x16x32_bf16 v[40:43], v[148:151], a[8:11], 0
  ds_read_b64_tr_b16 v[146:147], v212 offset:8192
  v_add_u32 v172, 73728, v214
  v_mfma_f32_16x16x32_bf16 v[44:47], v[148:151], a[12:15], 0
  v_add_u32 v173, 73728, v215
  s_waitcnt lgkmcnt(13)
  v_mfma_f32_16x16x32_bf16 v[48:51], v[152:155], a[0:3], 0
  ds_read_b64_tr_b16 v[148:149], v213 offset:2048
  v_mfma_f32_16x16x32_bf16 v[52:55], v[152:155], a[4:7], 0
  v_mfma_f32_16x16x32_bf16 v[56:59], v[152:155], a[8:11], 0
  ds_read_b64_tr_b16 v[150:151], v213 offset:8192
  v_mul_f32 v96, v80, v96
  v_mfma_f32_16x16x32_bf16 v[60:63], v[152:155], a[12:15], 0
  buffer_load_dwordx4 v226, s[60:63], s38 offen offset:1024 lds
  s_add_u32 m0, s25, 73728
  s_add_u32 s38, s12, 36864
  s_add_u32 s38, s38, s28
  s_waitcnt lgkmcnt(13)
  v_mfma_f32_16x16x32_bf16 v[64:67], v[156:159], a[0:3], 0
  ds_read_b64_tr_b16 v[152:153], v210 offset:4096
  v_mul_f32 v97, v81, v97
  v_mfma_f32_16x16x32_bf16 v[68:71], v[156:159], a[4:7], 0
  v_mul_f32 v98, v82, v98
  v_mul_f32 v100, v84, v100
  v_mfma_f32_16x16x32_bf16 v[72:75], v[156:159], a[8:11], 0
  ds_read_b64_tr_b16 v[154:155], v210 offset:10240
  v_mul_f32 v99, v83, v99
  v_mfma_f32_16x16x32_bf16 v[76:79], v[156:159], a[12:15], 0
  v_mul_f32 v80, s39, v80
  v_mul_f32 v101, v85, v101
  s_waitcnt lgkmcnt(13)
  v_mfma_f32_16x16x32_bf16 v[16:19], v[160:163], a[16:19], v[16:19]
  ds_read_b64_tr_b16 v[156:157], v211 offset:4096
  v_mul_f32 v81, s39, v81
  v_mfma_f32_16x16x32_bf16 v[20:23], v[160:163], a[20:23], v[20:23]
  v_mul_f32 v82, s39, v82
  v_mul_f32 v102, v86, v102
  v_mfma_f32_16x16x32_bf16 v[24:27], v[160:163], a[24:27], v[24:27]
  ds_read_b64_tr_b16 v[158:159], v211 offset:10240
  v_mul_f32 v83, s39, v83
  v_mfma_f32_16x16x32_bf16 v[28:31], v[160:163], a[28:31], v[28:31]
  v_exp_f32 v80, -v80
  s_waitcnt lgkmcnt(8)
  v_mfma_f32_16x16x32_bf16 v[32:35], v[164:167], a[16:19], v[32:35]
  ds_read_b64_tr_b16 v[160:161], v212 offset:4096
  v_mul_f32 v103, v87, v103
  v_mfma_f32_16x16x32_bf16 v[36:39], v[164:167], a[20:23], v[36:39]
  v_exp_f32 v81, -v81
  v_mfma_f32_16x16x32_bf16 v[40:43], v[164:167], a[24:27], v[40:43]
  ds_read_b64_tr_b16 v[162:163], v212 offset:10240
  v_mul_f32 v84, s39, v84
  v_mfma_f32_16x16x32_bf16 v[44:47], v[164:167], a[28:31], v[44:47]
  v_exp_f32 v82, -v82
  s_waitcnt lgkmcnt(8)
  v_mfma_f32_16x16x32_bf16 v[48:51], v[144:147], a[16:19], v[48:51]
  ds_read_b64_tr_b16 v[164:165], v213 offset:4096
  v_mul_f32 v85, s39, v85
  v_mfma_f32_16x16x32_bf16 v[52:55], v[144:147], a[20:23], v[52:55]
  v_exp_f32 v83, -v83
  v_mfma_f32_16x16x32_bf16 v[56:59], v[144:147], a[24:27], v[56:59]
  ds_read_b64_tr_b16 v[166:167], v213 offset:10240
  v_add_f32 v80, 1.0, v80
  v_mfma_f32_16x16x32_bf16 v[60:63], v[144:147], a[28:31], v[60:63]
  v_add_f32 v81, 1.0, v81
  v_mul_f32 v86, s39, v86
  s_waitcnt lgkmcnt(8)
  v_mfma_f32_16x16x32_bf16 v[64:67], v[148:151], a[16:19], v[64:67]
  v_add_f32 v82, 1.0, v82
  v_mul_f32 v87, s39, v87
  v_mfma_f32_16x16x32_bf16 v[68:71], v[148:151], a[20:23], v[68:71]
  v_add_f32 v83, 1.0, v83
  v_exp_f32 v84, -v84
  v_mfma_f32_16x16x32_bf16 v[72:75], v[148:151], a[24:27], v[72:75]
  v_rcp_f32 v80, v80
  v_mfma_f32_16x16x32_bf16 v[76:79], v[148:151], a[28:31], v[76:79]
  v_rcp_f32 v81, v81
  s_waitcnt lgkmcnt(0)
  s_waitcnt vmcnt(6)
  s_barrier
  v_mfma_f32_16x16x32_bf16 v[16:19], v[152:155], a[32:35], v[16:19]
  ds_read_b64_tr_b16 v[144:145], v210 offset:24576
  v_exp_f32 v85, -v85
  v_mfma_f32_16x16x32_bf16 v[20:23], v[152:155], a[36:39], v[20:23]
  ds_read_b128 a[128:131], v234 offset:49152
  v_exp_f32 v86, -v86
  v_mfma_f32_16x16x32_bf16 v[24:27], v[152:155], a[40:43], v[24:27]
  ds_read_b64_tr_b16 v[146:147], v210 offset:30720
  v_exp_f32 v87, -v87
  v_mfma_f32_16x16x32_bf16 v[28:31], v[152:155], a[44:47], v[28:31]
  ds_read_b64_tr_b16 v[148:149], v211 offset:24576
  v_add_f32 v84, 1.0, v84
  v_mfma_f32_16x16x32_bf16 v[32:35], v[156:159], a[32:35], v[32:35]
  ds_read_b64_tr_b16 v[150:151], v211 offset:30720
  buffer_load_dwordx4 v225, s[60:63], s38 offen lds
  v_mfma_f32_16x16x32_bf16 v[36:39], v[156:159], a[36:39], v[36:39]
  ds_read_b64_tr_b16 v[152:153], v212 offset:24576
  v_add_f32 v85, 1.0, v85
  v_mfma_f32_16x16x32_bf16 v[40:43], v[156:159], a[40:43], v[40:43]
  ds_read_b64_tr_b16 v[154:155], v212 offset:30720
  v_add_f32 v86, 1.0, v86
  v_mfma_f32_16x16x32_bf16 v[44:47], v[156:159], a[44:47], v[44:47]
  ds_read_b128 a[132:135], v234 offset:51200
  v_rcp_f32 v82, v82
  v_mfma_f32_16x16x32_bf16 v[48:51], v[160:163], a[32:35], v[48:51]
  ds_read_b64_tr_b16 v[156:157], v213 offset:24576
  buffer_load_dwordx4 v226, s[60:63], s38 offen offset:1024 lds
  s_add_u32 m0, s25, 75776
  s_add_u32 s38, s13, 0
  s_add_u32 s38, s38, s28
  v_mfma_f32_16x16x32_bf16 v[52:55], v[160:163], a[36:39], v[52:55]
  ds_read_b128 a[136:139], v234 offset:53248
  v_rcp_f32 v83, v83
  v_mfma_f32_16x16x32_bf16 v[56:59], v[160:163], a[40:43], v[56:59]
  ds_read_b64_tr_b16 v[158:159], v213 offset:30720
  v_mul_f32 v96, v80, v96
  v_mfma_f32_16x16x32_bf16 v[60:63], v[160:163], a[44:47], v[60:63]
  ds_read_b128 a[140:143], v234 offset:55296
  v_mul_f32 v97, v81, v97
  v_mfma_f32_16x16x32_bf16 v[64:67], v[164:167], a[32:35], v[64:67]
  ds_read_b64_tr_b16 v[160:161], v210 offset:26624
  buffer_load_dwordx4 v225, s[60:63], s38 offen lds
  v_mfma_f32_16x16x32_bf16 v[68:71], v[164:167], a[36:39], v[68:71]
  ds_read_b128 a[144:147], v235 offset:49152
  v_mul_f32 v98, v82, v98
  v_mfma_f32_16x16x32_bf16 v[72:75], v[164:167], a[40:43], v[72:75]
  ds_read_b64_tr_b16 v[162:163], v210 offset:32768
  v_mul_f32 v99, v83, v99
  v_mfma_f32_16x16x32_bf16 v[76:79], v[164:167], a[44:47], v[76:79]
  ds_read_b128 a[148:151], v235 offset:51200
  v_cvt_pk_bf16_f32 v80, v96, v97
  s_waitcnt lgkmcnt(13)
  v_mfma_f32_16x16x32_bf16 v[16:19], v[144:147], a[48:51], v[16:19]
  ds_read_b64_tr_b16 v[164:165], v211 offset:26624
  buffer_load_dwordx4 v226, s[60:63], s38 offen offset:1024 lds
  s_add_u32 m0, s25, 98304
  s_add_u32 s38, s9, 0
  s_add_u32 s38, s38, s29
  v_mfma_f32_16x16x32_bf16 v[20:23], v[144:147], a[52:55], v[20:23]
  ds_read_b128 a[152:155], v235 offset:53248
  buffer_load_dwordx4 v225, s[60:63], s38 offen lds
  v_mfma_f32_16x16x32_bf16 v[24:27], v[144:147], a[56:59], v[24:27]
  ds_read_b64_tr_b16 v[166:167], v211 offset:32768
  v_cvt_pk_bf16_f32 v81, v98, v99
  v_mfma_f32_16x16x32_bf16 v[28:31], v[144:147], a[60:63], v[28:31]
  ds_read_b128 a[156:159], v235 offset:55296
  ds_write_b64 v233, v[80:81] offset:0
  s_waitcnt lgkmcnt(15)
  v_mfma_f32_16x16x32_bf16 v[32:35], v[148:151], a[48:51], v[32:35]
  ds_read_b64_tr_b16 v[144:145], v212 offset:26624
  v_mul_f32 v104, v88, v104
  v_mfma_f32_16x16x32_bf16 v[36:39], v[148:151], a[52:55], v[36:39]
  buffer_load_dwordx4 v226, s[60:63], s38 offen offset:1024 lds
  v_mfma_f32_16x16x32_bf16 v[40:43], v[148:151], a[56:59], v[40:43]
  ds_read_b64_tr_b16 v[146:147], v212 offset:32768
  v_mul_f32 v105, v89, v105
  v_mfma_f32_16x16x32_bf16 v[44:47], v[148:151], a[60:63], v[44:47]
  buffer_load_dwordx4 v227, s[60:63], s38 offen offset:2048 lds
  s_add_u32 m0, s25, 101376
  s_add_u32 s38, s9, 55296
  s_add_u32 s38, s38, s29
  s_waitcnt lgkmcnt(15)
  v_mfma_f32_16x16x32_bf16 v[48:51], v[152:155], a[48:51], v[48:51]
  ds_read_b64_tr_b16 v[148:149], v213 offset:26624
  v_mul_f32 v106, v90, v106
  v_mfma_f32_16x16x32_bf16 v[52:55], v[152:155], a[52:55], v[52:55]
  v_mul_f32 v107, v91, v107
  v_add_f32 v87, 1.0, v87
  v_mfma_f32_16x16x32_bf16 v[56:59], v[152:155], a[56:59], v[56:59]
  ds_read_b64_tr_b16 v[150:151], v213 offset:32768
  v_mul_f32 v88, s39, v88
  v_mfma_f32_16x16x32_bf16 v[60:63], v[152:155], a[60:63], v[60:63]
  buffer_load_dwordx4 v225, s[60:63], s38 offen lds
  s_add_u32 m0, s25, 102400
  s_add_u32 s38, s10, 0
  s_add_u32 s38, s38, s29
  s_waitcnt lgkmcnt(14)
  v_mfma_f32_16x16x32_bf16 v[64:67], v[156:159], a[48:51], v[64:67]
  ds_read_b64_tr_b16 v[152:153], v210 offset:28672
  v_mul_f32 v89, s39, v89
  v_mfma_f32_16x16x32_bf16 v[68:71], v[156:159], a[52:55], v[68:71]
  v_mul_f32 v90, s39, v90
  v_rcp_f32 v84, v84
  v_mfma_f32_16x16x32_bf16 v[72:75], v[156:159], a[56:59], v[72:75]
  ds_read_b64_tr_b16 v[154:155], v210 offset:34816
  v_mul_f32 v91, s39, v91
  v_mfma_f32_16x16x32_bf16 v[76:79], v[156:159], a[60:63], v[76:79]
  buffer_load_dwordx4 v225, s[60:63], s38 offen lds
  s_waitcnt lgkmcnt(12)
  v_mfma_f32_16x16x32_bf16 v[16:19], v[160:163], a[64:67], v[16:19]
  ds_read_b64_tr_b16 v[156:157], v211 offset:28672
  v_exp_f32 v88, -v88
  v_mfma_f32_16x16x32_bf16 v[20:23], v[160:163], a[68:71], v[20:23]
  v_exp_f32 v89, -v89
  v_mfma_f32_16x16x32_bf16 v[24:27], v[160:163], a[72:75], v[24:27]
  ds_read_b64_tr_b16 v[158:159], v211 offset:34816
  v_exp_f32 v90, -v90
  v_mfma_f32_16x16x32_bf16 v[28:31], v[160:163], a[76:79], v[28:31]
  buffer_load_dwordx4 v226, s[60:63], s38 offen offset:1024 lds
  s_add_u32 m0, s25, 0
  s_add_u32 s38, s10, 36864
  s_add_u32 s38, s38, s29
  s_waitcnt lgkmcnt(10)
  v_mfma_f32_16x16x32_bf16 v[32:35], v[164:167], a[64:67], v[32:35]
  ds_read_b64_tr_b16 v[160:161], v212 offset:28672
  v_exp_f32 v91, -v91
  v_mfma_f32_16x16x32_bf16 v[36:39], v[164:167], a[68:71], v[36:39]
  buffer_load_dwordx4 v225, s[60:63], s38 offen lds
  v_mfma_f32_16x16x32_bf16 v[40:43], v[164:167], a[72:75], v[40:43]
  ds_read_b64_tr_b16 v[162:163], v212 offset:34816
  v_add_f32 v88, 1.0, v88
  v_mfma_f32_16x16x32_bf16 v[44:47], v[164:167], a[76:79], v[44:47]
  buffer_load_dwordx4 v226, s[60:63], s38 offen offset:1024 lds
  s_add_u32 m0, s25, 2048
  s_add_u32 s38, s11, 0
  s_add_u32 s38, s38, s29
  s_waitcnt lgkmcnt(8)
  v_mfma_f32_16x16x32_bf16 v[48:51], v[144:147], a[64:67], v[48:51]
  ds_read_b64_tr_b16 v[164:165], v213 offset:28672
  v_add_f32 v89, 1.0, v89
  v_mfma_f32_16x16x32_bf16 v[52:55], v[144:147], a[68:71], v[52:55]
  v_add_f32 v90, 1.0, v90
  v_rcp_f32 v85, v85
  v_mfma_f32_16x16x32_bf16 v[56:59], v[144:147], a[72:75], v[56:59]
  ds_read_b64_tr_b16 v[166:167], v213 offset:34816
  v_add_f32 v91, 1.0, v91
  v_mfma_f32_16x16x32_bf16 v[60:63], v[144:147], a[76:79], v[60:63]
  buffer_load_dwordx4 v225, s[60:63], s38 offen lds
  s_waitcnt lgkmcnt(8)
  v_mfma_f32_16x16x32_bf16 v[64:67], v[148:151], a[64:67], v[64:67]
  v_rcp_f32 v88, v88
  v_mfma_f32_16x16x32_bf16 v[68:71], v[148:151], a[68:71], v[68:71]
  v_rcp_f32 v89, v89
  v_mfma_f32_16x16x32_bf16 v[72:75], v[148:151], a[72:75], v[72:75]
  v_rcp_f32 v90, v90
  v_mfma_f32_16x16x32_bf16 v[76:79], v[148:151], a[76:79], v[76:79]
  buffer_load_dwordx4 v226, s[60:63], s38 offen offset:1024 lds
  v_rcp_f32 v91, v91
  v_rcp_f32 v86, v86
  v_mul_f32 v104, v88, v104
  v_rcp_f32 v87, v87
  v_mul_f32 v105, v89, v105
  v_mul_f32 v100, v84, v100
  v_mul_f32 v106, v90, v106
  v_mul_f32 v101, v85, v101
  v_mul_f32 v107, v91, v107
  v_mul_f32 v102, v86, v102
  v_cvt_pk_bf16_f32 v88, v104, v105
  v_mul_f32 v103, v87, v103
  v_cvt_pk_bf16_f32 v89, v106, v107
  v_cvt_pk_bf16_f32 v84, v100, v101
  ds_write_b64 v233, v[88:89] offset:4608
  v_cvt_pk_bf16_f32 v85, v102, v103
  ds_write_b64 v233, v[84:85] offset:2304
  v_mul_f32 v108, v92, v108
  v_mul_f32 v109, v93, v109
  v_mul_f32 v110, v94, v110
  v_mul_f32 v111, v95, v111
  v_mul_f32 v92, s39, v92
  v_mul_f32 v93, s39, v93
  v_mul_f32 v94, s39, v94
  v_mul_f32 v95, s39, v95
  v_exp_f32 v92, -v92
  v_exp_f32 v93, -v93
  v_exp_f32 v94, -v94
  v_exp_f32 v95, -v95
  v_add_f32 v92, 1.0, v92
  v_add_f32 v93, 1.0, v93
  v_add_f32 v94, 1.0, v94
  v_add_f32 v95, 1.0, v95
  v_rcp_f32 v92, v92
  v_rcp_f32 v93, v93
  v_rcp_f32 v94, v94
  v_rcp_f32 v95, v95
  v_mul_f32 v108, v92, v108
  v_mul_f32 v109, v93, v109
  v_mul_f32 v110, v94, v110
  v_mul_f32 v111, v95, v111
  v_cvt_pk_bf16_f32 v92, v108, v109
  v_cvt_pk_bf16_f32 v93, v110, v111
  ds_write_b64 v233, v[92:93] offset:6912
  s_waitcnt lgkmcnt(0)
  s_waitcnt vmcnt(14)
  s_barrier
  v_mfma_f32_16x16x32_bf16 v[16:19], v[152:155], a[80:83], v[16:19]
  ds_read_b64_tr_b16 v[144:145], v210 offset:49152
  v_mfma_f32_16x16x32_bf16 v[20:23], v[152:155], a[84:87], v[20:23]
  ds_read_b128 a[160:163], v236 offset:0
  v_mfma_f32_16x16x32_bf16 v[24:27], v[152:155], a[88:91], v[24:27]
  ds_read_b64_tr_b16 v[146:147], v210 offset:55296
  v_mfma_f32_16x16x32_bf16 v[28:31], v[152:155], a[92:95], v[28:31]
  ds_read_b64_tr_b16 v[148:149], v211 offset:49152
  v_mfma_f32_16x16x32_bf16 v[32:35], v[156:159], a[80:83], v[32:35]
  ds_read_b64_tr_b16 v[150:151], v211 offset:55296
  v_mfma_f32_16x16x32_bf16 v[36:39], v[156:159], a[84:87], v[36:39]
  ds_read_b64_tr_b16 v[152:153], v212 offset:49152
  v_mfma_f32_16x16x32_bf16 v[40:43], v[156:159], a[88:91], v[40:43]
  ds_read_b64_tr_b16 v[154:155], v212 offset:55296
  buffer_load_dwordx4 v227, s[60:63], s38 offen offset:2048 lds
  s_add_u32 m0, s25, 5120
  s_add_u32 s38, s11, 55296
  s_add_u32 s38, s38, s29
  v_mfma_f32_16x16x32_bf16 v[44:47], v[156:159], a[92:95], v[44:47]
  ds_read_b128 a[164:167], v236 offset:2304
  v_mfma_f32_16x16x32_bf16 v[48:51], v[160:163], a[80:83], v[48:51]
  ds_read_b64_tr_b16 v[156:157], v213 offset:49152
  v_mfma_f32_16x16x32_bf16 v[52:55], v[160:163], a[84:87], v[52:55]
  ds_read_b128 a[168:171], v236 offset:4608
  v_mfma_f32_16x16x32_bf16 v[56:59], v[160:163], a[88:91], v[56:59]
  ds_read_b64_tr_b16 v[158:159], v213 offset:55296
  buffer_load_dwordx4 v225, s[60:63], s38 offen lds
  s_add_u32 m0, s25, 24576
  s_add_u32 s38, s16, 0
  s_add_u32 s38, s38, s29
  v_mfma_f32_16x16x32_bf16 v[60:63], v[160:163], a[92:95], v[60:63]
  ds_read_b128 a[172:175], v236 offset:6912
  buffer_load_dwordx4 v225, s[64:67], s38 offen lds
  v_mfma_f32_16x16x32_bf16 v[64:67], v[164:167], a[80:83], v[64:67]
  ds_read_b64_tr_b16 v[160:161], v210 offset:51200
  v_mfma_f32_16x16x32_bf16 v[68:71], v[164:167], a[84:87], v[68:71]
  buffer_load_dwordx4 v226, s[64:67], s38 offen offset:1024 lds
  v_mfma_f32_16x16x32_bf16 v[72:75], v[164:167], a[88:91], v[72:75]
  ds_read_b64_tr_b16 v[162:163], v210 offset:57344
  v_mfma_f32_16x16x32_bf16 v[76:79], v[164:167], a[92:95], v[76:79]
  s_waitcnt lgkmcnt(11)
  v_mfma_f32_16x16x32_bf16 v[16:19], v[144:147], a[96:99], v[16:19]
  ds_read_b64_tr_b16 v[164:165], v211 offset:51200
  v_mfma_f32_16x16x32_bf16 v[20:23], v[144:147], a[100:103], v[20:23]
  buffer_load_dwordx4 v227, s[64:67], s38 offen offset:2048 lds
  s_add_u32 m0, s25, 27648
  s_add_u32 s38, s16, 55296
  s_add_u32 s38, s38, s29
  v_mfma_f32_16x16x32_bf16 v[24:27], v[144:147], a[104:107], v[24:27]
  ds_read_b64_tr_b16 v[166:167], v211 offset:57344
  v_mfma_f32_16x16x32_bf16 v[28:31], v[144:147], a[108:111], v[28:31]
  s_waitcnt lgkmcnt(11)
  v_mfma_f32_16x16x32_bf16 v[32:35], v[148:151], a[96:99], v[32:35]
  ds_read_b64_tr_b16 v[144:145], v212 offset:51200
  v_mfma_f32_16x16x32_bf16 v[36:39], v[148:151], a[100:103], v[36:39]
  buffer_load_dwordx4 v225, s[64:67], s38 offen lds
  s_add_u32 m0, s25, 28672
  s_add_u32 s38, s12, 0
  s_add_u32 s38, s38, s29
  v_mfma_f32_16x16x32_bf16 v[40:43], v[148:151], a[104:107], v[40:43]
  ds_read_b64_tr_b16 v[146:147], v212 offset:57344
  v_mfma_f32_16x16x32_bf16 v[44:47], v[148:151], a[108:111], v[44:47]
  s_waitcnt lgkmcnt(11)
  v_mfma_f32_16x16x32_bf16 v[48:51], v[152:155], a[96:99], v[48:51]
  ds_read_b64_tr_b16 v[148:149], v213 offset:51200
  v_mfma_f32_16x16x32_bf16 v[52:55], v[152:155], a[100:103], v[52:55]
  buffer_load_dwordx4 v225, s[60:63], s38 offen lds
  v_mfma_f32_16x16x32_bf16 v[56:59], v[152:155], a[104:107], v[56:59]
  ds_read_b64_tr_b16 v[150:151], v213 offset:57344
  v_mfma_f32_16x16x32_bf16 v[60:63], v[152:155], a[108:111], v[60:63]
  s_waitcnt lgkmcnt(9)
  v_mfma_f32_16x16x32_bf16 v[64:67], v[156:159], a[96:99], v[64:67]
  ds_read_b64_tr_b16 v[152:153], v210 offset:53248
  v_mfma_f32_16x16x32_bf16 v[68:71], v[156:159], a[100:103], v[68:71]
  buffer_load_dwordx4 v226, s[60:63], s38 offen offset:1024 lds
  s_add_u32 m0, s25, 122880
  s_add_u32 s38, s12, 36864
  s_add_u32 s38, s38, s29
  v_mfma_f32_16x16x32_bf16 v[72:75], v[156:159], a[104:107], v[72:75]
  ds_read_b64_tr_b16 v[154:155], v210 offset:59392
  v_mfma_f32_16x16x32_bf16 v[76:79], v[156:159], a[108:111], v[76:79]
  s_waitcnt lgkmcnt(8)
  v_mfma_f32_16x16x32_bf16 v[16:19], v[160:163], a[112:115], v[16:19]
  ds_read_b64_tr_b16 v[156:157], v211 offset:53248
  v_mfma_f32_16x16x32_bf16 v[20:23], v[160:163], a[116:119], v[20:23]
  v_mfma_f32_16x16x32_bf16 v[24:27], v[160:163], a[120:123], v[24:27]
  ds_read_b64_tr_b16 v[158:159], v211 offset:59392
  v_mfma_f32_16x16x32_bf16 v[28:31], v[160:163], a[124:127], v[28:31]
  s_waitcnt lgkmcnt(8)
  v_mfma_f32_16x16x32_bf16 v[32:35], v[164:167], a[112:115], v[32:35]
  ds_read_b64_tr_b16 v[160:161], v212 offset:53248
  v_mfma_f32_16x16x32_bf16 v[36:39], v[164:167], a[116:119], v[36:39]
  v_mfma_f32_16x16x32_bf16 v[40:43], v[164:167], a[120:123], v[40:43]
  ds_read_b64_tr_b16 v[162:163], v212 offset:59392
  v_mfma_f32_16x16x32_bf16 v[44:47], v[164:167], a[124:127], v[44:47]
  s_waitcnt lgkmcnt(8)
  v_mfma_f32_16x16x32_bf16 v[48:51], v[144:147], a[112:115], v[48:51]
  ds_read_b64_tr_b16 v[164:165], v213 offset:53248
  v_mfma_f32_16x16x32_bf16 v[52:55], v[144:147], a[116:119], v[52:55]
  v_mfma_f32_16x16x32_bf16 v[56:59], v[144:147], a[120:123], v[56:59]
  ds_read_b64_tr_b16 v[166:167], v213 offset:59392
  v_mfma_f32_16x16x32_bf16 v[60:63], v[144:147], a[124:127], v[60:63]
  s_waitcnt lgkmcnt(8)
  v_mfma_f32_16x16x32_bf16 v[64:67], v[148:151], a[112:115], v[64:67]
  v_mfma_f32_16x16x32_bf16 v[68:71], v[148:151], a[116:119], v[68:71]
  v_mfma_f32_16x16x32_bf16 v[72:75], v[148:151], a[120:123], v[72:75]
  v_mfma_f32_16x16x32_bf16 v[76:79], v[148:151], a[124:127], v[76:79]
  s_waitcnt lgkmcnt(0)
  s_waitcnt vmcnt(18)
  s_barrier
  v_mfma_f32_16x16x32_bf16 v[16:19], v[152:155], a[128:131], v[16:19]
  ds_read_b64_tr_b16 v[144:145], v168 offset:0
  v_mfma_f32_16x16x32_bf16 v[20:23], v[152:155], a[132:135], v[20:23]
  v_mfma_f32_16x16x32_bf16 v[24:27], v[152:155], a[136:139], v[24:27]
  ds_read_b64_tr_b16 v[146:147], v168 offset:6144
  v_mfma_f32_16x16x32_bf16 v[28:31], v[152:155], a[140:143], v[28:31]
  ds_read_b64_tr_b16 v[148:149], v169 offset:0
  v_mfma_f32_16x16x32_bf16 v[32:35], v[156:159], a[128:131], v[32:35]
  ds_read_b64_tr_b16 v[150:151], v169 offset:6144
  v_mfma_f32_16x16x32_bf16 v[36:39], v[156:159], a[132:135], v[36:39]
  ds_read_b64_tr_b16 v[152:153], v170 offset:0
  v_mfma_f32_16x16x32_bf16 v[40:43], v[156:159], a[136:139], v[40:43]
  ds_read_b64_tr_b16 v[154:155], v170 offset:6144
  v_mfma_f32_16x16x32_bf16 v[44:47], v[156:159], a[140:143], v[44:47]
  v_mfma_f32_16x16x32_bf16 v[48:51], v[160:163], a[128:131], v[48:51]
  ds_read_b64_tr_b16 v[156:157], v171 offset:0
  v_mfma_f32_16x16x32_bf16 v[52:55], v[160:163], a[132:135], v[52:55]
  v_mfma_f32_16x16x32_bf16 v[56:59], v[160:163], a[136:139], v[56:59]
  ds_read_b64_tr_b16 v[158:159], v171 offset:6144
  v_mfma_f32_16x16x32_bf16 v[60:63], v[160:163], a[140:143], v[60:63]
  v_mfma_f32_16x16x32_bf16 v[64:67], v[164:167], a[128:131], v[64:67]
  ds_read_b64_tr_b16 v[160:161], v168 offset:2048
  v_mfma_f32_16x16x32_bf16 v[68:71], v[164:167], a[132:135], v[68:71]
  v_mfma_f32_16x16x32_bf16 v[72:75], v[164:167], a[136:139], v[72:75]
  ds_read_b64_tr_b16 v[162:163], v168 offset:8192
  v_mfma_f32_16x16x32_bf16 v[76:79], v[164:167], a[140:143], v[76:79]
  s_waitcnt lgkmcnt(8)
  v_mfma_f32_16x16x32_bf16 v[16:19], v[144:147], a[144:147], v[16:19]
  ds_read_b64_tr_b16 v[164:165], v169 offset:2048
  v_mfma_f32_16x16x32_bf16 v[20:23], v[144:147], a[148:151], v[20:23]
  v_mfma_f32_16x16x32_bf16 v[24:27], v[144:147], a[152:155], v[24:27]
  ds_read_b64_tr_b16 v[166:167], v169 offset:8192
  v_mfma_f32_16x16x32_bf16 v[28:31], v[144:147], a[156:159], v[28:31]
  s_waitcnt lgkmcnt(8)
  v_mfma_f32_16x16x32_bf16 v[32:35], v[148:151], a[144:147], v[32:35]
  ds_read_b64_tr_b16 v[144:145], v170 offset:2048
  v_mfma_f32_16x16x32_bf16 v[36:39], v[148:151], a[148:151], v[36:39]
  v_mfma_f32_16x16x32_bf16 v[40:43], v[148:151], a[152:155], v[40:43]
  ds_read_b64_tr_b16 v[146:147], v170 offset:8192
  v_mfma_f32_16x16x32_bf16 v[44:47], v[148:151], a[156:159], v[44:47]
  s_waitcnt lgkmcnt(8)
  v_mfma_f32_16x16x32_bf16 v[48:51], v[152:155], a[144:147], v[48:51]
  ds_read_b64_tr_b16 v[148:149], v171 offset:2048
  v_mfma_f32_16x16x32_bf16 v[52:55], v[152:155], a[148:151], v[52:55]
  v_mfma_f32_16x16x32_bf16 v[56:59], v[152:155], a[152:155], v[56:59]
  ds_read_b64_tr_b16 v[150:151], v171 offset:8192
  v_mfma_f32_16x16x32_bf16 v[60:63], v[152:155], a[156:159], v[60:63]
  s_waitcnt lgkmcnt(8)
  v_mfma_f32_16x16x32_bf16 v[64:67], v[156:159], a[144:147], v[64:67]
  v_mfma_f32_16x16x32_bf16 v[68:71], v[156:159], a[148:151], v[68:71]
  v_mfma_f32_16x16x32_bf16 v[72:75], v[156:159], a[152:155], v[72:75]
  v_mfma_f32_16x16x32_bf16 v[76:79], v[156:159], a[156:159], v[76:79]
  s_waitcnt lgkmcnt(0)
  s_waitcnt vmcnt(12)
  s_barrier
  v_mfma_f32_16x16x32_bf16 v[16:19], v[160:163], a[160:163], v[16:19]
  ds_read_b64_tr_b16 v[152:153], v168 offset:24576
  v_mfma_f32_16x16x32_bf16 v[20:23], v[160:163], a[164:167], v[20:23]
  buffer_load_dwordx4 v225, s[60:63], s38 offen lds
  v_mfma_f32_16x16x32_bf16 v[24:27], v[160:163], a[168:171], v[24:27]
  ds_read_b64_tr_b16 v[154:155], v168 offset:30720
  v_mfma_f32_16x16x32_bf16 v[28:31], v[160:163], a[172:175], v[28:31]
  ds_read_b64_tr_b16 v[156:157], v169 offset:24576
  v_mfma_f32_16x16x32_bf16 v[32:35], v[164:167], a[160:163], v[32:35]
  ds_read_b64_tr_b16 v[158:159], v169 offset:30720
  v_mfma_f32_16x16x32_bf16 v[36:39], v[164:167], a[164:167], v[36:39]
  ds_read_b64_tr_b16 v[160:161], v170 offset:24576
  v_mfma_f32_16x16x32_bf16 v[40:43], v[164:167], a[168:171], v[40:43]
  ds_read_b64_tr_b16 v[162:163], v170 offset:30720
  v_mfma_f32_16x16x32_bf16 v[44:47], v[164:167], a[172:175], v[44:47]
  buffer_load_dwordx4 v226, s[60:63], s38 offen offset:1024 lds
  s_add_u32 m0, s25, 124928
  s_add_u32 s38, s13, 0
  s_add_u32 s38, s38, s29
  v_mfma_f32_16x16x32_bf16 v[48:51], v[144:147], a[160:163], v[48:51]
  ds_read_b64_tr_b16 v[164:165], v171 offset:24576
  v_mfma_f32_16x16x32_bf16 v[52:55], v[144:147], a[164:167], v[52:55]
  buffer_load_dwordx4 v225, s[60:63], s38 offen lds
  v_mfma_f32_16x16x32_bf16 v[56:59], v[144:147], a[168:171], v[56:59]
  ds_read_b64_tr_b16 v[166:167], v171 offset:30720
  v_mfma_f32_16x16x32_bf16 v[60:63], v[144:147], a[172:175], v[60:63]
  v_mfma_f32_16x16x32_bf16 v[64:67], v[148:151], a[160:163], v[64:67]
  ds_read_b64_tr_b16 v[144:145], v168 offset:26624
  v_mfma_f32_16x16x32_bf16 v[68:71], v[148:151], a[164:167], v[68:71]
  buffer_load_dwordx4 v226, s[60:63], s38 offen offset:1024 lds
  s_add_u32 m0, s25, 49152
  s_add_u32 s38, s9, 1024
  v_mfma_f32_16x16x32_bf16 v[72:75], v[148:151], a[168:171], v[72:75]
  ds_read_b64_tr_b16 v[146:147], v168 offset:32768
  v_mfma_f32_16x16x32_bf16 v[76:79], v[148:151], a[172:175], v[76:79]
  buffer_load_dwordx4 v228, s[60:63], s38 offen lds
  s_waitcnt lgkmcnt(8)
  v_mfma_f32_16x16x32_bf16 v[80:83], v[152:155], a[0:3], 0
  ds_read_b64_tr_b16 v[148:149], v169 offset:26624
  v_mfma_f32_16x16x32_bf16 v[84:87], v[152:155], a[4:7], 0
  v_mfma_f32_16x16x32_bf16 v[88:91], v[152:155], a[8:11], 0
  ds_read_b64_tr_b16 v[150:151], v169 offset:32768
  v_mfma_f32_16x16x32_bf16 v[92:95], v[152:155], a[12:15], 0
  buffer_load_dwordx4 v229, s[60:63], s38 offen offset:1024 lds
  s_add_u32 m0, s25, 51200
  s_add_u32 s38, s10, 1024
  s_waitcnt lgkmcnt(8)
  v_mfma_f32_16x16x32_bf16 v[96:99], v[156:159], a[0:3], 0
  ds_read_b64_tr_b16 v[152:153], v170 offset:26624
  v_mfma_f32_16x16x32_bf16 v[100:103], v[156:159], a[4:7], 0
  v_mfma_f32_16x16x32_bf16 v[104:107], v[156:159], a[8:11], 0
  ds_read_b64_tr_b16 v[154:155], v170 offset:32768
  v_mfma_f32_16x16x32_bf16 v[108:111], v[156:159], a[12:15], 0
  buffer_load_dwordx4 v228, s[60:63], s38 offen lds
  s_waitcnt lgkmcnt(8)
  v_mfma_f32_16x16x32_bf16 v[112:115], v[160:163], a[0:3], 0
  ds_read_b64_tr_b16 v[156:157], v171 offset:26624
  v_mfma_f32_16x16x32_bf16 v[116:119], v[160:163], a[4:7], 0
  v_mfma_f32_16x16x32_bf16 v[120:123], v[160:163], a[8:11], 0
  ds_read_b64_tr_b16 v[158:159], v171 offset:32768
  v_mfma_f32_16x16x32_bf16 v[124:127], v[160:163], a[12:15], 0
  buffer_load_dwordx4 v229, s[60:63], s38 offen offset:1024 lds
  s_add_u32 m0, s25, 53248
  s_add_u32 s38, s11, 1024
  s_waitcnt lgkmcnt(8)
  v_mfma_f32_16x16x32_bf16 v[128:131], v[164:167], a[0:3], 0
  ds_read_b64_tr_b16 v[160:161], v168 offset:28672
  v_mfma_f32_16x16x32_bf16 v[132:135], v[164:167], a[4:7], 0
  v_mfma_f32_16x16x32_bf16 v[136:139], v[164:167], a[8:11], 0
  ds_read_b64_tr_b16 v[162:163], v168 offset:34816
  v_mfma_f32_16x16x32_bf16 v[140:143], v[164:167], a[12:15], 0
  buffer_load_dwordx4 v228, s[60:63], s38 offen lds
  s_waitcnt lgkmcnt(8)
  v_mfma_f32_16x16x32_bf16 v[80:83], v[144:147], a[16:19], v[80:83]
  ds_read_b64_tr_b16 v[164:165], v169 offset:28672
  v_mfma_f32_16x16x32_bf16 v[84:87], v[144:147], a[20:23], v[84:87]
  v_mfma_f32_16x16x32_bf16 v[88:91], v[144:147], a[24:27], v[88:91]
  ds_read_b64_tr_b16 v[166:167], v169 offset:34816
  v_mfma_f32_16x16x32_bf16 v[92:95], v[144:147], a[28:31], v[92:95]
  buffer_load_dwordx4 v229, s[60:63], s38 offen offset:1024 lds
  s_add_u32 m0, s25, 73728
  s_add_u32 s38, s16, 1024
  s_waitcnt lgkmcnt(8)
  v_mfma_f32_16x16x32_bf16 v[96:99], v[148:151], a[16:19], v[96:99]
  ds_read_b64_tr_b16 v[144:145], v170 offset:28672
  v_mfma_f32_16x16x32_bf16 v[100:103], v[148:151], a[20:23], v[100:103]
  buffer_load_dwordx4 v228, s[64:67], s38 offen lds
  v_mfma_f32_16x16x32_bf16 v[104:107], v[148:151], a[24:27], v[104:107]
  ds_read_b64_tr_b16 v[146:147], v170 offset:34816
  v_mfma_f32_16x16x32_bf16 v[108:111], v[148:151], a[28:31], v[108:111]
  buffer_load_dwordx4 v229, s[64:67], s38 offen offset:1024 lds
  s_add_u32 m0, s25, 75776
  s_add_u32 s38, s12, 1024
  s_waitcnt lgkmcnt(8)
  v_mfma_f32_16x16x32_bf16 v[112:115], v[152:155], a[16:19], v[112:115]
  ds_read_b64_tr_b16 v[148:149], v171 offset:28672
  v_mfma_f32_16x16x32_bf16 v[116:119], v[152:155], a[20:23], v[116:119]
  v_mfma_f32_16x16x32_bf16 v[120:123], v[152:155], a[24:27], v[120:123]
  ds_read_b64_tr_b16 v[150:151], v171 offset:34816
  v_mfma_f32_16x16x32_bf16 v[124:127], v[152:155], a[28:31], v[124:127]
  buffer_load_dwordx4 v228, s[60:63], s38 offen lds
  s_waitcnt lgkmcnt(8)
  v_mfma_f32_16x16x32_bf16 v[128:131], v[156:159], a[16:19], v[128:131]
  v_mfma_f32_16x16x32_bf16 v[132:135], v[156:159], a[20:23], v[132:135]
  v_mfma_f32_16x16x32_bf16 v[136:139], v[156:159], a[24:27], v[136:139]
  v_mfma_f32_16x16x32_bf16 v[140:143], v[156:159], a[28:31], v[140:143]
  buffer_load_dwordx4 v229, s[60:63], s38 offen offset:1024 lds
  s_add_u32 m0, s25, 77824
  s_add_u32 s38, s13, 1024
  s_waitcnt lgkmcnt(0)
  s_waitcnt vmcnt(20)
  s_barrier
  v_mfma_f32_16x16x32_bf16 v[80:83], v[160:163], a[32:35], v[80:83]
  ds_read_b64_tr_b16 v[152:153], v210 offset:0
  v_mfma_f32_16x16x32_bf16 v[84:87], v[160:163], a[36:39], v[84:87]
  v_mfma_f32_16x16x32_bf16 v[88:91], v[160:163], a[40:43], v[88:91]
  ds_read_b64_tr_b16 v[154:155], v210 offset:6144
  v_mfma_f32_16x16x32_bf16 v[92:95], v[160:163], a[44:47], v[92:95]
  ds_read_b64_tr_b16 v[156:157], v211 offset:0
  v_mfma_f32_16x16x32_bf16 v[96:99], v[164:167], a[32:35], v[96:99]
  ds_read_b64_tr_b16 v[158:159], v211 offset:6144
  v_mfma_f32_16x16x32_bf16 v[100:103], v[164:167], a[36:39], v[100:103]
  ds_read_b64_tr_b16 v[160:161], v212 offset:0
  v_mfma_f32_16x16x32_bf16 v[104:107], v[164:167], a[40:43], v[104:107]
  ds_read_b64_tr_b16 v[162:163], v212 offset:6144
  buffer_load_dwordx4 v228, s[60:63], s38 offen lds
  s_add_u32 m0, s25, 98304
  s_add_u32 s38, s9, 0
  s_add_u32 s38, s38, s30
  v_mfma_f32_16x16x32_bf16 v[108:111], v[164:167], a[44:47], v[108:111]
  buffer_load_dwordx4 v225, s[60:63], s38 offen lds
  v_mfma_f32_16x16x32_bf16 v[112:115], v[144:147], a[32:35], v[112:115]
  ds_read_b64_tr_b16 v[164:165], v213 offset:0
  v_cvt_pk_bf16_f32 v16, v16, v17
  v_mfma_f32_16x16x32_bf16 v[116:119], v[144:147], a[36:39], v[116:119]
  buffer_load_dwordx4 v226, s[60:63], s38 offen offset:1024 lds
  v_mfma_f32_16x16x32_bf16 v[120:123], v[144:147], a[40:43], v[120:123]
  ds_read_b64_tr_b16 v[166:167], v213 offset:6144
  v_cvt_pk_bf16_f32 v17, v18, v19
  v_mfma_f32_16x16x32_bf16 v[124:127], v[144:147], a[44:47], v[124:127]
  v_cvt_pk_bf16_f32 v18, v32, v33
  v_cvt_pk_bf16_f32 v19, v34, v35
  s_add_u32 s45, s18, 0
  v_mfma_f32_16x16x32_bf16 v[128:131], v[148:151], a[32:35], v[128:131]
  ds_read_b64_tr_b16 v[144:145], v210 offset:2048
  v_mfma_f32_16x16x32_bf16 v[132:135], v[148:151], a[36:39], v[132:135]
  buffer_load_dwordx4 v227, s[60:63], s38 offen offset:2048 lds
  s_add_u32 m0, s25, 101376
  s_add_u32 s38, s9, 55296
  s_add_u32 s38, s38, s30
  v_mfma_f32_16x16x32_bf16 v[136:139], v[148:151], a[40:43], v[136:139]
  ds_read_b64_tr_b16 v[146:147], v210 offset:8192
  v_mfma_f32_16x16x32_bf16 v[140:143], v[148:151], a[44:47], v[140:143]
  buffer_store_dwordx4 v[16:19], v243, s[68:71], s45 offen sc1
  s_waitcnt lgkmcnt(8)
  v_mfma_f32_16x16x32_bf16 v[80:83], v[152:155], a[48:51], v[80:83]
  ds_read_b64_tr_b16 v[148:149], v211 offset:2048
  v_cvt_pk_bf16_f32 v20, v20, v21
  v_mfma_f32_16x16x32_bf16 v[84:87], v[152:155], a[52:55], v[84:87]
  buffer_load_dwordx4 v225, s[60:63], s38 offen lds
  s_add_u32 m0, s25, 102400
  s_add_u32 s38, s10, 0
  s_add_u32 s38, s38, s30
  v_mfma_f32_16x16x32_bf16 v[88:91], v[152:155], a[56:59], v[88:91]
  ds_read_b64_tr_b16 v[150:151], v211 offset:8192
  v_cvt_pk_bf16_f32 v21, v22, v23
  v_mfma_f32_16x16x32_bf16 v[92:95], v[152:155], a[60:63], v[92:95]
  v_cvt_pk_bf16_f32 v22, v36, v37
  v_cvt_pk_bf16_f32 v23, v38, v39
  s_waitcnt lgkmcnt(8)
  v_mfma_f32_16x16x32_bf16 v[96:99], v[156:159], a[48:51], v[96:99]
  ds_read_b64_tr_b16 v[152:153], v212 offset:2048
  v_mfma_f32_16x16x32_bf16 v[100:103], v[156:159], a[52:55], v[100:103]
  buffer_load_dwordx4 v225, s[60:63], s38 offen lds
  v_mfma_f32_16x16x32_bf16 v[104:107], v[156:159], a[56:59], v[104:107]
  ds_read_b64_tr_b16 v[154:155], v212 offset:8192
  v_mfma_f32_16x16x32_bf16 v[108:111], v[156:159], a[60:63], v[108:111]
  buffer_store_dwordx4 v[20:23], v243, s[68:71], s45 offen offset:1024 sc1
  s_waitcnt lgkmcnt(8)
  v_mfma_f32_16x16x32_bf16 v[112:115], v[160:163], a[48:51], v[112:115]
  ds_read_b64_tr_b16 v[156:157], v213 offset:2048
  v_cvt_pk_bf16_f32 v24, v24, v25
  v_mfma_f32_16x16x32_bf16 v[116:119], v[160:163], a[52:55], v[116:119]
  buffer_load_dwordx4 v226, s[60:63], s38 offen offset:1024 lds
  s_add_u32 m0, s25, 0
  s_add_u32 s38, s10, 36864
  s_add_u32 s38, s38, s30
  v_mfma_f32_16x16x32_bf16 v[120:123], v[160:163], a[56:59], v[120:123]
  ds_read_b64_tr_b16 v[158:159], v213 offset:8192
  v_cvt_pk_bf16_f32 v25, v26, v27
  v_mfma_f32_16x16x32_bf16 v[124:127], v[160:163], a[60:63], v[124:127]
  v_cvt_pk_bf16_f32 v26, v40, v41
  v_cvt_pk_bf16_f32 v27, v42, v43
  s_waitcnt lgkmcnt(8)
  v_mfma_f32_16x16x32_bf16 v[128:131], v[164:167], a[48:51], v[128:131]
  ds_read_b64_tr_b16 v[160:161], v210 offset:4096
  v_mfma_f32_16x16x32_bf16 v[132:135], v[164:167], a[52:55], v[132:135]
  buffer_store_dwordx4 v[24:27], v243, s[68:71], s45 offen offset:2048 sc1
  v_mfma_f32_16x16x32_bf16 v[136:139], v[164:167], a[56:59], v[136:139]
  ds_read_b64_tr_b16 v[162:163], v210 offset:10240
  v_cvt_pk_bf16_f32 v28, v28, v29
  v_mfma_f32_16x16x32_bf16 v[140:143], v[164:167], a[60:63], v[140:143]
  v_cvt_pk_bf16_f32 v29, v30, v31
  v_cvt_pk_bf16_f32 v30, v44, v45
  s_waitcnt lgkmcnt(8)
  v_mfma_f32_16x16x32_bf16 v[80:83], v[144:147], a[64:67], v[80:83]
  ds_read_b64_tr_b16 v[164:165], v211 offset:4096
  v_cvt_pk_bf16_f32 v31, v46, v47
  v_mfma_f32_16x16x32_bf16 v[84:87], v[144:147], a[68:71], v[84:87]
  buffer_store_dwordx4 v[28:31], v243, s[68:71], s45 offen offset:3072 sc1
  v_mfma_f32_16x16x32_bf16 v[88:91], v[144:147], a[72:75], v[88:91]
  ds_read_b64_tr_b16 v[166:167], v211 offset:10240
  v_cvt_pk_bf16_f32 v48, v48, v49
  v_mfma_f32_16x16x32_bf16 v[92:95], v[144:147], a[76:79], v[92:95]
  v_cvt_pk_bf16_f32 v49, v50, v51
  v_cvt_pk_bf16_f32 v50, v64, v65
  s_waitcnt lgkmcnt(8)
  v_mfma_f32_16x16x32_bf16 v[96:99], v[148:151], a[64:67], v[96:99]
  ds_read_b64_tr_b16 v[144:145], v212 offset:4096
  v_cvt_pk_bf16_f32 v51, v66, v67
  s_add_u32 s45, s18, 4096
  v_mfma_f32_16x16x32_bf16 v[100:103], v[148:151], a[68:71], v[100:103]
  buffer_store_dwordx4 v[48:51], v243, s[68:71], s45 offen sc1
  v_mfma_f32_16x16x32_bf16 v[104:107], v[148:151], a[72:75], v[104:107]
  ds_read_b64_tr_b16 v[146:147], v212 offset:10240
  v_cvt_pk_bf16_f32 v52, v52, v53
  v_mfma_f32_16x16x32_bf16 v[108:111], v[148:151], a[76:79], v[108:111]
  v_cvt_pk_bf16_f32 v53, v54, v55
  v_cvt_pk_bf16_f32 v54, v68, v69
  s_waitcnt lgkmcnt(8)
  v_mfma_f32_16x16x32_bf16 v[112:115], v[152:155], a[64:67], v[112:115]
  ds_read_b64_tr_b16 v[148:149], v213 offset:4096
  v_cvt_pk_bf16_f32 v55, v70, v71
  v_mfma_f32_16x16x32_bf16 v[116:119], v[152:155], a[68:71], v[116:119]
  buffer_store_dwordx4 v[52:55], v243, s[68:71], s45 offen offset:1024 sc1
  v_mfma_f32_16x16x32_bf16 v[120:123], v[152:155], a[72:75], v[120:123]
  ds_read_b64_tr_b16 v[150:151], v213 offset:10240
  v_cvt_pk_bf16_f32 v56, v56, v57
  v_mfma_f32_16x16x32_bf16 v[124:127], v[152:155], a[76:79], v[124:127]
  v_cvt_pk_bf16_f32 v57, v58, v59
  v_cvt_pk_bf16_f32 v58, v72, v73
  s_waitcnt lgkmcnt(8)
  v_mfma_f32_16x16x32_bf16 v[128:131], v[156:159], a[64:67], v[128:131]
  v_cvt_pk_bf16_f32 v59, v74, v75
  v_mfma_f32_16x16x32_bf16 v[132:135], v[156:159], a[68:71], v[132:135]
  buffer_store_dwordx4 v[56:59], v243, s[68:71], s45 offen offset:2048 sc1
  v_mfma_f32_16x16x32_bf16 v[136:139], v[156:159], a[72:75], v[136:139]
  v_cvt_pk_bf16_f32 v60, v60, v61
  v_cvt_pk_bf16_f32 v61, v62, v63
  v_mfma_f32_16x16x32_bf16 v[140:143], v[156:159], a[76:79], v[140:143]
  v_cvt_pk_bf16_f32 v62, v76, v77
  v_cvt_pk_bf16_f32 v63, v78, v79
  s_waitcnt lgkmcnt(0)
  s_waitcnt vmcnt(28)
  s_barrier
  v_mfma_f32_16x16x32_bf16 v[80:83], v[160:163], a[80:83], v[80:83]
  ds_read_b64_tr_b16 v[152:153], v210 offset:24576
  v_mfma_f32_16x16x32_bf16 v[84:87], v[160:163], a[84:87], v[84:87]
  buffer_load_dwordx4 v225, s[60:63], s38 offen lds
  v_mfma_f32_16x16x32_bf16 v[88:91], v[160:163], a[88:91], v[88:91]
  ds_read_b64_tr_b16 v[154:155], v210 offset:30720
  v_mfma_f32_16x16x32_bf16 v[92:95], v[160:163], a[92:95], v[92:95]
  ds_read_b64_tr_b16 v[156:157], v211 offset:24576
  v_mfma_f32_16x16x32_bf16 v[96:99], v[164:167], a[80:83], v[96:99]
  ds_read_b64_tr_b16 v[158:159], v211 offset:30720
  v_mfma_f32_16x16x32_bf16 v[100:103], v[164:167], a[84:87], v[100:103]
  ds_read_b64_tr_b16 v[160:161], v212 offset:24576
  buffer_store_dwordx4 v[60:63], v243, s[68:71], s45 offen offset:3072 sc1
  v_mfma_f32_16x16x32_bf16 v[104:107], v[164:167], a[88:91], v[104:107]
  ds_read_b64_tr_b16 v[162:163], v212 offset:30720
  v_mfma_f32_16x16x32_bf16 v[108:111], v[164:167], a[92:95], v[108:111]
  buffer_load_dwordx4 v226, s[60:63], s38 offen offset:1024 lds
  s_add_u32 m0, s25, 2048
  s_add_u32 s38, s11, 0
  s_add_u32 s38, s38, s30
  v_mfma_f32_16x16x32_bf16 v[112:115], v[144:147], a[80:83], v[112:115]
  ds_read_b64_tr_b16 v[164:165], v213 offset:24576
  v_mfma_f32_16x16x32_bf16 v[116:119], v[144:147], a[84:87], v[116:119]
  buffer_load_dwordx4 v225, s[60:63], s38 offen lds
  v_mfma_f32_16x16x32_bf16 v[120:123], v[144:147], a[88:91], v[120:123]
  ds_read_b64_tr_b16 v[166:167], v213 offset:30720
  v_mfma_f32_16x16x32_bf16 v[124:127], v[144:147], a[92:95], v[124:127]
  v_mfma_f32_16x16x32_bf16 v[128:131], v[148:151], a[80:83], v[128:131]
  ds_read_b64_tr_b16 v[144:145], v210 offset:26624
  v_mfma_f32_16x16x32_bf16 v[132:135], v[148:151], a[84:87], v[132:135]
  buffer_load_dwordx4 v226, s[60:63], s38 offen offset:1024 lds
  v_mfma_f32_16x16x32_bf16 v[136:139], v[148:151], a[88:91], v[136:139]
  ds_read_b64_tr_b16 v[146:147], v210 offset:32768
  v_mfma_f32_16x16x32_bf16 v[140:143], v[148:151], a[92:95], v[140:143]
  s_waitcnt lgkmcnt(8)
  v_mfma_f32_16x16x32_bf16 v[80:83], v[152:155], a[96:99], v[80:83]
  ds_read_b64_tr_b16 v[148:149], v211 offset:26624
  v_mfma_f32_16x16x32_bf16 v[84:87], v[152:155], a[100:103], v[84:87]
  buffer_load_dwordx4 v227, s[60:63], s38 offen offset:2048 lds
  s_add_u32 m0, s25, 5120
  s_add_u32 s38, s11, 55296
  s_add_u32 s38, s38, s30
  v_mfma_f32_16x16x32_bf16 v[88:91], v[152:155], a[104:107], v[88:91]
  ds_read_b64_tr_b16 v[150:151], v211 offset:32768
  v_mfma_f32_16x16x32_bf16 v[92:95], v[152:155], a[108:111], v[92:95]
  s_waitcnt lgkmcnt(8)
  v_mfma_f32_16x16x32_bf16 v[96:99], v[156:159], a[96:99], v[96:99]
  ds_read_b64_tr_b16 v[152:153], v212 offset:26624
  v_mfma_f32_16x16x32_bf16 v[100:103], v[156:159], a[100:103], v[100:103]
  buffer_load_dwordx4 v225, s[60:63], s38 offen lds
  s_add_u32 m0, s25, 24576
  s_add_u32 s38, s16, 0
  s_add_u32 s38, s38, s30
  v_mfma_f32_16x16x32_bf16 v[104:107], v[156:159], a[104:107], v[104:107]
  ds_read_b64_tr_b16 v[154:155], v212 offset:32768
  v_mfma_f32_16x16x32_bf16 v[108:111], v[156:159], a[108:111], v[108:111]
  s_waitcnt lgkmcnt(8)
  v_mfma_f32_16x16x32_bf16 v[112:115], v[160:163], a[96:99], v[112:115]
  ds_read_b64_tr_b16 v[156:157], v213 offset:26624
  v_mfma_f32_16x16x32_bf16 v[116:119], v[160:163], a[100:103], v[116:119]
  v_mfma_f32_16x16x32_bf16 v[120:123], v[160:163], a[104:107], v[120:123]
  ds_read_b64_tr_b16 v[158:159], v213 offset:32768
  v_mfma_f32_16x16x32_bf16 v[124:127], v[160:163], a[108:111], v[124:127]
  s_waitcnt lgkmcnt(8)
  v_mfma_f32_16x16x32_bf16 v[128:131], v[164:167], a[96:99], v[128:131]
  ds_read_b64_tr_b16 v[160:161], v210 offset:28672
  v_mfma_f32_16x16x32_bf16 v[132:135], v[164:167], a[100:103], v[132:135]
  v_mfma_f32_16x16x32_bf16 v[136:139], v[164:167], a[104:107], v[136:139]
  ds_read_b64_tr_b16 v[162:163], v210 offset:34816
  v_mfma_f32_16x16x32_bf16 v[140:143], v[164:167], a[108:111], v[140:143]
  s_waitcnt lgkmcnt(8)
  v_mfma_f32_16x16x32_bf16 v[80:83], v[144:147], a[112:115], v[80:83]
  ds_read_b64_tr_b16 v[164:165], v211 offset:28672
  v_mfma_f32_16x16x32_bf16 v[84:87], v[144:147], a[116:119], v[84:87]
  v_mfma_f32_16x16x32_bf16 v[88:91], v[144:147], a[120:123], v[88:91]
  ds_read_b64_tr_b16 v[166:167], v211 offset:34816
  v_mfma_f32_16x16x32_bf16 v[92:95], v[144:147], a[124:127], v[92:95]
  s_waitcnt lgkmcnt(8)
  v_mfma_f32_16x16x32_bf16 v[96:99], v[148:151], a[112:115], v[96:99]
  ds_read_b64_tr_b16 v[144:145], v212 offset:28672
  v_mfma_f32_16x16x32_bf16 v[100:103], v[148:151], a[116:119], v[100:103]
  v_mfma_f32_16x16x32_bf16 v[104:107], v[148:151], a[120:123], v[104:107]
  ds_read_b64_tr_b16 v[146:147], v212 offset:34816
  v_mfma_f32_16x16x32_bf16 v[108:111], v[148:151], a[124:127], v[108:111]
  s_waitcnt lgkmcnt(8)
  v_mfma_f32_16x16x32_bf16 v[112:115], v[152:155], a[112:115], v[112:115]
  ds_read_b64_tr_b16 v[148:149], v213 offset:28672
  v_mfma_f32_16x16x32_bf16 v[116:119], v[152:155], a[116:119], v[116:119]
  v_mfma_f32_16x16x32_bf16 v[120:123], v[152:155], a[120:123], v[120:123]
  ds_read_b64_tr_b16 v[150:151], v213 offset:34816
  v_mfma_f32_16x16x32_bf16 v[124:127], v[152:155], a[124:127], v[124:127]
  s_waitcnt lgkmcnt(8)
  v_mfma_f32_16x16x32_bf16 v[128:131], v[156:159], a[112:115], v[128:131]
  v_mfma_f32_16x16x32_bf16 v[132:135], v[156:159], a[116:119], v[132:135]
  v_mfma_f32_16x16x32_bf16 v[136:139], v[156:159], a[120:123], v[136:139]
  v_mfma_f32_16x16x32_bf16 v[140:143], v[156:159], a[124:127], v[140:143]
  s_waitcnt lgkmcnt(0)
  s_waitcnt vmcnt(31)
  s_barrier
  v_mfma_f32_16x16x32_bf16 v[80:83], v[160:163], a[128:131], v[80:83]
  ds_read_b64_tr_b16 v[152:153], v168 offset:49152
  v_mfma_f32_16x16x32_bf16 v[84:87], v[160:163], a[132:135], v[84:87]
  buffer_load_dwordx4 v225, s[64:67], s38 offen lds
  v_mfma_f32_16x16x32_bf16 v[88:91], v[160:163], a[136:139], v[88:91]
  ds_read_b64_tr_b16 v[154:155], v168 offset:55296
  v_mfma_f32_16x16x32_bf16 v[92:95], v[160:163], a[140:143], v[92:95]
  ds_read_b64_tr_b16 v[156:157], v169 offset:49152
  v_mfma_f32_16x16x32_bf16 v[96:99], v[164:167], a[128:131], v[96:99]
  ds_read_b64_tr_b16 v[158:159], v169 offset:55296
  v_mfma_f32_16x16x32_bf16 v[100:103], v[164:167], a[132:135], v[100:103]
  ds_read_b64_tr_b16 v[160:161], v170 offset:49152
  v_mfma_f32_16x16x32_bf16 v[104:107], v[164:167], a[136:139], v[104:107]
  ds_read_b64_tr_b16 v[162:163], v170 offset:55296
  v_mfma_f32_16x16x32_bf16 v[108:111], v[164:167], a[140:143], v[108:111]
  buffer_load_dwordx4 v226, s[64:67], s38 offen offset:1024 lds
  v_mfma_f32_16x16x32_bf16 v[112:115], v[144:147], a[128:131], v[112:115]
  ds_read_b64_tr_b16 v[164:165], v171 offset:49152
  v_mfma_f32_16x16x32_bf16 v[116:119], v[144:147], a[132:135], v[116:119]
  buffer_load_dwordx4 v227, s[64:67], s38 offen offset:2048 lds
  s_add_u32 m0, s25, 27648
  s_add_u32 s38, s16, 55296
  s_add_u32 s38, s38, s30
  v_mfma_f32_16x16x32_bf16 v[120:123], v[144:147], a[136:139], v[120:123]
  ds_read_b64_tr_b16 v[166:167], v171 offset:55296
  v_mfma_f32_16x16x32_bf16 v[124:127], v[144:147], a[140:143], v[124:127]
  v_mfma_f32_16x16x32_bf16 v[128:131], v[148:151], a[128:131], v[128:131]
  ds_read_b64_tr_b16 v[144:145], v168 offset:51200
  v_mfma_f32_16x16x32_bf16 v[132:135], v[148:151], a[132:135], v[132:135]
  buffer_load_dwordx4 v225, s[64:67], s38 offen lds
  s_add_u32 m0, s25, 28672
  s_add_u32 s38, s12, 0
  s_add_u32 s38, s38, s30
  v_mfma_f32_16x16x32_bf16 v[136:139], v[148:151], a[136:139], v[136:139]
  ds_read_b64_tr_b16 v[146:147], v168 offset:57344
  v_mfma_f32_16x16x32_bf16 v[140:143], v[148:151], a[140:143], v[140:143]
  s_waitcnt lgkmcnt(8)
  v_mfma_f32_16x16x32_bf16 v[80:83], v[152:155], a[144:147], v[80:83]
  ds_read_b64_tr_b16 v[148:149], v169 offset:51200
  v_mfma_f32_16x16x32_bf16 v[84:87], v[152:155], a[148:151], v[84:87]
  buffer_load_dwordx4 v225, s[60:63], s38 offen lds
  v_mfma_f32_16x16x32_bf16 v[88:91], v[152:155], a[152:155], v[88:91]
  ds_read_b64_tr_b16 v[150:151], v169 offset:57344
  v_mfma_f32_16x16x32_bf16 v[92:95], v[152:155], a[156:159], v[92:95]
  s_waitcnt lgkmcnt(8)
  v_mfma_f32_16x16x32_bf16 v[96:99], v[156:159], a[144:147], v[96:99]
  ds_read_b64_tr_b16 v[152:153], v170 offset:51200
  v_mfma_f32_16x16x32_bf16 v[100:103], v[156:159], a[148:151], v[100:103]
  buffer_load_dwordx4 v226, s[60:63], s38 offen offset:1024 lds
  s_add_u32 m0, s25, 122880
  s_add_u32 s38, s12, 36864
  s_add_u32 s38, s38, s30
  v_mfma_f32_16x16x32_bf16 v[104:107], v[156:159], a[152:155], v[104:107]
  ds_read_b64_tr_b16 v[154:155], v170 offset:57344
  v_mfma_f32_16x16x32_bf16 v[108:111], v[156:159], a[156:159], v[108:111]
  s_waitcnt lgkmcnt(8)
  v_mfma_f32_16x16x32_bf16 v[112:115], v[160:163], a[144:147], v[112:115]
  ds_read_b64_tr_b16 v[156:157], v171 offset:51200
  v_mfma_f32_16x16x32_bf16 v[116:119], v[160:163], a[148:151], v[116:119]
  v_mfma_f32_16x16x32_bf16 v[120:123], v[160:163], a[152:155], v[120:123]
  ds_read_b64_tr_b16 v[158:159], v171 offset:57344
  v_mfma_f32_16x16x32_bf16 v[124:127], v[160:163], a[156:159], v[124:127]
  s_waitcnt lgkmcnt(8)
  v_mfma_f32_16x16x32_bf16 v[128:131], v[164:167], a[144:147], v[128:131]
  v_mfma_f32_16x16x32_bf16 v[132:135], v[164:167], a[148:151], v[132:135]
  v_mfma_f32_16x16x32_bf16 v[136:139], v[164:167], a[152:155], v[136:139]
  v_mfma_f32_16x16x32_bf16 v[140:143], v[164:167], a[156:159], v[140:143]
  s_waitcnt lgkmcnt(0)
  s_waitcnt vmcnt(31)
  s_barrier
  v_mfma_f32_16x16x32_bf16 v[80:83], v[144:147], a[160:163], v[80:83]
  ds_read_b64_tr_b16 v[160:161], v214 offset:49152
  v_mfma_f32_16x16x32_bf16 v[84:87], v[144:147], a[164:167], v[84:87]
  buffer_load_dwordx4 v225, s[60:63], s38 offen lds
  v_mfma_f32_16x16x32_bf16 v[88:91], v[144:147], a[168:171], v[88:91]
  ds_read_b64_tr_b16 v[162:163], v214 offset:49664
  v_mfma_f32_16x16x32_bf16 v[92:95], v[144:147], a[172:175], v[92:95]
  ds_read_b64_tr_b16 v[164:165], v215 offset:49152
  v_mfma_f32_16x16x32_bf16 v[96:99], v[148:151], a[160:163], v[96:99]
  ds_read_b64_tr_b16 v[166:167], v215 offset:49664
  v_mfma_f32_16x16x32_bf16 v[100:103], v[148:151], a[164:167], v[100:103]
  ds_read_b64_tr_b16 v[144:145], v214 offset:50176
  v_mfma_f32_16x16x32_bf16 v[104:107], v[148:151], a[168:171], v[104:107]
  ds_read_b64_tr_b16 v[146:147], v214 offset:50688
  v_mfma_f32_16x16x32_bf16 v[108:111], v[148:151], a[172:175], v[108:111]
  buffer_load_dwordx4 v226, s[60:63], s38 offen offset:1024 lds
  s_add_u32 m0, s25, 124928
  s_add_u32 s38, s13, 0
  s_add_u32 s38, s38, s30
  v_mfma_f32_16x16x32_bf16 v[112:115], v[152:155], a[160:163], v[112:115]
  ds_read_b64_tr_b16 v[148:149], v215 offset:50176
  v_mfma_f32_16x16x32_bf16 v[116:119], v[152:155], a[164:167], v[116:119]
  buffer_load_dwordx4 v225, s[60:63], s38 offen lds
  v_mfma_f32_16x16x32_bf16 v[120:123], v[152:155], a[168:171], v[120:123]
  ds_read_b64_tr_b16 v[150:151], v215 offset:50688
  v_mfma_f32_16x16x32_bf16 v[124:127], v[152:155], a[172:175], v[124:127]
  v_mfma_f32_16x16x32_bf16 v[128:131], v[156:159], a[160:163], v[128:131]
  ds_read_b64_tr_b16 v[152:153], v214 offset:51200
  v_mfma_f32_16x16x32_bf16 v[132:135], v[156:159], a[164:167], v[132:135]
  buffer_load_dwordx4 v226, s[60:63], s38 offen offset:1024 lds
  s_add_u32 m0, s25, 49152
  s_add_u32 s38, s9, 0
  s_add_u32 s38, s38, s31
  v_mfma_f32_16x16x32_bf16 v[136:139], v[156:159], a[168:171], v[136:139]
  ds_read_b64_tr_b16 v[154:155], v214 offset:51712
  v_mfma_f32_16x16x32_bf16 v[140:143], v[156:159], a[172:175], v[140:143]
  s_waitcnt lgkmcnt(8)
  v_mfma_f32_16x16x32_bf16 v[16:19], v[160:163], a[0:3], 0
  ds_read_b64_tr_b16 v[156:157], v215 offset:51200
  v_mfma_f32_16x16x32_bf16 v[20:23], v[160:163], a[4:7], 0
  v_mfma_f32_16x16x32_bf16 v[24:27], v[160:163], a[8:11], 0
  ds_read_b64_tr_b16 v[158:159], v215 offset:51712
  v_mfma_f32_16x16x32_bf16 v[28:31], v[160:163], a[12:15], 0
  s_waitcnt lgkmcnt(8)
  v_mfma_f32_16x16x32_bf16 v[32:35], v[164:167], a[0:3], 0
  ds_read_b64_tr_b16 v[160:161], v214 offset:52224
  v_mfma_f32_16x16x32_bf16 v[36:39], v[164:167], a[4:7], 0
  v_mfma_f32_16x16x32_bf16 v[40:43], v[164:167], a[8:11], 0
  ds_read_b64_tr_b16 v[162:163], v214 offset:52736
  v_mfma_f32_16x16x32_bf16 v[44:47], v[164:167], a[12:15], 0
  s_waitcnt lgkmcnt(8)
  v_mfma_f32_16x16x32_bf16 v[16:19], v[144:147], a[16:19], v[16:19]
  ds_read_b64_tr_b16 v[164:165], v215 offset:52224
  v_mfma_f32_16x16x32_bf16 v[20:23], v[144:147], a[20:23], v[20:23]
  v_mfma_f32_16x16x32_bf16 v[24:27], v[144:147], a[24:27], v[24:27]
  ds_read_b64_tr_b16 v[166:167], v215 offset:52736
  v_cvt_pk_bf16_f32 v80, v80, v81
  v_mfma_f32_16x16x32_bf16 v[28:31], v[144:147], a[28:31], v[28:31]
  v_cvt_pk_bf16_f32 v81, v82, v83
  v_cvt_pk_bf16_f32 v82, v96, v97
  s_waitcnt lgkmcnt(8)
  v_mfma_f32_16x16x32_bf16 v[32:35], v[148:151], a[16:19], v[32:35]
  ds_read_b64_tr_b16 v[144:145], v214 offset:53248
  v_cvt_pk_bf16_f32 v83, v98, v99
  s_add_u32 s45, s18, 32768
  v_mfma_f32_16x16x32_bf16 v[36:39], v[148:151], a[20:23], v[36:39]
  buffer_store_dwordx4 v[80:83], v243, s[68:71], s45 offen sc1
  v_mfma_f32_16x16x32_bf16 v[40:43], v[148:151], a[24:27], v[40:43]
  ds_read_b64_tr_b16 v[146:147], v214 offset:53760
  v_cvt_pk_bf16_f32 v84, v84, v85
  v_mfma_f32_16x16x32_bf16 v[44:47], v[148:151], a[28:31], v[44:47]
  v_cvt_pk_bf16_f32 v85, v86, v87
  s_waitcnt lgkmcnt(8)
  v_mfma_f32_16x16x32_bf16 v[16:19], v[152:155], a[32:35], v[16:19]
  ds_read_b64_tr_b16 v[148:149], v215 offset:53248
  v_cvt_pk_bf16_f32 v86, v100, v101
  v_mfma_f32_16x16x32_bf16 v[20:23], v[152:155], a[36:39], v[20:23]
  v_mfma_f32_16x16x32_bf16 v[24:27], v[152:155], a[40:43], v[24:27]
  ds_read_b64_tr_b16 v[150:151], v215 offset:53760
  v_cvt_pk_bf16_f32 v87, v102, v103
  v_mfma_f32_16x16x32_bf16 v[28:31], v[152:155], a[44:47], v[28:31]
  s_waitcnt lgkmcnt(8)
  v_mfma_f32_16x16x32_bf16 v[32:35], v[156:159], a[32:35], v[32:35]
  ds_read_b64_tr_b16 v[152:153], v214 offset:54272
  v_mfma_f32_16x16x32_bf16 v[36:39], v[156:159], a[36:39], v[36:39]
  buffer_store_dwordx4 v[84:87], v243, s[68:71], s45 offen offset:1024 sc1
  v_mfma_f32_16x16x32_bf16 v[40:43], v[156:159], a[40:43], v[40:43]
  ds_read_b64_tr_b16 v[154:155], v214 offset:54784
  v_cvt_pk_bf16_f32 v88, v88, v89
  v_mfma_f32_16x16x32_bf16 v[44:47], v[156:159], a[44:47], v[44:47]
  v_cvt_pk_bf16_f32 v89, v90, v91
  s_waitcnt lgkmcnt(8)
  v_mfma_f32_16x16x32_bf16 v[16:19], v[160:163], a[48:51], v[16:19]
  ds_read_b64_tr_b16 v[156:157], v215 offset:54272
  v_mfma_f32_16x16x32_bf16 v[20:23], v[160:163], a[52:55], v[20:23]
  v_cvt_pk_bf16_f32 v90, v104, v105
  v_mfma_f32_16x16x32_bf16 v[24:27], v[160:163], a[56:59], v[24:27]
  ds_read_b64_tr_b16 v[158:159], v215 offset:54784
  v_cvt_pk_bf16_f32 v91, v106, v107
  v_mfma_f32_16x16x32_bf16 v[28:31], v[160:163], a[60:63], v[28:31]
  s_waitcnt lgkmcnt(8)
  v_mfma_f32_16x16x32_bf16 v[32:35], v[164:167], a[48:51], v[32:35]
  buffer_store_dwordx4 v[88:91], v243, s[68:71], s45 offen offset:2048 sc1
  v_mfma_f32_16x16x32_bf16 v[36:39], v[164:167], a[52:55], v[36:39]
  v_mfma_f32_16x16x32_bf16 v[40:43], v[164:167], a[56:59], v[40:43]
  v_cvt_pk_bf16_f32 v92, v92, v93
  v_mfma_f32_16x16x32_bf16 v[44:47], v[164:167], a[60:63], v[44:47]
  v_cvt_pk_bf16_f32 v93, v94, v95
  s_waitcnt lgkmcnt(0)
  s_waitcnt vmcnt(33)
  s_barrier
  v_mfma_f32_16x16x32_bf16 v[16:19], v[144:147], a[64:67], v[16:19]
  ds_read_b64_tr_b16 v[160:161], v172 offset:0
  v_mfma_f32_16x16x32_bf16 v[20:23], v[144:147], a[68:71], v[20:23]
  buffer_load_dwordx4 v225, s[60:63], s38 offen lds
  v_mfma_f32_16x16x32_bf16 v[24:27], v[144:147], a[72:75], v[24:27]
  ds_read_b64_tr_b16 v[162:163], v172 offset:512
  v_cvt_pk_bf16_f32 v94, v108, v109
  v_mfma_f32_16x16x32_bf16 v[28:31], v[144:147], a[76:79], v[28:31]
  ds_read_b64_tr_b16 v[164:165], v173 offset:0
  v_cvt_pk_bf16_f32 v95, v110, v111
  v_mfma_f32_16x16x32_bf16 v[32:35], v[148:151], a[64:67], v[32:35]
  ds_read_b64_tr_b16 v[166:167], v173 offset:512
  v_mfma_f32_16x16x32_bf16 v[36:39], v[148:151], a[68:71], v[36:39]
  ds_read_b64_tr_b16 v[144:145], v172 offset:1024
  v_mfma_f32_16x16x32_bf16 v[40:43], v[148:151], a[72:75], v[40:43]
  ds_read_b64_tr_b16 v[146:147], v172 offset:1536
  v_mfma_f32_16x16x32_bf16 v[44:47], v[148:151], a[76:79], v[44:47]
  buffer_load_dwordx4 v226, s[60:63], s38 offen offset:1024 lds
  v_mfma_f32_16x16x32_bf16 v[16:19], v[152:155], a[80:83], v[16:19]
  ds_read_b64_tr_b16 v[148:149], v173 offset:1024
  v_mfma_f32_16x16x32_bf16 v[20:23], v[152:155], a[84:87], v[20:23]
  buffer_load_dwordx4 v227, s[60:63], s38 offen offset:2048 lds
  s_add_u32 m0, s25, 52224
  s_add_u32 s38, s9, 55296
  s_add_u32 s38, s38, s31
  v_mfma_f32_16x16x32_bf16 v[24:27], v[152:155], a[88:91], v[24:27]
  ds_read_b64_tr_b16 v[150:151], v173 offset:1536
  v_mfma_f32_16x16x32_bf16 v[28:31], v[152:155], a[92:95], v[28:31]
  buffer_store_dwordx4 v[92:95], v243, s[68:71], s45 offen offset:3072 sc1
  v_mfma_f32_16x16x32_bf16 v[32:35], v[156:159], a[80:83], v[32:35]
  ds_read_b64_tr_b16 v[152:153], v172 offset:2048
  v_cvt_pk_bf16_f32 v112, v112, v113
  v_mfma_f32_16x16x32_bf16 v[36:39], v[156:159], a[84:87], v[36:39]
  buffer_load_dwordx4 v225, s[60:63], s38 offen lds
  s_add_u32 m0, s25, 53248
  s_add_u32 s38, s10, 0
  s_add_u32 s38, s38, s31
  v_mfma_f32_16x16x32_bf16 v[40:43], v[156:159], a[88:91], v[40:43]
  ds_read_b64_tr_b16 v[154:155], v172 offset:2560
  v_cvt_pk_bf16_f32 v113, v114, v115
  v_mfma_f32_16x16x32_bf16 v[44:47], v[156:159], a[92:95], v[44:47]
  v_cvt_pk_bf16_f32 v114, v128, v129
  v_cvt_pk_bf16_f32 v115, v130, v131
  s_add_u32 s45, s18, 36864
  s_waitcnt lgkmcnt(8)
  v_mfma_f32_16x16x32_bf16 v[16:19], v[160:163], a[96:99], v[16:19]
  ds_read_b64_tr_b16 v[156:157], v173 offset:2048
  v_mfma_f32_16x16x32_bf16 v[20:23], v[160:163], a[100:103], v[20:23]
  buffer_load_dwordx4 v225, s[60:63], s38 offen lds
  v_mfma_f32_16x16x32_bf16 v[24:27], v[160:163], a[104:107], v[24:27]
  ds_read_b64_tr_b16 v[158:159], v173 offset:2560
  s_waitcnt vmcnt(24)
  v_mov_b32 v9, 1
  v_mov_b32 v10, 0
  s_mov_b64 exec, 1
  buffer_store_dword v9, v10, s[68:71], s27 offen sc1
  s_mov_b64 exec, -1
  v_mfma_f32_16x16x32_bf16 v[28:31], v[160:163], a[108:111], v[28:31]
  buffer_store_dwordx4 v[112:115], v243, s[68:71], s45 offen sc1
  s_waitcnt lgkmcnt(8)
  v_mfma_f32_16x16x32_bf16 v[32:35], v[164:167], a[96:99], v[32:35]
  ds_read_b64_tr_b16 v[160:161], v172 offset:3072
  v_cvt_pk_bf16_f32 v116, v116, v117
  v_mfma_f32_16x16x32_bf16 v[36:39], v[164:167], a[100:103], v[36:39]
  buffer_load_dwordx4 v226, s[60:63], s38 offen offset:1024 lds
  s_add_u32 m0, s25, 73728
  s_add_u32 s38, s10, 36864
  s_add_u32 s38, s38, s31
  v_mfma_f32_16x16x32_bf16 v[40:43], v[164:167], a[104:107], v[40:43]
  ds_read_b64_tr_b16 v[162:163], v172 offset:3584
  v_cvt_pk_bf16_f32 v117, v118, v119
  v_mfma_f32_16x16x32_bf16 v[44:47], v[164:167], a[108:111], v[44:47]
  v_cvt_pk_bf16_f32 v118, v132, v133
  v_cvt_pk_bf16_f32 v119, v134, v135
  s_waitcnt lgkmcnt(8)
  v_mfma_f32_16x16x32_bf16 v[16:19], v[144:147], a[112:115], v[16:19]
  ds_read_b64_tr_b16 v[164:165], v173 offset:3072
  v_mfma_f32_16x16x32_bf16 v[20:23], v[144:147], a[116:119], v[20:23]
  buffer_store_dwordx4 v[116:119], v243, s[68:71], s45 offen offset:1024 sc1
  v_mfma_f32_16x16x32_bf16 v[24:27], v[144:147], a[120:123], v[24:27]
  ds_read_b64_tr_b16 v[166:167], v173 offset:3584
  v_cvt_pk_bf16_f32 v120, v120, v121
  v_mfma_f32_16x16x32_bf16 v[28:31], v[144:147], a[124:127], v[28:31]
  v_cvt_pk_bf16_f32 v121, v122, v123
  s_waitcnt lgkmcnt(8)
  v_mfma_f32_16x16x32_bf16 v[32:35], v[148:151], a[112:115], v[32:35]
  ds_read_b64_tr_b16 v[144:145], v172 offset:4096
  v_cvt_pk_bf16_f32 v122, v136, v137
  v_mfma_f32_16x16x32_bf16 v[36:39], v[148:151], a[116:119], v[36:39]
  v_mfma_f32_16x16x32_bf16 v[40:43], v[148:151], a[120:123], v[40:43]
  ds_read_b64_tr_b16 v[146:147], v172 offset:4608
  v_cvt_pk_bf16_f32 v123, v138, v139
  v_mfma_f32_16x16x32_bf16 v[44:47], v[148:151], a[124:127], v[44:47]
  s_waitcnt lgkmcnt(8)
  v_mfma_f32_16x16x32_bf16 v[16:19], v[152:155], a[128:131], v[16:19]
  ds_read_b64_tr_b16 v[148:149], v173 offset:4096
  v_mfma_f32_16x16x32_bf16 v[20:23], v[152:155], a[132:135], v[20:23]
  buffer_store_dwordx4 v[120:123], v243, s[68:71], s45 offen offset:2048 sc1
  v_mfma_f32_16x16x32_bf16 v[24:27], v[152:155], a[136:139], v[24:27]
  ds_read_b64_tr_b16 v[150:151], v173 offset:4608
  v_cvt_pk_bf16_f32 v124, v124, v125
  v_mfma_f32_16x16x32_bf16 v[28:31], v[152:155], a[140:143], v[28:31]
  v_cvt_pk_bf16_f32 v125, v126, v127
  s_waitcnt lgkmcnt(8)
  v_mfma_f32_16x16x32_bf16 v[32:35], v[156:159], a[128:131], v[32:35]
  v_mfma_f32_16x16x32_bf16 v[36:39], v[156:159], a[132:135], v[36:39]
  v_cvt_pk_bf16_f32 v126, v140, v141
  v_mfma_f32_16x16x32_bf16 v[40:43], v[156:159], a[136:139], v[40:43]
  v_cvt_pk_bf16_f32 v127, v142, v143
  v_mfma_f32_16x16x32_bf16 v[44:47], v[156:159], a[140:143], v[44:47]
  s_waitcnt lgkmcnt(0)
  s_barrier
  v_mfma_f32_16x16x32_bf16 v[16:19], v[160:163], a[144:147], v[16:19]
  ds_read_b64_tr_b16 v[152:153], v168 offset:24576
  v_mfma_f32_16x16x32_bf16 v[20:23], v[160:163], a[148:151], v[20:23]
  buffer_load_dwordx4 v225, s[60:63], s38 offen lds
  v_mfma_f32_16x16x32_bf16 v[24:27], v[160:163], a[152:155], v[24:27]
  ds_read_b64_tr_b16 v[154:155], v168 offset:30720
  v_mfma_f32_16x16x32_bf16 v[28:31], v[160:163], a[156:159], v[28:31]
  ds_read_b64_tr_b16 v[156:157], v169 offset:24576
  v_mfma_f32_16x16x32_bf16 v[32:35], v[164:167], a[144:147], v[32:35]
  ds_read_b64_tr_b16 v[158:159], v169 offset:30720
  v_mfma_f32_16x16x32_bf16 v[36:39], v[164:167], a[148:151], v[36:39]
  ds_read_b64_tr_b16 v[160:161], v170 offset:24576
  v_mfma_f32_16x16x32_bf16 v[40:43], v[164:167], a[152:155], v[40:43]
  ds_read_b64_tr_b16 v[162:163], v170 offset:30720
  v_mfma_f32_16x16x32_bf16 v[44:47], v[164:167], a[156:159], v[44:47]
  buffer_load_dwordx4 v226, s[60:63], s38 offen offset:1024 lds
  s_add_u32 m0, s25, 75776
  s_add_u32 s38, s11, 0
  s_add_u32 s38, s38, s31
  v_mfma_f32_16x16x32_bf16 v[16:19], v[144:147], a[160:163], v[16:19]
  ds_read_b64_tr_b16 v[164:165], v171 offset:24576
  buffer_store_dwordx4 v[124:127], v243, s[68:71], s45 offen offset:3072 sc1
  v_mfma_f32_16x16x32_bf16 v[20:23], v[144:147], a[164:167], v[20:23]
  buffer_load_dwordx4 v225, s[60:63], s38 offen lds
  v_mfma_f32_16x16x32_bf16 v[24:27], v[144:147], a[168:171], v[24:27]
  ds_read_b64_tr_b16 v[166:167], v171 offset:30720
  v_mfma_f32_16x16x32_bf16 v[28:31], v[144:147], a[172:175], v[28:31]
  v_mfma_f32_16x16x32_bf16 v[32:35], v[148:151], a[160:163], v[32:35]
  ds_read_b64_tr_b16 v[144:145], v168 offset:26624
  v_mfma_f32_16x16x32_bf16 v[36:39], v[148:151], a[164:167], v[36:39]
  buffer_load_dwordx4 v226, s[60:63], s38 offen offset:1024 lds
  v_mfma_f32_16x16x32_bf16 v[40:43], v[148:151], a[168:171], v[40:43]
  ds_read_b64_tr_b16 v[146:147], v168 offset:32768
  v_mfma_f32_16x16x32_bf16 v[44:47], v[148:151], a[172:175], v[44:47]
  s_waitcnt lgkmcnt(8)
  v_mfma_f32_16x16x32_bf16 v[80:83], v[152:155], a[0:3], 0
  ds_read_b64_tr_b16 v[148:149], v169 offset:26624
  v_mfma_f32_16x16x32_bf16 v[84:87], v[152:155], a[4:7], 0
  buffer_load_dwordx4 v227, s[60:63], s38 offen offset:2048 lds
  s_add_u32 m0, s25, 78848
  s_add_u32 s38, s11, 55296
  s_add_u32 s38, s38, s31
  v_mfma_f32_16x16x32_bf16 v[88:91], v[152:155], a[8:11], 0
  ds_read_b64_tr_b16 v[150:151], v169 offset:32768
  v_mfma_f32_16x16x32_bf16 v[92:95], v[152:155], a[12:15], 0
  s_waitcnt lgkmcnt(8)
  v_mfma_f32_16x16x32_bf16 v[96:99], v[156:159], a[0:3], 0
  ds_read_b64_tr_b16 v[152:153], v170 offset:26624
  v_mfma_f32_16x16x32_bf16 v[100:103], v[156:159], a[4:7], 0
  buffer_load_dwordx4 v225, s[60:63], s38 offen lds
  s_add_u32 m0, s25, 98304
  s_add_u32 s38, s16, 0
  s_add_u32 s38, s38, s31
  v_mfma_f32_16x16x32_bf16 v[104:107], v[156:159], a[8:11], 0
  ds_read_b64_tr_b16 v[154:155], v170 offset:32768
  v_mfma_f32_16x16x32_bf16 v[108:111], v[156:159], a[12:15], 0
  s_waitcnt lgkmcnt(8)
  v_mfma_f32_16x16x32_bf16 v[112:115], v[160:163], a[0:3], 0
  ds_read_b64_tr_b16 v[156:157], v171 offset:26624
  v_mfma_f32_16x16x32_bf16 v[116:119], v[160:163], a[4:7], 0
  v_mfma_f32_16x16x32_bf16 v[120:123], v[160:163], a[8:11], 0
  ds_read_b64_tr_b16 v[158:159], v171 offset:32768
  v_cvt_pk_bf16_f32 v16, v16, v17
  v_mfma_f32_16x16x32_bf16 v[124:127], v[160:163], a[12:15], 0
  v_cvt_pk_bf16_f32 v17, v18, v19
  v_cvt_pk_bf16_f32 v18, v32, v33
  s_waitcnt lgkmcnt(8)
  v_mfma_f32_16x16x32_bf16 v[128:131], v[164:167], a[0:3], 0
  ds_read_b64_tr_b16 v[160:161], v168 offset:28672
  v_cvt_pk_bf16_f32 v19, v34, v35
  s_mov_b32 s45, s44
  v_mfma_f32_16x16x32_bf16 v[132:135], v[164:167], a[4:7], 0
  buffer_store_dwordx4 v[16:19], v243, s[68:71], s45 offen sc1
  v_mfma_f32_16x16x32_bf16 v[136:139], v[164:167], a[8:11], 0
  ds_read_b64_tr_b16 v[162:163], v168 offset:34816
  v_cvt_pk_bf16_f32 v20, v20, v21
  v_mfma_f32_16x16x32_bf16 v[140:143], v[164:167], a[12:15], 0
  s_waitcnt lgkmcnt(8)
  v_mfma_f32_16x16x32_bf16 v[80:83], v[144:147], a[16:19], v[80:83]
  ds_read_b64_tr_b16 v[164:165], v169 offset:28672
  v_mfma_f32_16x16x32_bf16 v[84:87], v[144:147], a[20:23], v[84:87]
  v_cvt_pk_bf16_f32 v21, v22, v23
  v_mfma_f32_16x16x32_bf16 v[88:91], v[144:147], a[24:27], v[88:91]
  ds_read_b64_tr_b16 v[166:167], v169 offset:34816
  v_mfma_f32_16x16x32_bf16 v[92:95], v[144:147], a[28:31], v[92:95]
  v_cvt_pk_bf16_f32 v22, v36, v37
  s_waitcnt lgkmcnt(8)
  v_mfma_f32_16x16x32_bf16 v[96:99], v[148:151], a[16:19], v[96:99]
  ds_read_b64_tr_b16 v[144:145], v170 offset:28672
  v_mov_b32 v11, 0
  v_mfma_f32_16x16x32_bf16 v[100:103], v[148:151], a[20:23], v[100:103]
  buffer_load_dwordx4 v[4:7], v11, s[68:71], s26 offen sc1
  v_mfma_f32_16x16x32_bf16 v[104:107], v[148:151], a[24:27], v[104:107]
  ds_read_b64_tr_b16 v[146:147], v170 offset:34816
  v_cvt_pk_bf16_f32 v23, v38, v39
  v_mfma_f32_16x16x32_bf16 v[108:111], v[148:151], a[28:31], v[108:111]
  s_waitcnt lgkmcnt(8)
  v_mfma_f32_16x16x32_bf16 v[112:115], v[152:155], a[16:19], v[112:115]
  ds_read_b64_tr_b16 v[148:149], v171 offset:28672
  v_mfma_f32_16x16x32_bf16 v[116:119], v[152:155], a[20:23], v[116:119]
  buffer_store_dwordx4 v[20:23], v243, s[68:71], s45 offen offset:1024 sc1
  v_mfma_f32_16x16x32_bf16 v[120:123], v[152:155], a[24:27], v[120:123]
  ds_read_b64_tr_b16 v[150:151], v171 offset:34816
  v_mfma_f32_16x16x32_bf16 v[124:127], v[152:155], a[28:31], v[124:127]
  v_cvt_pk_bf16_f32 v24, v24, v25
  s_waitcnt lgkmcnt(8)
  v_mfma_f32_16x16x32_bf16 v[128:131], v[156:159], a[16:19], v[128:131]
  v_mfma_f32_16x16x32_bf16 v[132:135], v[156:159], a[20:23], v[132:135]
  v_cvt_pk_bf16_f32 v25, v26, v27
  v_mfma_f32_16x16x32_bf16 v[136:139], v[156:159], a[24:27], v[136:139]
  v_mfma_f32_16x16x32_bf16 v[140:143], v[156:159], a[28:31], v[140:143]
  v_cvt_pk_bf16_f32 v26, v40, v41
  s_waitcnt lgkmcnt(0)
  s_waitcnt vmcnt(34)
  s_barrier
  v_mfma_f32_16x16x32_bf16 v[80:83], v[160:163], a[32:35], v[80:83]
  ds_read_b64_tr_b16 v[152:153], v210 offset:0
  v_mfma_f32_16x16x32_bf16 v[84:87], v[160:163], a[36:39], v[84:87]
  buffer_load_dwordx4 v225, s[64:67], s38 offen lds
  v_mfma_f32_16x16x32_bf16 v[88:91], v[160:163], a[40:43], v[88:91]
  ds_read_b64_tr_b16 v[154:155], v210 offset:6144
  v_cvt_pk_bf16_f32 v27, v42, v43
  v_mfma_f32_16x16x32_bf16 v[92:95], v[160:163], a[44:47], v[92:95]
  ds_read_b64_tr_b16 v[156:157], v211 offset:0
  v_mfma_f32_16x16x32_bf16 v[96:99], v[164:167], a[32:35], v[96:99]
  ds_read_b64_tr_b16 v[158:159], v211 offset:6144
  v_mfma_f32_16x16x32_bf16 v[100:103], v[164:167], a[36:39], v[100:103]
  ds_read_b64_tr_b16 v[160:161], v212 offset:0
  v_mfma_f32_16x16x32_bf16 v[104:107], v[164:167], a[40:43], v[104:107]
  ds_read_b64_tr_b16 v[162:163], v212 offset:6144
  v_mfma_f32_16x16x32_bf16 v[108:111], v[164:167], a[44:47], v[108:111]
  buffer_load_dwordx4 v226, s[64:67], s38 offen offset:1024 lds
  v_mfma_f32_16x16x32_bf16 v[112:115], v[144:147], a[32:35], v[112:115]
  ds_read_b64_tr_b16 v[164:165], v213 offset:0
  v_mfma_f32_16x16x32_bf16 v[116:119], v[144:147], a[36:39], v[116:119]
  buffer_load_dwordx4 v227, s[64:67], s38 offen offset:2048 lds
  s_add_u32 m0, s25, 101376
  s_add_u32 s38, s16, 55296
  s_add_u32 s38, s38, s31
  v_mfma_f32_16x16x32_bf16 v[120:123], v[144:147], a[40:43], v[120:123]
  ds_read_b64_tr_b16 v[166:167], v213 offset:6144
  v_mfma_f32_16x16x32_bf16 v[124:127], v[144:147], a[44:47], v[124:127]
  buffer_store_dwordx4 v[24:27], v243, s[68:71], s45 offen offset:2048 sc1
  v_mfma_f32_16x16x32_bf16 v[128:131], v[148:151], a[32:35], v[128:131]
  ds_read_b64_tr_b16 v[144:145], v210 offset:2048
  v_cvt_pk_bf16_f32 v28, v28, v29
  v_mfma_f32_16x16x32_bf16 v[132:135], v[148:151], a[36:39], v[132:135]
  buffer_load_dwordx4 v225, s[64:67], s38 offen lds
  s_add_u32 m0, s25, 102400
  s_add_u32 s38, s12, 0
  s_add_u32 s38, s38, s31
  v_mfma_f32_16x16x32_bf16 v[136:139], v[148:151], a[40:43], v[136:139]
  ds_read_b64_tr_b16 v[146:147], v210 offset:8192
  v_cvt_pk_bf16_f32 v29, v30, v31
  v_mfma_f32_16x16x32_bf16 v[140:143], v[148:151], a[44:47], v[140:143]
  v_cvt_pk_bf16_f32 v30, v44, v45
  v_cvt_pk_bf16_f32 v31, v46, v47
  s_waitcnt lgkmcnt(8)
  v_mfma_f32_16x16x32_bf16 v[80:83], v[152:155], a[48:51], v[80:83]
  ds_read_b64_tr_b16 v[148:149], v211 offset:2048
  v_mfma_f32_16x16x32_bf16 v[84:87], v[152:155], a[52:55], v[84:87]
  buffer_load_dwordx4 v225, s[60:63], s38 offen lds
  v_mfma_f32_16x16x32_bf16 v[88:91], v[152:155], a[56:59], v[88:91]
  ds_read_b64_tr_b16 v[150:151], v211 offset:8192
  v_mfma_f32_16x16x32_bf16 v[92:95], v[152:155], a[60:63], v[92:95]
  buffer_store_dwordx4 v[28:31], v243, s[68:71], s45 offen offset:3072 sc1
  s_waitcnt lgkmcnt(8)
  v_mfma_f32_16x16x32_bf16 v[96:99], v[156:159], a[48:51], v[96:99]
  ds_read_b64_tr_b16 v[152:153], v212 offset:2048
  v_mfma_f32_16x16x32_bf16 v[100:103], v[156:159], a[52:55], v[100:103]
  buffer_load_dwordx4 v226, s[60:63], s38 offen offset:1024 lds
  s_add_u32 m0, s25, 0
  s_add_u32 s38, s12, 36864
  s_add_u32 s38, s38, s31
  v_mfma_f32_16x16x32_bf16 v[104:107], v[156:159], a[56:59], v[104:107]
  ds_read_b64_tr_b16 v[154:155], v212 offset:8192
  v_mfma_f32_16x16x32_bf16 v[108:111], v[156:159], a[60:63], v[108:111]
  s_waitcnt lgkmcnt(8)
  v_mfma_f32_16x16x32_bf16 v[112:115], v[160:163], a[48:51], v[112:115]
  ds_read_b64_tr_b16 v[156:157], v213 offset:2048
  v_mfma_f32_16x16x32_bf16 v[116:119], v[160:163], a[52:55], v[116:119]
  v_mfma_f32_16x16x32_bf16 v[120:123], v[160:163], a[56:59], v[120:123]
  ds_read_b64_tr_b16 v[158:159], v213 offset:8192
  v_mfma_f32_16x16x32_bf16 v[124:127], v[160:163], a[60:63], v[124:127]
  s_waitcnt lgkmcnt(8)
  v_mfma_f32_16x16x32_bf16 v[128:131], v[164:167], a[48:51], v[128:131]
  ds_read_b64_tr_b16 v[160:161], v210 offset:4096
  v_mfma_f32_16x16x32_bf16 v[132:135], v[164:167], a[52:55], v[132:135]
  v_mfma_f32_16x16x32_bf16 v[136:139], v[164:167], a[56:59], v[136:139]
  ds_read_b64_tr_b16 v[162:163], v210 offset:10240
  v_mfma_f32_16x16x32_bf16 v[140:143], v[164:167], a[60:63], v[140:143]
  s_waitcnt lgkmcnt(8)
  v_mfma_f32_16x16x32_bf16 v[80:83], v[144:147], a[64:67], v[80:83]
  ds_read_b64_tr_b16 v[164:165], v211 offset:4096
  v_mfma_f32_16x16x32_bf16 v[84:87], v[144:147], a[68:71], v[84:87]
  v_mfma_f32_16x16x32_bf16 v[88:91], v[144:147], a[72:75], v[88:91]
  ds_read_b64_tr_b16 v[166:167], v211 offset:10240
  v_mfma_f32_16x16x32_bf16 v[92:95], v[144:147], a[76:79], v[92:95]
  s_waitcnt lgkmcnt(8)
  v_mfma_f32_16x16x32_bf16 v[96:99], v[148:151], a[64:67], v[96:99]
  ds_read_b64_tr_b16 v[144:145], v212 offset:4096
  v_mfma_f32_16x16x32_bf16 v[100:103], v[148:151], a[68:71], v[100:103]
  v_mfma_f32_16x16x32_bf16 v[104:107], v[148:151], a[72:75], v[104:107]
  ds_read_b64_tr_b16 v[146:147], v212 offset:10240
  v_mfma_f32_16x16x32_bf16 v[108:111], v[148:151], a[76:79], v[108:111]
  s_waitcnt lgkmcnt(8)
  v_mfma_f32_16x16x32_bf16 v[112:115], v[152:155], a[64:67], v[112:115]
  ds_read_b64_tr_b16 v[148:149], v213 offset:4096
  v_mfma_f32_16x16x32_bf16 v[116:119], v[152:155], a[68:71], v[116:119]
  v_mfma_f32_16x16x32_bf16 v[120:123], v[152:155], a[72:75], v[120:123]
  ds_read_b64_tr_b16 v[150:151], v213 offset:10240
  v_mfma_f32_16x16x32_bf16 v[124:127], v[152:155], a[76:79], v[124:127]
  s_waitcnt lgkmcnt(8)
  v_mfma_f32_16x16x32_bf16 v[128:131], v[156:159], a[64:67], v[128:131]
  v_mfma_f32_16x16x32_bf16 v[132:135], v[156:159], a[68:71], v[132:135]
  v_mfma_f32_16x16x32_bf16 v[136:139], v[156:159], a[72:75], v[136:139]
  v_mfma_f32_16x16x32_bf16 v[140:143], v[156:159], a[76:79], v[140:143]
  s_waitcnt lgkmcnt(0)
  s_waitcnt vmcnt(36)
  s_barrier
  v_mfma_f32_16x16x32_bf16 v[80:83], v[160:163], a[80:83], v[80:83]
  ds_read_b64_tr_b16 v[152:153], v210 offset:24576
  v_mfma_f32_16x16x32_bf16 v[84:87], v[160:163], a[84:87], v[84:87]
  buffer_load_dwordx4 v225, s[60:63], s38 offen lds
  v_mfma_f32_16x16x32_bf16 v[88:91], v[160:163], a[88:91], v[88:91]
  ds_read_b64_tr_b16 v[154:155], v210 offset:30720
  v_mfma_f32_16x16x32_bf16 v[92:95], v[160:163], a[92:95], v[92:95]
  ds_read_b64_tr_b16 v[156:157], v211 offset:24576
  v_mfma_f32_16x16x32_bf16 v[96:99], v[164:167], a[80:83], v[96:99]
  ds_read_b64_tr_b16 v[158:159], v211 offset:30720
  v_mfma_f32_16x16x32_bf16 v[100:103], v[164:167], a[84:87], v[100:103]
  ds_read_b64_tr_b16 v[160:161], v212 offset:24576
  v_mfma_f32_16x16x32_bf16 v[104:107], v[164:167], a[88:91], v[104:107]
  ds_read_b64_tr_b16 v[162:163], v212 offset:30720
  v_mfma_f32_16x16x32_bf16 v[108:111], v[164:167], a[92:95], v[108:111]
  buffer_load_dwordx4 v226, s[60:63], s38 offen offset:1024 lds
  s_add_u32 m0, s25, 2048
  s_add_u32 s38, s13, 0
  s_add_u32 s38, s38, s31
  v_mfma_f32_16x16x32_bf16 v[112:115], v[144:147], a[80:83], v[112:115]
  ds_read_b64_tr_b16 v[164:165], v213 offset:24576
  v_mfma_f32_16x16x32_bf16 v[116:119], v[144:147], a[84:87], v[116:119]
  buffer_load_dwordx4 v225, s[60:63], s38 offen lds
  v_mfma_f32_16x16x32_bf16 v[120:123], v[144:147], a[88:91], v[120:123]
  ds_read_b64_tr_b16 v[166:167], v213 offset:30720
  v_mfma_f32_16x16x32_bf16 v[124:127], v[144:147], a[92:95], v[124:127]
  v_mfma_f32_16x16x32_bf16 v[128:131], v[148:151], a[80:83], v[128:131]
  ds_read_b64_tr_b16 v[144:145], v210 offset:26624
  v_mfma_f32_16x16x32_bf16 v[132:135], v[148:151], a[84:87], v[132:135]
  buffer_load_dwordx4 v226, s[60:63], s38 offen offset:1024 lds
  v_mfma_f32_16x16x32_bf16 v[136:139], v[148:151], a[88:91], v[136:139]
  ds_read_b64_tr_b16 v[146:147], v210 offset:32768
  v_mfma_f32_16x16x32_bf16 v[140:143], v[148:151], a[92:95], v[140:143]
  s_waitcnt lgkmcnt(8)
  v_mfma_f32_16x16x32_bf16 v[80:83], v[152:155], a[96:99], v[80:83]
  ds_read_b64_tr_b16 v[148:149], v211 offset:26624
  v_mfma_f32_16x16x32_bf16 v[84:87], v[152:155], a[100:103], v[84:87]
  v_mfma_f32_16x16x32_bf16 v[88:91], v[152:155], a[104:107], v[88:91]
  ds_read_b64_tr_b16 v[150:151], v211 offset:32768
  v_mfma_f32_16x16x32_bf16 v[92:95], v[152:155], a[108:111], v[92:95]
  s_waitcnt lgkmcnt(8)
  v_mfma_f32_16x16x32_bf16 v[96:99], v[156:159], a[96:99], v[96:99]
  ds_read_b64_tr_b16 v[152:153], v212 offset:26624
  v_mfma_f32_16x16x32_bf16 v[100:103], v[156:159], a[100:103], v[100:103]
  v_mfma_f32_16x16x32_bf16 v[104:107], v[156:159], a[104:107], v[104:107]
  ds_read_b64_tr_b16 v[154:155], v212 offset:32768
  v_mfma_f32_16x16x32_bf16 v[108:111], v[156:159], a[108:111], v[108:111]
  s_waitcnt lgkmcnt(8)
  v_mfma_f32_16x16x32_bf16 v[112:115], v[160:163], a[96:99], v[112:115]
  ds_read_b64_tr_b16 v[156:157], v213 offset:26624
  v_mfma_f32_16x16x32_bf16 v[116:119], v[160:163], a[100:103], v[116:119]
  v_mfma_f32_16x16x32_bf16 v[120:123], v[160:163], a[104:107], v[120:123]
  ds_read_b64_tr_b16 v[158:159], v213 offset:32768
  v_mfma_f32_16x16x32_bf16 v[124:127], v[160:163], a[108:111], v[124:127]
  s_waitcnt lgkmcnt(8)
  v_mfma_f32_16x16x32_bf16 v[128:131], v[164:167], a[96:99], v[128:131]
  ds_read_b64_tr_b16 v[160:161], v210 offset:28672
  v_mfma_f32_16x16x32_bf16 v[132:135], v[164:167], a[100:103], v[132:135]
  v_mfma_f32_16x16x32_bf16 v[136:139], v[164:167], a[104:107], v[136:139]
  ds_read_b64_tr_b16 v[162:163], v210 offset:34816
  v_mfma_f32_16x16x32_bf16 v[140:143], v[164:167], a[108:111], v[140:143]
  s_waitcnt lgkmcnt(8)
  v_mfma_f32_16x16x32_bf16 v[80:83], v[144:147], a[112:115], v[80:83]
  ds_read_b64_tr_b16 v[164:165], v211 offset:28672
  v_mfma_f32_16x16x32_bf16 v[84:87], v[144:147], a[116:119], v[84:87]
  v_mfma_f32_16x16x32_bf16 v[88:91], v[144:147], a[120:123], v[88:91]
  ds_read_b64_tr_b16 v[166:167], v211 offset:34816
  v_mfma_f32_16x16x32_bf16 v[92:95], v[144:147], a[124:127], v[92:95]
  s_waitcnt lgkmcnt(8)
  v_mfma_f32_16x16x32_bf16 v[96:99], v[148:151], a[112:115], v[96:99]
  ds_read_b64_tr_b16 v[144:145], v212 offset:28672
  v_mfma_f32_16x16x32_bf16 v[100:103], v[148:151], a[116:119], v[100:103]
  v_mfma_f32_16x16x32_bf16 v[104:107], v[148:151], a[120:123], v[104:107]
  ds_read_b64_tr_b16 v[146:147], v212 offset:34816
  v_mfma_f32_16x16x32_bf16 v[108:111], v[148:151], a[124:127], v[108:111]
  s_waitcnt lgkmcnt(8)
  v_mfma_f32_16x16x32_bf16 v[112:115], v[152:155], a[112:115], v[112:115]
  ds_read_b64_tr_b16 v[148:149], v213 offset:28672
  v_mfma_f32_16x16x32_bf16 v[116:119], v[152:155], a[116:119], v[116:119]
  v_mfma_f32_16x16x32_bf16 v[120:123], v[152:155], a[120:123], v[120:123]
  ds_read_b64_tr_b16 v[150:151], v213 offset:34816
  v_mfma_f32_16x16x32_bf16 v[124:127], v[152:155], a[124:127], v[124:127]
  s_waitcnt lgkmcnt(8)
  v_mfma_f32_16x16x32_bf16 v[128:131], v[156:159], a[112:115], v[128:131]
  v_mfma_f32_16x16x32_bf16 v[132:135], v[156:159], a[116:119], v[132:135]
  v_mfma_f32_16x16x32_bf16 v[136:139], v[156:159], a[120:123], v[136:139]
  v_mfma_f32_16x16x32_bf16 v[140:143], v[156:159], a[124:127], v[140:143]
  s_waitcnt vmcnt(13)
  v_and_b32 v4, v4, v5
  v_and_b32 v6, v6, v7
  v_and_b32 v4, v4, v6
  s_nop 0
  v_readfirstlane_b32 s36, v4
  s_nop 3
  s_cmp_eq_u32 s36, 1
  s_cbranch_scc1 K1_poll2_ok
K1_poll2_spin:
  s_sleep 1
  buffer_load_dwordx4 v[4:7], v11, s[68:71], s26 offen sc1
  s_waitcnt vmcnt(0)
  v_and_b32 v4, v4, v5
  v_and_b32 v6, v6, v7
  v_and_b32 v4, v4, v6
  s_nop 1
  v_readfirstlane_b32 s36, v4
  s_nop 3
  s_cmp_eq_u32 s36, 1
  s_cbranch_scc0 K1_poll2_spin
K1_poll2_ok:
  s_waitcnt lgkmcnt(0)
  s_barrier
  v_mfma_f32_16x16x32_bf16 v[80:83], v[160:163], a[128:131], v[80:83]
  ds_read_b64_tr_b16 v[152:153], v168 offset:49152
  v_mfma_f32_16x16x32_bf16 v[84:87], v[160:163], a[132:135], v[84:87]
  s_add_u32 s40, s19, 0
  buffer_load_dwordx4 v[176:179], v243, s[68:71], s40 offen sc1
  buffer_load_dwordx4 v[180:183], v243, s[68:71], s40 offen offset:1024 sc1
  v_mfma_f32_16x16x32_bf16 v[88:91], v[160:163], a[136:139], v[88:91]
  ds_read_b64_tr_b16 v[154:155], v168 offset:55296
  buffer_load_dwordx4 v[184:187], v243, s[68:71], s40 offen offset:2048 sc1
  v_mov_b32 v9, 1
  v_mov_b32 v10, 16
  s_mov_b64 exec, 1
  buffer_store_dword v9, v10, s[68:71], s27 offen sc1
  s_mov_b64 exec, -1
  v_mfma_f32_16x16x32_bf16 v[92:95], v[160:163], a[140:143], v[92:95]
  ds_read_b64_tr_b16 v[156:157], v169 offset:49152
  buffer_load_dwordx4 v[188:191], v243, s[68:71], s40 offen offset:3072 sc1
  v_mfma_f32_16x16x32_bf16 v[96:99], v[164:167], a[128:131], v[96:99]
  ds_read_b64_tr_b16 v[158:159], v169 offset:55296
  s_add_u32 s40, s19, 4096
  v_mfma_f32_16x16x32_bf16 v[100:103], v[164:167], a[132:135], v[100:103]
  ds_read_b64_tr_b16 v[160:161], v170 offset:49152
  v_mfma_f32_16x16x32_bf16 v[104:107], v[164:167], a[136:139], v[104:107]
  ds_read_b64_tr_b16 v[162:163], v170 offset:55296
  v_mfma_f32_16x16x32_bf16 v[108:111], v[164:167], a[140:143], v[108:111]
  buffer_load_dwordx4 v[192:195], v243, s[68:71], s40 offen sc1
  v_mfma_f32_16x16x32_bf16 v[112:115], v[144:147], a[128:131], v[112:115]
  ds_read_b64_tr_b16 v[164:165], v171 offset:49152
  v_mfma_f32_16x16x32_bf16 v[116:119], v[144:147], a[132:135], v[116:119]
  v_mfma_f32_16x16x32_bf16 v[120:123], v[144:147], a[136:139], v[120:123]
  ds_read_b64_tr_b16 v[166:167], v171 offset:55296
  buffer_load_dwordx4 v[196:199], v243, s[68:71], s40 offen offset:1024 sc1
  v_mfma_f32_16x16x32_bf16 v[124:127], v[144:147], a[140:143], v[124:127]
  v_mfma_f32_16x16x32_bf16 v[128:131], v[148:151], a[128:131], v[128:131]
  ds_read_b64_tr_b16 v[144:145], v168 offset:51200
  v_mfma_f32_16x16x32_bf16 v[132:135], v[148:151], a[132:135], v[132:135]
  buffer_load_dwordx4 v[248:251], v243, s[68:71], s40 offen offset:2048 sc1
  v_mfma_f32_16x16x32_bf16 v[136:139], v[148:151], a[136:139], v[136:139]
  ds_read_b64_tr_b16 v[146:147], v168 offset:57344
  v_mfma_f32_16x16x32_bf16 v[140:143], v[148:151], a[140:143], v[140:143]
  s_waitcnt lgkmcnt(8)
  v_mfma_f32_16x16x32_bf16 v[80:83], v[152:155], a[144:147], v[80:83]
  ds_read_b64_tr_b16 v[148:149], v169 offset:51200
  buffer_load_dwordx4 v[252:255], v243, s[68:71], s40 offen offset:3072 sc1
  v_mfma_f32_16x16x32_bf16 v[84:87], v[152:155], a[148:151], v[84:87]
  v_mfma_f32_16x16x32_bf16 v[88:91], v[152:155], a[152:155], v[88:91]
  ds_read_b64_tr_b16 v[150:151], v169 offset:57344
  v_mfma_f32_16x16x32_bf16 v[92:95], v[152:155], a[156:159], v[92:95]
  s_waitcnt lgkmcnt(8)
  v_mfma_f32_16x16x32_bf16 v[96:99], v[156:159], a[144:147], v[96:99]
  ds_read_b64_tr_b16 v[152:153], v170 offset:51200
  v_mfma_f32_16x16x32_bf16 v[100:103], v[156:159], a[148:151], v[100:103]
  v_mfma_f32_16x16x32_bf16 v[104:107], v[156:159], a[152:155], v[104:107]
  ds_read_b64_tr_b16 v[154:155], v170 offset:57344
  v_mfma_f32_16x16x32_bf16 v[108:111], v[156:159], a[156:159], v[108:111]
  s_waitcnt lgkmcnt(8)
  v_mfma_f32_16x16x32_bf16 v[112:115], v[160:163], a[144:147], v[112:115]
  ds_read_b64_tr_b16 v[156:157], v171 offset:51200
  v_mfma_f32_16x16x32_bf16 v[116:119], v[160:163], a[148:151], v[116:119]
  v_mfma_f32_16x16x32_bf16 v[120:123], v[160:163], a[152:155], v[120:123]
  ds_read_b64_tr_b16 v[158:159], v171 offset:57344
  v_mfma_f32_16x16x32_bf16 v[124:127], v[160:163], a[156:159], v[124:127]
  s_waitcnt lgkmcnt(8)
  v_mfma_f32_16x16x32_bf16 v[128:131], v[164:167], a[144:147], v[128:131]
  v_mfma_f32_16x16x32_bf16 v[132:135], v[164:167], a[148:151], v[132:135]
  v_mfma_f32_16x16x32_bf16 v[136:139], v[164:167], a[152:155], v[136:139]
  v_mfma_f32_16x16x32_bf16 v[140:143], v[164:167], a[156:159], v[140:143]
  s_waitcnt lgkmcnt(0)
  s_barrier
  v_mfma_f32_16x16x32_bf16 v[80:83], v[144:147], a[160:163], v[80:83]
  ds_read_b64_tr_b16 v[160:161], v210 offset:49152
  v_mfma_f32_16x16x32_bf16 v[84:87], v[144:147], a[164:167], v[84:87]
  v_mfma_f32_16x16x32_bf16 v[88:91], v[144:147], a[168:171], v[88:91]
  ds_read_b64_tr_b16 v[162:163], v210 offset:55296
  v_mfma_f32_16x16x32_bf16 v[92:95], v[144:147], a[172:175], v[92:95]
  ds_read_b64_tr_b16 v[164:165], v211 offset:49152
  v_mfma_f32_16x16x32_bf16 v[96:99], v[148:151], a[160:163], v[96:99]
  ds_read_b64_tr_b16 v[166:167], v211 offset:55296
  v_mfma_f32_16x16x32_bf16 v[100:103], v[148:151], a[164:167], v[100:103]
  ds_read_b64_tr_b16 v[144:145], v212 offset:49152
  v_mfma_f32_16x16x32_bf16 v[104:107], v[148:151], a[168:171], v[104:107]
  ds_read_b64_tr_b16 v[146:147], v212 offset:55296
  v_mfma_f32_16x16x32_bf16 v[108:111], v[148:151], a[172:175], v[108:111]
  v_mfma_f32_16x16x32_bf16 v[112:115], v[152:155], a[160:163], v[112:115]
  ds_read_b64_tr_b16 v[148:149], v213 offset:49152
  v_mfma_f32_16x16x32_bf16 v[116:119], v[152:155], a[164:167], v[116:119]
  v_mfma_f32_16x16x32_bf16 v[120:123], v[152:155], a[168:171], v[120:123]
  ds_read_b64_tr_b16 v[150:151], v213 offset:55296
  v_mfma_f32_16x16x32_bf16 v[124:127], v[152:155], a[172:175], v[124:127]
  v_mfma_f32_16x16x32_bf16 v[128:131], v[156:159], a[160:163], v[128:131]
  ds_read_b64_tr_b16 v[152:153], v210 offset:51200
  v_mfma_f32_16x16x32_bf16 v[132:135], v[156:159], a[164:167], v[132:135]
  v_mfma_f32_16x16x32_bf16 v[136:139], v[156:159], a[168:171], v[136:139]
  ds_read_b64_tr_b16 v[154:155], v210 offset:57344
  v_mfma_f32_16x16x32_bf16 v[140:143], v[156:159], a[172:175], v[140:143]
  s_waitcnt lgkmcnt(8)
  v_mfma_f32_16x16x32_bf16 v[16:19], v[160:163], a[0:3], 0
  ds_read_b64_tr_b16 v[156:157], v211 offset:51200
  v_mfma_f32_16x16x32_bf16 v[20:23], v[160:163], a[4:7], 0
  v_mfma_f32_16x16x32_bf16 v[24:27], v[160:163], a[8:11], 0
  ds_read_b64_tr_b16 v[158:159], v211 offset:57344
  v_mfma_f32_16x16x32_bf16 v[28:31], v[160:163], a[12:15], 0
  s_waitcnt lgkmcnt(8)
  v_mfma_f32_16x16x32_bf16 v[32:35], v[164:167], a[0:3], 0
  ds_read_b64_tr_b16 v[160:161], v212 offset:51200
  v_mfma_f32_16x16x32_bf16 v[36:39], v[164:167], a[4:7], 0
  v_mfma_f32_16x16x32_bf16 v[40:43], v[164:167], a[8:11], 0
  ds_read_b64_tr_b16 v[162:163], v212 offset:57344
  v_mfma_f32_16x16x32_bf16 v[44:47], v[164:167], a[12:15], 0
  s_waitcnt lgkmcnt(8)
  v_mfma_f32_16x16x32_bf16 v[48:51], v[144:147], a[0:3], 0
  ds_read_b64_tr_b16 v[164:165], v213 offset:51200
  v_mfma_f32_16x16x32_bf16 v[52:55], v[144:147], a[4:7], 0
  v_mfma_f32_16x16x32_bf16 v[56:59], v[144:147], a[8:11], 0
  ds_read_b64_tr_b16 v[166:167], v213 offset:57344
  v_mfma_f32_16x16x32_bf16 v[60:63], v[144:147], a[12:15], 0
  s_waitcnt lgkmcnt(8)
  v_mfma_f32_16x16x32_bf16 v[64:67], v[148:151], a[0:3], 0
  ds_read_b64_tr_b16 v[144:145], v210 offset:53248
  v_mfma_f32_16x16x32_bf16 v[68:71], v[148:151], a[4:7], 0
  v_mfma_f32_16x16x32_bf16 v[72:75], v[148:151], a[8:11], 0
  ds_read_b64_tr_b16 v[146:147], v210 offset:59392
  v_mfma_f32_16x16x32_bf16 v[76:79], v[148:151], a[12:15], 0
  s_waitcnt lgkmcnt(8)
  v_mfma_f32_16x16x32_bf16 v[16:19], v[152:155], a[16:19], v[16:19]
  ds_read_b64_tr_b16 v[148:149], v211 offset:53248
  v_mfma_f32_16x16x32_bf16 v[20:23], v[152:155], a[20:23], v[20:23]
  v_mfma_f32_16x16x32_bf16 v[24:27], v[152:155], a[24:27], v[24:27]
  ds_read_b64_tr_b16 v[150:151], v211 offset:59392
  v_mfma_f32_16x16x32_bf16 v[28:31], v[152:155], a[28:31], v[28:31]
  s_waitcnt lgkmcnt(8)
  v_mfma_f32_16x16x32_bf16 v[32:35], v[156:159], a[16:19], v[32:35]
  ds_read_b64_tr_b16 v[152:153], v212 offset:53248
  v_mov_b32 v11, 16
  v_mfma_f32_16x16x32_bf16 v[36:39], v[156:159], a[20:23], v[36:39]
  buffer_load_dwordx4 v[4:7], v11, s[68:71], s26 offen sc1
  v_mfma_f32_16x16x32_bf16 v[40:43], v[156:159], a[24:27], v[40:43]
  ds_read_b64_tr_b16 v[154:155], v212 offset:59392
  v_mfma_f32_16x16x32_bf16 v[44:47], v[156:159], a[28:31], v[44:47]
  s_waitcnt lgkmcnt(8)
  v_mfma_f32_16x16x32_bf16 v[48:51], v[160:163], a[16:19], v[48:51]
  ds_read_b64_tr_b16 v[156:157], v213 offset:53248
  v_mfma_f32_16x16x32_bf16 v[52:55], v[160:163], a[20:23], v[52:55]
  v_mfma_f32_16x16x32_bf16 v[56:59], v[160:163], a[24:27], v[56:59]
  ds_read_b64_tr_b16 v[158:159], v213 offset:59392
  v_mfma_f32_16x16x32_bf16 v[60:63], v[160:163], a[28:31], v[60:63]
  s_waitcnt lgkmcnt(8)
  v_mfma_f32_16x16x32_bf16 v[64:67], v[164:167], a[16:19], v[64:67]
  v_mfma_f32_16x16x32_bf16 v[68:71], v[164:167], a[20:23], v[68:71]
  v_mfma_f32_16x16x32_bf16 v[72:75], v[164:167], a[24:27], v[72:75]
  v_mfma_f32_16x16x32_bf16 v[76:79], v[164:167], a[28:31], v[76:79]
  s_waitcnt lgkmcnt(0)
  s_barrier
  v_mfma_f32_16x16x32_bf16 v[16:19], v[144:147], a[32:35], v[16:19]
  ds_read_b64_tr_b16 v[160:161], v168 offset:0
  v_mfma_f32_16x16x32_bf16 v[20:23], v[144:147], a[36:39], v[20:23]
  v_mfma_f32_16x16x32_bf16 v[24:27], v[144:147], a[40:43], v[24:27]
  ds_read_b64_tr_b16 v[162:163], v168 offset:6144
  v_mfma_f32_16x16x32_bf16 v[28:31], v[144:147], a[44:47], v[28:31]
  ds_read_b64_tr_b16 v[164:165], v169 offset:0
  v_mfma_f32_16x16x32_bf16 v[32:35], v[148:151], a[32:35], v[32:35]
  ds_read_b64_tr_b16 v[166:167], v169 offset:6144
  v_mfma_f32_16x16x32_bf16 v[36:39], v[148:151], a[36:39], v[36:39]
  ds_read_b64_tr_b16 v[144:145], v170 offset:0
  v_mfma_f32_16x16x32_bf16 v[40:43], v[148:151], a[40:43], v[40:43]
  ds_read_b64_tr_b16 v[146:147], v170 offset:6144
  v_mfma_f32_16x16x32_bf16 v[44:47], v[148:151], a[44:47], v[44:47]
  v_mfma_f32_16x16x32_bf16 v[48:51], v[152:155], a[32:35], v[48:51]
  ds_read_b64_tr_b16 v[148:149], v171 offset:0
  v_mfma_f32_16x16x32_bf16 v[52:55], v[152:155], a[36:39], v[52:55]
  v_mfma_f32_16x16x32_bf16 v[56:59], v[152:155], a[40:43], v[56:59]
  ds_read_b64_tr_b16 v[150:151], v171 offset:6144
  v_mfma_f32_16x16x32_bf16 v[60:63], v[152:155], a[44:47], v[60:63]
  v_mfma_f32_16x16x32_bf16 v[64:67], v[156:159], a[32:35], v[64:67]
  ds_read_b64_tr_b16 v[152:153], v168 offset:2048
  v_mfma_f32_16x16x32_bf16 v[68:71], v[156:159], a[36:39], v[68:71]
  v_mfma_f32_16x16x32_bf16 v[72:75], v[156:159], a[40:43], v[72:75]
  ds_read_b64_tr_b16 v[154:155], v168 offset:8192
  v_mfma_f32_16x16x32_bf16 v[76:79], v[156:159], a[44:47], v[76:79]
  s_waitcnt lgkmcnt(8)
  v_mfma_f32_16x16x32_bf16 v[16:19], v[160:163], a[48:51], v[16:19]
  ds_read_b64_tr_b16 v[156:157], v169 offset:2048
  v_mfma_f32_16x16x32_bf16 v[20:23], v[160:163], a[52:55], v[20:23]
  v_mfma_f32_16x16x32_bf16 v[24:27], v[160:163], a[56:59], v[24:27]
  ds_read_b64_tr_b16 v[158:159], v169 offset:8192
  s_waitcnt vmcnt(9)
  v_lshlrev_b32 v244, 16, v176
  v_mfma_f32_16x16x32_bf16 v[28:31], v[160:163], a[60:63], v[28:31]
  v_and_b32 v245, s43, v176
  v_add_f32 v80, v80, v244
  s_waitcnt lgkmcnt(8)
  v_mfma_f32_16x16x32_bf16 v[32:35], v[164:167], a[48:51], v[32:35]
  ds_read_b64_tr_b16 v[160:161], v170 offset:2048
  v_add_f32 v81, v81, v245
  v_mfma_f32_16x16x32_bf16 v[36:39], v[164:167], a[52:55], v[36:39]
  v_lshlrev_b32 v246, 16, v177
  v_and_b32 v247, s43, v177
  v_mfma_f32_16x16x32_bf16 v[40:43], v[164:167], a[56:59], v[40:43]
  ds_read_b64_tr_b16 v[162:163], v170 offset:8192
  v_add_f32 v82, v82, v246
  v_mfma_f32_16x16x32_bf16 v[44:47], v[164:167], a[60:63], v[44:47]
  v_add_f32 v83, v83, v247
  v_lshlrev_b32 v244, 16, v178
  s_waitcnt lgkmcnt(8)
  v_mfma_f32_16x16x32_bf16 v[48:51], v[144:147], a[48:51], v[48:51]
  ds_read_b64_tr_b16 v[164:165], v171 offset:2048
  v_and_b32 v245, s43, v178
  v_mfma_f32_16x16x32_bf16 v[52:55], v[144:147], a[52:55], v[52:55]
  v_add_f32 v96, v96, v244
  v_add_f32 v97, v97, v245
  v_mfma_f32_16x16x32_bf16 v[56:59], v[144:147], a[56:59], v[56:59]
  ds_read_b64_tr_b16 v[166:167], v171 offset:8192
  v_lshlrev_b32 v246, 16, v179
  v_mfma_f32_16x16x32_bf16 v[60:63], v[144:147], a[60:63], v[60:63]
  v_and_b32 v247, s43, v179
  v_add_f32 v98, v98, v246
  s_waitcnt lgkmcnt(8)
  v_mfma_f32_16x16x32_bf16 v[64:67], v[148:151], a[48:51], v[64:67]
  ds_read_b64_tr_b16 v[144:145], v168 offset:4096
  v_add_f32 v99, v99, v247
  v_mfma_f32_16x16x32_bf16 v[68:71], v[148:151], a[52:55], v[68:71]
  v_cvt_pk_bf16_f32 v80, v80, v81
  v_cvt_pk_bf16_f32 v81, v82, v83
  v_mfma_f32_16x16x32_bf16 v[72:75], v[148:151], a[56:59], v[72:75]
  ds_read_b64_tr_b16 v[146:147], v168 offset:10240
  v_cvt_pk_bf16_f32 v82, v96, v97
  v_mfma_f32_16x16x32_bf16 v[76:79], v[148:151], a[60:63], v[76:79]
  v_cvt_pk_bf16_f32 v83, v98, v99
  s_lshl_b32 s45, s30, 7
  s_add_u32 s45, s45, s17
  s_add_u32 s45, s45, 0
  s_waitcnt lgkmcnt(8)
  v_mfma_f32_16x16x32_bf16 v[16:19], v[152:155], a[64:67], v[16:19]
  ds_read_b64_tr_b16 v[148:149], v169 offset:4096
  v_mfma_f32_16x16x32_bf16 v[20:23], v[152:155], a[68:71], v[20:23]
  buffer_store_dwordx4 v[80:83], v243, s[68:71], s45 offen sc1
  v_mfma_f32_16x16x32_bf16 v[24:27], v[152:155], a[72:75], v[24:27]
  ds_read_b64_tr_b16 v[150:151], v169 offset:10240
  s_waitcnt vmcnt(9)
  v_lshlrev_b32 v244, 16, v180
  v_mfma_f32_16x16x32_bf16 v[28:31], v[152:155], a[76:79], v[28:31]
  v_and_b32 v245, s43, v180
  v_add_f32 v84, v84, v244
  s_waitcnt lgkmcnt(8)
  v_mfma_f32_16x16x32_bf16 v[32:35], v[156:159], a[64:67], v[32:35]
  ds_read_b64_tr_b16 v[152:153], v170 offset:4096
  v_add_f32 v85, v85, v245
  v_mfma_f32_16x16x32_bf16 v[36:39], v[156:159], a[68:71], v[36:39]
  v_lshlrev_b32 v246, 16, v181
  v_and_b32 v247, s43, v181
  v_mfma_f32_16x16x32_bf16 v[40:43], v[156:159], a[72:75], v[40:43]
  ds_read_b64_tr_b16 v[154:155], v170 offset:10240
  v_add_f32 v86, v86, v246
  v_mfma_f32_16x16x32_bf16 v[44:47], v[156:159], a[76:79], v[44:47]
  v_add_f32 v87, v87, v247
  v_lshlrev_b32 v244, 16, v182
  s_waitcnt lgkmcnt(8)
  v_mfma_f32_16x16x32_bf16 v[48:51], v[160:163], a[64:67], v[48:51]
  ds_read_b64_tr_b16 v[156:157], v171 offset:4096
  v_and_b32 v245, s43, v182
  v_mfma_f32_16x16x32_bf16 v[52:55], v[160:163], a[68:71], v[52:55]
  v_add_f32 v100, v100, v244
  v_add_f32 v101, v101, v245
  v_mfma_f32_16x16x32_bf16 v[56:59], v[160:163], a[72:75], v[56:59]
  ds_read_b64_tr_b16 v[158:159], v171 offset:10240
  v_lshlrev_b32 v246, 16, v183
  v_mfma_f32_16x16x32_bf16 v[60:63], v[160:163], a[76:79], v[60:63]
  v_and_b32 v247, s43, v183
  v_add_f32 v102, v102, v246
  s_waitcnt lgkmcnt(8)
  v_mfma_f32_16x16x32_bf16 v[64:67], v[164:167], a[64:67], v[64:67]
  v_add_f32 v103, v103, v247
  v_cvt_pk_bf16_f32 v84, v84, v85
  v_mfma_f32_16x16x32_bf16 v[68:71], v[164:167], a[68:71], v[68:71]
  v_cvt_pk_bf16_f32 v85, v86, v87
  v_cvt_pk_bf16_f32 v86, v100, v101
  v_mfma_f32_16x16x32_bf16 v[72:75], v[164:167], a[72:75], v[72:75]
  v_cvt_pk_bf16_f32 v87, v102, v103
  v_mfma_f32_16x16x32_bf16 v[76:79], v[164:167], a[76:79], v[76:79]
  buffer_store_dwordx4 v[84:87], v243, s[68:71], s45 offen offset:1024 sc1
  s_waitcnt vmcnt(2)
  v_and_b32 v4, v4, v5
  v_and_b32 v6, v6, v7
  v_and_b32 v4, v4, v6
  s_nop 0
  v_readfirstlane_b32 s36, v4
  s_nop 3
  s_cmp_eq_u32 s36, 1
  s_cbranch_scc1 K1_poll3_ok
K1_poll3_spin:
  s_sleep 1
  buffer_load_dwordx4 v[4:7], v11, s[68:71], s26 offen sc1
  s_waitcnt vmcnt(0)
  v_and_b32 v4, v4, v5
  v_and_b32 v6, v6, v7
  v_and_b32 v4, v4, v6
  s_nop 1
  v_readfirstlane_b32 s36, v4
  s_nop 3
  s_cmp_eq_u32 s36, 1
  s_cbranch_scc0 K1_poll3_spin
K1_poll3_ok:
  s_waitcnt lgkmcnt(0)
  s_barrier
  v_mfma_f32_16x16x32_bf16 v[16:19], v[144:147], a[80:83], v[16:19]
  ds_read_b64_tr_b16 v[160:161], v168 offset:24576
  v_lshlrev_b32 v244, 16, v184
  v_mfma_f32_16x16x32_bf16 v[20:23], v[144:147], a[84:87], v[20:23]
  s_add_u32 s40, s19, 32768
  v_and_b32 v245, s43, v184
  buffer_load_dwordx4 v[200:203], v243, s[68:71], s40 offen sc1
  v_mfma_f32_16x16x32_bf16 v[24:27], v[144:147], a[88:91], v[24:27]
  ds_read_b64_tr_b16 v[162:163], v168 offset:30720
  buffer_load_dwordx4 v[204:207], v243, s[68:71], s40 offen offset:1024 sc1
  v_mfma_f32_16x16x32_bf16 v[28:31], v[144:147], a[92:95], v[28:31]
  ds_read_b64_tr_b16 v[164:165], v169 offset:24576
  buffer_load_dwordx4 v[216:219], v243, s[68:71], s40 offen offset:2048 sc1
  v_mfma_f32_16x16x32_bf16 v[32:35], v[148:151], a[80:83], v[32:35]
  ds_read_b64_tr_b16 v[166:167], v169 offset:30720
  buffer_load_dwordx4 v[220:223], v243, s[68:71], s40 offen offset:3072 sc1
  s_add_u32 s40, s19, 36864
  v_mfma_f32_16x16x32_bf16 v[36:39], v[148:151], a[84:87], v[36:39]
  ds_read_b64_tr_b16 v[144:145], v170 offset:24576
  v_add_f32 v88, v88, v244
  v_mfma_f32_16x16x32_bf16 v[40:43], v[148:151], a[88:91], v[40:43]
  ds_read_b64_tr_b16 v[146:147], v170 offset:30720
  v_add_f32 v89, v89, v245
  v_mfma_f32_16x16x32_bf16 v[44:47], v[148:151], a[92:95], v[44:47]
  buffer_load_dwordx4 v[232:235], v243, s[68:71], s40 offen sc1
  v_lshlrev_b32 v246, 16, v185
  v_mfma_f32_16x16x32_bf16 v[48:51], v[152:155], a[80:83], v[48:51]
  ds_read_b64_tr_b16 v[148:149], v171 offset:24576
  v_and_b32 v247, s43, v185
  v_mfma_f32_16x16x32_bf16 v[52:55], v[152:155], a[84:87], v[52:55]
  v_add_f32 v90, v90, v246
  v_add_f32 v91, v91, v247
  v_mfma_f32_16x16x32_bf16 v[56:59], v[152:155], a[88:91], v[56:59]
  ds_read_b64_tr_b16 v[150:151], v171 offset:30720
  buffer_load_dwordx4 v[236:239], v243, s[68:71], s40 offen offset:1024 sc1
  v_mfma_f32_16x16x32_bf16 v[60:63], v[152:155], a[92:95], v[60:63]
  v_lshlrev_b32 v244, 16, v186
  v_and_b32 v245, s43, v186
  v_mfma_f32_16x16x32_bf16 v[64:67], v[156:159], a[80:83], v[64:67]
  ds_read_b64_tr_b16 v[152:153], v168 offset:26624
  v_add_f32 v104, v104, v244
  v_mfma_f32_16x16x32_bf16 v[68:71], v[156:159], a[84:87], v[68:71]
  buffer_load_dwordx4 v[8:11], v243, s[68:71], s40 offen offset:2048 sc1
  v_add_f32 v105, v105, v245
  v_mfma_f32_16x16x32_bf16 v[72:75], v[156:159], a[88:91], v[72:75]
  ds_read_b64_tr_b16 v[154:155], v168 offset:32768
  v_lshlrev_b32 v246, 16, v187
  v_mfma_f32_16x16x32_bf16 v[76:79], v[156:159], a[92:95], v[76:79]
  v_and_b32 v247, s43, v187
  v_add_f32 v106, v106, v246
  s_waitcnt lgkmcnt(8)
  v_mfma_f32_16x16x32_bf16 v[16:19], v[160:163], a[96:99], v[16:19]
  ds_read_b64_tr_b16 v[156:157], v169 offset:26624
  buffer_load_dwordx4 v[12:15], v243, s[68:71], s40 offen offset:3072 sc1
  v_mfma_f32_16x16x32_bf16 v[20:23], v[160:163], a[100:103], v[20:23]
  v_add_f32 v107, v107, v247
  v_cvt_pk_bf16_f32 v88, v88, v89
  v_mfma_f32_16x16x32_bf16 v[24:27], v[160:163], a[104:107], v[24:27]
  ds_read_b64_tr_b16 v[158:159], v169 offset:32768
  v_cvt_pk_bf16_f32 v89, v90, v91
  v_mfma_f32_16x16x32_bf16 v[28:31], v[160:163], a[108:111], v[28:31]
  v_cvt_pk_bf16_f32 v90, v104, v105
  v_cvt_pk_bf16_f32 v91, v106, v107
  s_waitcnt lgkmcnt(8)
  v_mfma_f32_16x16x32_bf16 v[32:35], v[164:167], a[96:99], v[32:35]
  ds_read_b64_tr_b16 v[160:161], v170 offset:26624
  buffer_store_dwordx4 v[88:91], v243, s[68:71], s45 offen offset:2048 sc1
  v_mfma_f32_16x16x32_bf16 v[36:39], v[164:167], a[100:103], v[36:39]
  v_lshlrev_b32 v244, 16, v188
  v_and_b32 v245, s43, v188
  v_mfma_f32_16x16x32_bf16 v[40:43], v[164:167], a[104:107], v[40:43]
  ds_read_b64_tr_b16 v[162:163], v170 offset:32768
  v_add_f32 v92, v92, v244
  v_mfma_f32_16x16x32_bf16 v[44:47], v[164:167], a[108:111], v[44:47]
  v_add_f32 v93, v93, v245
  v_lshlrev_b32 v246, 16, v189
  s_waitcnt lgkmcnt(8)
  v_mfma_f32_16x16x32_bf16 v[48:51], v[144:147], a[96:99], v[48:51]
  ds_read_b64_tr_b16 v[164:165], v171 offset:26624
  v_and_b32 v247, s43, v189
  v_mfma_f32_16x16x32_bf16 v[52:55], v[144:147], a[100:103], v[52:55]
  v_add_f32 v94, v94, v246
  v_add_f32 v95, v95, v247
  v_mfma_f32_16x16x32_bf16 v[56:59], v[144:147], a[104:107], v[56:59]
  ds_read_b64_tr_b16 v[166:167], v171 offset:32768
  v_lshlrev_b32 v244, 16, v190
  v_mfma_f32_16x16x32_bf16 v[60:63], v[144:147], a[108:111], v[60:63]
  v_and_b32 v245, s43, v190
  v_add_f32 v108, v108, v244
  s_waitcnt lgkmcnt(8)
  v_mfma_f32_16x16x32_bf16 v[64:67], v[148:151], a[96:99], v[64:67]
  ds_read_b64_tr_b16 v[144:145], v168 offset:28672
  v_add_f32 v109, v109, v245
  v_mfma_f32_16x16x32_bf16 v[68:71], v[148:151], a[100:103], v[68:71]
  v_lshlrev_b32 v246, 16, v191
  v_and_b32 v247, s43, v191
  v_mfma_f32_16x16x32_bf16 v[72:75], v[148:151], a[104:107], v[72:75]
  ds_read_b64_tr_b16 v[146:147], v168 offset:34816
  v_add_f32 v110, v110, v246
  v_mfma_f32_16x16x32_bf16 v[76:79], v[148:151], a[108:111], v[76:79]
  v_add_f32 v111, v111, v247
  v_cvt_pk_bf16_f32 v92, v92, v93
  s_waitcnt lgkmcnt(8)
  v_mfma_f32_16x16x32_bf16 v[16:19], v[152:155], a[112:115], v[16:19]
  ds_read_b64_tr_b16 v[148:149], v169 offset:28672
  v_cvt_pk_bf16_f32 v93, v94, v95
  v_mfma_f32_16x16x32_bf16 v[20:23], v[152:155], a[116:119], v[20:23]
  v_cvt_pk_bf16_f32 v94, v108, v109
  v_cvt_pk_bf16_f32 v95, v110, v111
  v_mfma_f32_16x16x32_bf16 v[24:27], v[152:155], a[120:123], v[24:27]
  ds_read_b64_tr_b16 v[150:151], v169 offset:34816
  v_mfma_f32_16x16x32_bf16 v[28:31], v[152:155], a[124:127], v[28:31]
  buffer_store_dwordx4 v[92:95], v243, s[68:71], s45 offen offset:3072 sc1
  s_waitcnt lgkmcnt(8)
  v_mfma_f32_16x16x32_bf16 v[32:35], v[156:159], a[112:115], v[32:35]
  ds_read_b64_tr_b16 v[152:153], v170 offset:28672
  v_lshlrev_b32 v244, 16, v192
  v_mfma_f32_16x16x32_bf16 v[36:39], v[156:159], a[116:119], v[36:39]
  v_and_b32 v245, s43, v192
  v_add_f32 v112, v112, v244
  v_mfma_f32_16x16x32_bf16 v[40:43], v[156:159], a[120:123], v[40:43]
  ds_read_b64_tr_b16 v[154:155], v170 offset:34816
  v_add_f32 v113, v113, v245
  v_mfma_f32_16x16x32_bf16 v[44:47], v[156:159], a[124:127], v[44:47]
  v_lshlrev_b32 v246, 16, v193
  v_and_b32 v247, s43, v193
  s_waitcnt lgkmcnt(8)
  v_mfma_f32_16x16x32_bf16 v[48:51], v[160:163], a[112:115], v[48:51]
  ds_read_b64_tr_b16 v[156:157], v171 offset:28672
  v_add_f32 v114, v114, v246
  v_mfma_f32_16x16x32_bf16 v[52:55], v[160:163], a[116:119], v[52:55]
  v_add_f32 v115, v115, v247
  v_lshlrev_b32 v244, 16, v194
  v_mfma_f32_16x16x32_bf16 v[56:59], v[160:163], a[120:123], v[56:59]
  ds_read_b64_tr_b16 v[158:159], v171 offset:34816
  v_and_b32 v245, s43, v194
  v_mfma_f32_16x16x32_bf16 v[60:63], v[160:163], a[124:127], v[60:63]
  v_add_f32 v128, v128, v244
  v_add_f32 v129, v129, v245
  s_waitcnt lgkmcnt(8)
  v_mfma_f32_16x16x32_bf16 v[64:67], v[164:167], a[112:115], v[64:67]
  v_lshlrev_b32 v246, 16, v195
  v_and_b32 v247, s43, v195
  v_mfma_f32_16x16x32_bf16 v[68:71], v[164:167], a[116:119], v[68:71]
  v_add_f32 v130, v130, v246
  v_add_f32 v131, v131, v247
  v_mfma_f32_16x16x32_bf16 v[72:75], v[164:167], a[120:123], v[72:75]
  v_cvt_pk_bf16_f32 v112, v112, v113
  v_cvt_pk_bf16_f32 v113, v114, v115
  v_mfma_f32_16x16x32_bf16 v[76:79], v[164:167], a[124:127], v[76:79]
  v_cvt_pk_bf16_f32 v114, v128, v129
  v_cvt_pk_bf16_f32 v115, v130, v131
  s_lshl_b32 s45, s30, 7
  s_add_u32 s45, s45, s17
  s_add_u32 s45, s45, 4096
  s_waitcnt lgkmcnt(0)
  s_barrier
  v_mfma_f32_16x16x32_bf16 v[16:19], v[144:147], a[128:131], v[16:19]
  ds_read_b64_tr_b16 v[160:161], v210 offset:0
  v_mfma_f32_16x16x32_bf16 v[20:23], v[144:147], a[132:135], v[20:23]
  buffer_store_dwordx4 v[112:115], v243, s[68:71], s45 offen sc1
  v_mfma_f32_16x16x32_bf16 v[24:27], v[144:147], a[136:139], v[24:27]
  ds_read_b64_tr_b16 v[162:163], v210 offset:6144
  v_lshlrev_b32 v244, 16, v196
  v_mfma_f32_16x16x32_bf16 v[28:31], v[144:147], a[140:143], v[28:31]
  ds_read_b64_tr_b16 v[164:165], v211 offset:0
  v_and_b32 v245, s43, v196
  v_mfma_f32_16x16x32_bf16 v[32:35], v[148:151], a[128:131], v[32:35]
  ds_read_b64_tr_b16 v[166:167], v211 offset:6144
  v_add_f32 v116, v116, v244
  v_mfma_f32_16x16x32_bf16 v[36:39], v[148:151], a[132:135], v[36:39]
  ds_read_b64_tr_b16 v[144:145], v212 offset:0
  v_add_f32 v117, v117, v245
  v_mfma_f32_16x16x32_bf16 v[40:43], v[148:151], a[136:139], v[40:43]
  ds_read_b64_tr_b16 v[146:147], v212 offset:6144
  v_lshlrev_b32 v246, 16, v197
  v_mfma_f32_16x16x32_bf16 v[44:47], v[148:151], a[140:143], v[44:47]
  v_and_b32 v247, s43, v197
  v_add_f32 v118, v118, v246
  v_mfma_f32_16x16x32_bf16 v[48:51], v[152:155], a[128:131], v[48:51]
  ds_read_b64_tr_b16 v[148:149], v213 offset:0
  v_add_f32 v119, v119, v247
  v_mfma_f32_16x16x32_bf16 v[52:55], v[152:155], a[132:135], v[52:55]
  v_lshlrev_b32 v244, 16, v198
  v_and_b32 v245, s43, v198
  v_mfma_f32_16x16x32_bf16 v[56:59], v[152:155], a[136:139], v[56:59]
  ds_read_b64_tr_b16 v[150:151], v213 offset:6144
  v_add_f32 v132, v132, v244
  v_mfma_f32_16x16x32_bf16 v[60:63], v[152:155], a[140:143], v[60:63]
  v_add_f32 v133, v133, v245
  v_lshlrev_b32 v246, 16, v199
  v_mfma_f32_16x16x32_bf16 v[64:67], v[156:159], a[128:131], v[64:67]
  ds_read_b64_tr_b16 v[152:153], v210 offset:2048
  v_and_b32 v247, s43, v199
  v_mfma_f32_16x16x32_bf16 v[68:71], v[156:159], a[132:135], v[68:71]
  v_add_f32 v134, v134, v246
  v_add_f32 v135, v135, v247
  v_mfma_f32_16x16x32_bf16 v[72:75], v[156:159], a[136:139], v[72:75]
  ds_read_b64_tr_b16 v[154:155], v210 offset:8192
  v_cvt_pk_bf16_f32 v116, v116, v117
  v_mfma_f32_16x16x32_bf16 v[76:79], v[156:159], a[140:143], v[76:79]
  v_cvt_pk_bf16_f32 v117, v118, v119
  v_cvt_pk_bf16_f32 v118, v132, v133
  s_waitcnt lgkmcnt(8)
  v_mfma_f32_16x16x32_bf16 v[16:19], v[160:163], a[144:147], v[16:19]
  ds_read_b64_tr_b16 v[156:157], v211 offset:2048
  v_cvt_pk_bf16_f32 v119, v134, v135
  v_mfma_f32_16x16x32_bf16 v[20:23], v[160:163], a[148:151], v[20:23]
  buffer_store_dwordx4 v[116:119], v243, s[68:71], s45 offen offset:1024 sc1
  v_mfma_f32_16x16x32_bf16 v[24:27], v[160:163], a[152:155], v[24:27]
  ds_read_b64_tr_b16 v[158:159], v211 offset:8192
  v_lshlrev_b32 v244, 16, v248
  v_mfma_f32_16x16x32_bf16 v[28:31], v[160:163], a[156:159], v[28:31]
  v_and_b32 v245, s43, v248
  v_add_f32 v120, v120, v244
  s_waitcnt lgkmcnt(8)
  v_mfma_f32_16x16x32_bf16 v[32:35], v[164:167], a[144:147], v[32:35]
  ds_read_b64_tr_b16 v[160:161], v212 offset:2048
  v_add_f32 v121, v121, v245
  v_mfma_f32_16x16x32_bf16 v[36:39], v[164:167], a[148:151], v[36:39]
  v_lshlrev_b32 v246, 16, v249
  v_and_b32 v247, s43, v249
  v_mfma_f32_16x16x32_bf16 v[40:43], v[164:167], a[152:155], v[40:43]
  ds_read_b64_tr_b16 v[162:163], v212 offset:8192
  v_add_f32 v122, v122, v246
  v_mfma_f32_16x16x32_bf16 v[44:47], v[164:167], a[156:159], v[44:47]
  v_add_f32 v123, v123, v247
  v_lshlrev_b32 v244, 16, v250
  s_waitcnt lgkmcnt(8)
  v_mfma_f32_16x16x32_bf16 v[48:51], v[144:147], a[144:147], v[48:51]
  ds_read_b64_tr_b16 v[164:165], v213 offset:2048
  v_and_b32 v245, s43, v250
  v_mfma_f32_16x16x32_bf16 v[52:55], v[144:147], a[148:151], v[52:55]
  v_add_f32 v136, v136, v244
  v_add_f32 v137, v137, v245
  v_mfma_f32_16x16x32_bf16 v[56:59], v[144:147], a[152:155], v[56:59]
  ds_read_b64_tr_b16 v[166:167], v213 offset:8192
  v_lshlrev_b32 v246, 16, v251
  v_mfma_f32_16x16x32_bf16 v[60:63], v[144:147], a[156:159], v[60:63]
  v_and_b32 v247, s43, v251
  v_add_f32 v138, v138, v246
  s_waitcnt lgkmcnt(8)
  v_mfma_f32_16x16x32_bf16 v[64:67], v[148:151], a[144:147], v[64:67]
  v_add_f32 v139, v139, v247
  v_cvt_pk_bf16_f32 v120, v120, v121
  v_mfma_f32_16x16x32_bf16 v[68:71], v[148:151], a[148:151], v[68:71]
  v_cvt_pk_bf16_f32 v121, v122, v123
  v_cvt_pk_bf16_f32 v122, v136, v137
  v_mfma_f32_16x16x32_bf16 v[72:75], v[148:151], a[152:155], v[72:75]
  v_cvt_pk_bf16_f32 v123, v138, v139
  v_mfma_f32_16x16x32_bf16 v[76:79], v[148:151], a[156:159], v[76:79]
  buffer_store_dwordx4 v[120:123], v243, s[68:71], s45 offen offset:2048 sc1
  s_waitcnt lgkmcnt(6)
  v_mfma_f32_16x16x32_bf16 v[16:19], v[152:155], a[160:163], v[16:19]
  v_lshlrev_b32 v244, 16, v252
  v_and_b32 v245, s43, v252
  v_mfma_f32_16x16x32_bf16 v[20:23], v[152:155], a[164:167], v[20:23]
  v_add_f32 v124, v124, v244
  v_add_f32 v125, v125, v245
  v_mfma_f32_16x16x32_bf16 v[24:27], v[152:155], a[168:171], v[24:27]
  v_lshlrev_b32 v246, 16, v253
  v_and_b32 v247, s43, v253
  v_mfma_f32_16x16x32_bf16 v[28:31], v[152:155], a[172:175], v[28:31]
  v_add_f32 v126, v126, v246
  v_add_f32 v127, v127, v247
  s_waitcnt lgkmcnt(4)
  v_mfma_f32_16x16x32_bf16 v[32:35], v[156:159], a[160:163], v[32:35]
  v_lshlrev_b32 v244, 16, v254
  v_and_b32 v245, s43, v254
  v_mfma_f32_16x16x32_bf16 v[36:39], v[156:159], a[164:167], v[36:39]
  v_add_f32 v140, v140, v244
  v_add_f32 v141, v141, v245
  v_mfma_f32_16x16x32_bf16 v[40:43], v[156:159], a[168:171], v[40:43]
  v_lshlrev_b32 v246, 16, v255
  v_mfma_f32_16x16x32_bf16 v[44:47], v[156:159], a[172:175], v[44:47]
  v_and_b32 v247, s43, v255
  s_waitcnt lgkmcnt(2)
  v_mfma_f32_16x16x32_bf16 v[48:51], v[160:163], a[160:163], v[48:51]
  v_add_f32 v142, v142, v246
  v_add_f32 v143, v143, v247
  v_mfma_f32_16x16x32_bf16 v[52:55], v[160:163], a[164:167], v[52:55]
  v_cvt_pk_bf16_f32 v124, v124, v125
  v_mfma_f32_16x16x32_bf16 v[56:59], v[160:163], a[168:171], v[56:59]
  v_cvt_pk_bf16_f32 v125, v126, v127
  v_cvt_pk_bf16_f32 v126, v140, v141
  v_mfma_f32_16x16x32_bf16 v[60:63], v[160:163], a[172:175], v[60:63]
  v_cvt_pk_bf16_f32 v127, v142, v143
  s_waitcnt lgkmcnt(0)
  v_mfma_f32_16x16x32_bf16 v[64:67], v[164:167], a[160:163], v[64:67]
  buffer_store_dwordx4 v[124:127], v243, s[68:71], s45 offen offset:3072 sc1
  v_mfma_f32_16x16x32_bf16 v[68:71], v[164:167], a[164:167], v[68:71]
  v_mfma_f32_16x16x32_bf16 v[72:75], v[164:167], a[168:171], v[72:75]
  v_mfma_f32_16x16x32_bf16 v[76:79], v[164:167], a[172:175], v[76:79]
  s_waitcnt vmcnt(13)
  v_lshlrev_b32 v244, 16, v200
  v_and_b32 v245, s43, v200
  v_add_f32 v16, v16, v244
  v_add_f32 v17, v17, v245
  v_lshlrev_b32 v246, 16, v201
  v_and_b32 v247, s43, v201
  v_add_f32 v18, v18, v246
  v_add_f32 v19, v19, v247
  v_lshlrev_b32 v244, 16, v202
  v_and_b32 v245, s43, v202
  v_add_f32 v32, v32, v244
  v_add_f32 v33, v33, v245
  v_lshlrev_b32 v246, 16, v203
  v_and_b32 v247, s43, v203
  v_add_f32 v34, v34, v246
  v_add_f32 v35, v35, v247
  v_cvt_pk_bf16_f32 v16, v16, v17
  v_cvt_pk_bf16_f32 v17, v18, v19
  v_cvt_pk_bf16_f32 v18, v32, v33
  v_cvt_pk_bf16_f32 v19, v34, v35
  s_lshl_b32 s45, s31, 7
  s_add_u32 s45, s45, s17
  s_add_u32 s45, s45, 0
  buffer_store_dwordx4 v[16:19], v243, s[68:71], s45 offen sc1
  s_waitcnt vmcnt(13)
  v_lshlrev_b32 v244, 16, v204
  v_and_b32 v245, s43, v204
  v_add_f32 v20, v20, v244
  v_add_f32 v21, v21, v245
  v_lshlrev_b32 v246, 16, v205
  v_and_b32 v247, s43, v205
  v_add_f32 v22, v22, v246
  v_add_f32 v23, v23, v247
  v_lshlrev_b32 v244, 16, v206
  v_and_b32 v245, s43, v206
  v_add_f32 v36, v36, v244
  v_add_f32 v37, v37, v245
  v_lshlrev_b32 v246, 16, v207
  v_and_b32 v247, s43, v207
  v_add_f32 v38, v38, v246
  v_add_f32 v39, v39, v247
  v_cvt_pk_bf16_f32 v20, v20, v21
  v_cvt_pk_bf16_f32 v21, v22, v23
  v_cvt_pk_bf16_f32 v22, v36, v37
  v_cvt_pk_bf16_f32 v23, v38, v39
  buffer_store_dwordx4 v[20:23], v243, s[68:71], s45 offen offset:1024 sc1
  s_waitcnt vmcnt(13)
  v_lshlrev_b32 v244, 16, v216
  v_and_b32 v245, s43, v216
  v_add_f32 v24, v24, v244
  v_add_f32 v25, v25, v245
  v_lshlrev_b32 v246, 16, v217
  v_and_b32 v247, s43, v217
  v_add_f32 v26, v26, v246
  v_add_f32 v27, v27, v247
  v_lshlrev_b32 v244, 16, v218
  v_and_b32 v245, s43, v218
  v_add_f32 v40, v40, v244
  v_add_f32 v41, v41, v245
  v_lshlrev_b32 v246, 16, v219
  v_and_b32 v247, s43, v219
  v_add_f32 v42, v42, v246
  v_add_f32 v43, v43, v247
  v_cvt_pk_bf16_f32 v24, v24, v25
  v_cvt_pk_bf16_f32 v25, v26, v27
  v_cvt_pk_bf16_f32 v26, v40, v41
  v_cvt_pk_bf16_f32 v27, v42, v43
  buffer_store_dwordx4 v[24:27], v243, s[68:71], s45 offen offset:2048 sc1
  s_waitcnt vmcnt(13)
  v_lshlrev_b32 v244, 16, v220
  v_and_b32 v245, s43, v220
  v_add_f32 v28, v28, v244
  v_add_f32 v29, v29, v245
  v_lshlrev_b32 v246, 16, v221
  v_and_b32 v247, s43, v221
  v_add_f32 v30, v30, v246
  v_add_f32 v31, v31, v247
  v_lshlrev_b32 v244, 16, v222
  v_and_b32 v245, s43, v222
  v_add_f32 v44, v44, v244
  v_add_f32 v45, v45, v245
  v_lshlrev_b32 v246, 16, v223
  v_and_b32 v247, s43, v223
  v_add_f32 v46, v46, v246
  v_add_f32 v47, v47, v247
  v_cvt_pk_bf16_f32 v28, v28, v29
  v_cvt_pk_bf16_f32 v29, v30, v31
  v_cvt_pk_bf16_f32 v30, v44, v45
  v_cvt_pk_bf16_f32 v31, v46, v47
  buffer_store_dwordx4 v[28:31], v243, s[68:71], s45 offen offset:3072 sc1
  s_waitcnt vmcnt(13)
  v_lshlrev_b32 v244, 16, v232
  v_and_b32 v245, s43, v232
  v_add_f32 v48, v48, v244
  v_add_f32 v49, v49, v245
  v_lshlrev_b32 v246, 16, v233
  v_and_b32 v247, s43, v233
  v_add_f32 v50, v50, v246
  v_add_f32 v51, v51, v247
  v_lshlrev_b32 v244, 16, v234
  v_and_b32 v245, s43, v234
  v_add_f32 v64, v64, v244
  v_add_f32 v65, v65, v245
  v_lshlrev_b32 v246, 16, v235
  v_and_b32 v247, s43, v235
  v_add_f32 v66, v66, v246
  v_add_f32 v67, v67, v247
  v_cvt_pk_bf16_f32 v48, v48, v49
  v_cvt_pk_bf16_f32 v49, v50, v51
  v_cvt_pk_bf16_f32 v50, v64, v65
  v_cvt_pk_bf16_f32 v51, v66, v67
  s_lshl_b32 s45, s31, 7
  s_add_u32 s45, s45, s17
  s_add_u32 s45, s45, 4096
  buffer_store_dwordx4 v[48:51], v243, s[68:71], s45 offen sc1
  s_waitcnt vmcnt(13)
  v_lshlrev_b32 v244, 16, v236
  v_and_b32 v245, s43, v236
  v_add_f32 v52, v52, v244
  v_add_f32 v53, v53, v245
  v_lshlrev_b32 v246, 16, v237
  v_and_b32 v247, s43, v237
  v_add_f32 v54, v54, v246
  v_add_f32 v55, v55, v247
  v_lshlrev_b32 v244, 16, v238
  v_and_b32 v245, s43, v238
  v_add_f32 v68, v68, v244
  v_add_f32 v69, v69, v245
  v_lshlrev_b32 v246, 16, v239
  v_and_b32 v247, s43, v239
  v_add_f32 v70, v70, v246
  v_add_f32 v71, v71, v247
  v_cvt_pk_bf16_f32 v52, v52, v53
  v_cvt_pk_bf16_f32 v53, v54, v55
  v_cvt_pk_bf16_f32 v54, v68, v69
  v_cvt_pk_bf16_f32 v55, v70, v71
  buffer_store_dwordx4 v[52:55], v243, s[68:71], s45 offen offset:1024 sc1
  s_waitcnt vmcnt(13)
  v_lshlrev_b32 v244, 16, v8
  v_and_b32 v245, s43, v8
  v_add_f32 v56, v56, v244
  v_add_f32 v57, v57, v245
  v_lshlrev_b32 v246, 16, v9
  v_and_b32 v247, s43, v9
  v_add_f32 v58, v58, v246
  v_add_f32 v59, v59, v247
  v_lshlrev_b32 v244, 16, v10
  v_and_b32 v245, s43, v10
  v_add_f32 v72, v72, v244
  v_add_f32 v73, v73, v245
  v_lshlrev_b32 v246, 16, v11
  v_and_b32 v247, s43, v11
  v_add_f32 v74, v74, v246
  v_add_f32 v75, v75, v247
  v_cvt_pk_bf16_f32 v56, v56, v57
  v_cvt_pk_bf16_f32 v57, v58, v59
  v_cvt_pk_bf16_f32 v58, v72, v73
  v_cvt_pk_bf16_f32 v59, v74, v75
  buffer_store_dwordx4 v[56:59], v243, s[68:71], s45 offen offset:2048 sc1
  s_waitcnt vmcnt(13)
  v_lshlrev_b32 v244, 16, v12
  v_and_b32 v245, s43, v12
  v_add_f32 v60, v60, v244
  v_add_f32 v61, v61, v245
  v_lshlrev_b32 v246, 16, v13
  v_and_b32 v247, s43, v13
  v_add_f32 v62, v62, v246
  v_add_f32 v63, v63, v247
  v_lshlrev_b32 v244, 16, v14
  v_and_b32 v245, s43, v14
  v_add_f32 v76, v76, v244
  v_add_f32 v77, v77, v245
  v_lshlrev_b32 v246, 16, v15
  v_and_b32 v247, s43, v15
  v_add_f32 v78, v78, v246
  v_add_f32 v79, v79, v247
  v_cvt_pk_bf16_f32 v60, v60, v61
  v_cvt_pk_bf16_f32 v61, v62, v63
  v_cvt_pk_bf16_f32 v62, v76, v77
  v_cvt_pk_bf16_f32 v63, v78, v79
  buffer_store_dwordx4 v[60:63], v243, s[68:71], s45 offen offset:3072 sc1
K1_end:
  s_endpgm
.globl k2_reduce_kernel
.p2align 8
.type k2_reduce_kernel,@function
k2_reduce_kernel:
  s_cmp_ge_u32 s2, 576
  s_cbranch_scc1 K2_end
  s_load_dwordx2 s[4:5], s[0:1], 0
  s_load_dwordx2 s[6:7], s[0:1], 72
  s_load_dwordx2 s[16:17], s[0:1], 56
  v_and_b32 v1, 63, v0
  v_lshrrev_b32 v2, 6, v0
  v_and_b32 v3, 15, v1
  v_lshrrev_b32 v4, 4, v1
  v_readfirstlane_b32 s20, v2
  v_lshlrev_b32 v5, 4, v1
  s_waitcnt lgkmcnt(0)
  s_mov_b32 s8, s4
  s_and_b32 s9, s5, 0xffff
  s_mov_b32 s10, 2359296
  s_mov_b32 s11, 0x20000
  s_add_u32 s6, s6, 6291456
  s_addc_u32 s7, s7, 0
  s_mov_b32 s12, s6
  s_and_b32 s13, s7, 0xffff
  s_mov_b32 s14, 37781504
  s_mov_b32 s15, 0x20000
  s_mov_b32 s24, s16
  s_and_b32 s25, s17, 0xffff
  s_mov_b32 s26, 2359296
  s_mov_b32 s27, 0x20000
  s_mul_i32 s21, s2, 4
  s_add_u32 s21, s21, s20
  s_mul_hi_u32 s22, s21, 29826162
  s_mul_i32 s23, s22, 144
  s_sub_u32 s23, s21, s23
  s_cmp_ge_u32 s23, 128
  s_cbranch_scc1 K2_half
  s_lshl_b32 s28, s22, 17
  s_lshl_b32 s29, s23, 10
  s_add_u32 s28, s28, s29
  buffer_load_dwordx4 v[16:19], v5, s[12:15], s28 offen
  s_add_u32 s28, s28, 2097152
  buffer_load_dwordx4 v[20:23], v5, s[12:15], s28 offen
  s_add_u32 s28, s28, 2097152
  buffer_load_dwordx4 v[24:27], v5, s[12:15], s28 offen
  s_add_u32 s28, s28, 2097152
  buffer_load_dwordx4 v[28:31], v5, s[12:15], s28 offen
  s_add_u32 s28, s28, 2097152
  buffer_load_dwordx4 v[32:35], v5, s[12:15], s28 offen
  s_add_u32 s28, s28, 2097152
  buffer_load_dwordx4 v[36:39], v5, s[12:15], s28 offen
  s_add_u32 s28, s28, 2097152
  buffer_load_dwordx4 v[40:43], v5, s[12:15], s28 offen
  s_add_u32 s28, s28, 2097152
  buffer_load_dwordx4 v[44:47], v5, s[12:15], s28 offen
  s_and_b32 s29, s23, 3
  s_lshr_b32 s31, s23, 3
  s_and_b32 s31, s31, 3
  s_lshr_b32 s34, s31, 1
  s_lshr_b32 s35, s23, 5
  s_lshl_b32 s35, s35, 7
  s_lshl_b32 s36, s34, 6
  s_add_u32 s35, s35, s36
  s_lshr_b32 s36, s23, 2
  s_and_b32 s36, s36, 1
  s_lshl_b32 s36, s36, 5
  s_add_u32 s35, s35, s36
  s_and_b32 s33, s31, 1
  s_lshl_b32 s37, s22, 7
  s_lshl_b32 s38, s33, 6
  s_add_u32 s37, s37, s38
  s_lshl_b32 s38, s29, 4
  s_add_u32 s37, s37, s38
  v_add_u32 v6, s37, v3
  v_mul_u32_u24 v6, 1152, v6
  s_lshl_b32 s40, s35, 1
  v_add_u32 v6, s40, v6
  v_lshlrev_b32 v7, 3, v4
  v_add_u32 v7, v6, v7
  buffer_load_dwordx2 v[8:9], v7, s[8:11], 0 offen
  buffer_load_dwordx2 v[10:11], v7, s[8:11], 0 offen offset:32
  v_and_b32 v12, 1, v4
  v_lshlrev_b32 v12, 5, v12
  v_lshrrev_b32 v13, 1, v4
  v_lshlrev_b32 v13, 4, v13
  v_add3_u32 v6, v6, v12, v13
  s_mov_b32 s41, 0xffff0000
  s_waitcnt vmcnt(9)
  v_lshlrev_b32 v80, 16, v16
  v_and_b32 v81, s41, v16
  v_lshlrev_b32 v82, 16, v17
  v_and_b32 v83, s41, v17
  v_lshlrev_b32 v84, 16, v18
  v_and_b32 v85, s41, v18
  v_lshlrev_b32 v86, 16, v19
  v_and_b32 v87, s41, v19
  s_waitcnt vmcnt(8)
  v_lshlrev_b32 v88, 16, v20
  v_and_b32 v89, s41, v20
  v_add_f32 v80, v80, v88
  v_add_f32 v81, v81, v89
  v_lshlrev_b32 v90, 16, v21
  v_and_b32 v91, s41, v21
  v_add_f32 v82, v82, v90
  v_add_f32 v83, v83, v91
  v_lshlrev_b32 v88, 16, v22
  v_and_b32 v89, s41, v22
  v_add_f32 v84, v84, v88
  v_add_f32 v85, v85, v89
  v_lshlrev_b32 v90, 16, v23
  v_and_b32 v91, s41, v23
  v_add_f32 v86, v86, v90
  v_add_f32 v87, v87, v91
  s_waitcnt vmcnt(7)
  v_lshlrev_b32 v88, 16, v24
  v_and_b32 v89, s41, v24
  v_add_f32 v80, v80, v88
  v_add_f32 v81, v81, v89
  v_lshlrev_b32 v90, 16, v25
  v_and_b32 v91, s41, v25
  v_add_f32 v82, v82, v90
  v_add_f32 v83, v83, v91
  v_lshlrev_b32 v88, 16, v26
  v_and_b32 v89, s41, v26
  v_add_f32 v84, v84, v88
  v_add_f32 v85, v85, v89
  v_lshlrev_b32 v90, 16, v27
  v_and_b32 v91, s41, v27
  v_add_f32 v86, v86, v90
  v_add_f32 v87, v87, v91
  s_waitcnt vmcnt(6)
  v_lshlrev_b32 v88, 16, v28
  v_and_b32 v89, s41, v28
  v_add_f32 v80, v80, v88
  v_add_f32 v81, v81, v89
  v_lshlrev_b32 v90, 16, v29
  v_and_b32 v91, s41, v29
  v_add_f32 v82, v82, v90
  v_add_f32 v83, v83, v91
  v_lshlrev_b32 v88, 16, v30
  v_and_b32 v89, s41, v30
  v_add_f32 v84, v84, v88
  v_add_f32 v85, v85, v89
  v_lshlrev_b32 v90, 16, v31
  v_and_b32 v91, s41, v31
  v_add_f32 v86, v86, v90
  v_add_f32 v87, v87, v91
  s_waitcnt vmcnt(5)
  v_lshlrev_b32 v88, 16, v32
  v_and_b32 v89, s41, v32
  v_add_f32 v80, v80, v88
  v_add_f32 v81, v81, v89
  v_lshlrev_b32 v90, 16, v33
  v_and_b32 v91, s41, v33
  v_add_f32 v82, v82, v90
  v_add_f32 v83, v83, v91
  v_lshlrev_b32 v88, 16, v34
  v_and_b32 v89, s41, v34
  v_add_f32 v84, v84, v88
  v_add_f32 v85, v85, v89
  v_lshlrev_b32 v90, 16, v35
  v_and_b32 v91, s41, v35
  v_add_f32 v86, v86, v90
  v_add_f32 v87, v87, v91
  s_waitcnt vmcnt(4)
  v_lshlrev_b32 v88, 16, v36
  v_and_b32 v89, s41, v36
  v_add_f32 v80, v80, v88
  v_add_f32 v81, v81, v89
  v_lshlrev_b32 v90, 16, v37
  v_and_b32 v91, s41, v37
  v_add_f32 v82, v82, v90
  v_add_f32 v83, v83, v91
  v_lshlrev_b32 v88, 16, v38
  v_and_b32 v89, s41, v38
  v_add_f32 v84, v84, v88
  v_add_f32 v85, v85, v89
  v_lshlrev_b32 v90, 16, v39
  v_and_b32 v91, s41, v39
  v_add_f32 v86, v86, v90
  v_add_f32 v87, v87, v91
  s_waitcnt vmcnt(3)
  v_lshlrev_b32 v88, 16, v40
  v_and_b32 v89, s41, v40
  v_add_f32 v80, v80, v88
  v_add_f32 v81, v81, v89
  v_lshlrev_b32 v90, 16, v41
  v_and_b32 v91, s41, v41
  v_add_f32 v82, v82, v90
  v_add_f32 v83, v83, v91
  v_lshlrev_b32 v88, 16, v42
  v_and_b32 v89, s41, v42
  v_add_f32 v84, v84, v88
  v_add_f32 v85, v85, v89
  v_lshlrev_b32 v90, 16, v43
  v_and_b32 v91, s41, v43
  v_add_f32 v86, v86, v90
  v_add_f32 v87, v87, v91
  s_waitcnt vmcnt(2)
  v_lshlrev_b32 v88, 16, v44
  v_and_b32 v89, s41, v44
  v_add_f32 v80, v80, v88
  v_add_f32 v81, v81, v89
  v_lshlrev_b32 v90, 16, v45
  v_and_b32 v91, s41, v45
  v_add_f32 v82, v82, v90
  v_add_f32 v83, v83, v91
  v_lshlrev_b32 v88, 16, v46
  v_and_b32 v89, s41, v46
  v_add_f32 v84, v84, v88
  v_add_f32 v85, v85, v89
  v_lshlrev_b32 v90, 16, v47
  v_and_b32 v91, s41, v47
  v_add_f32 v86, v86, v90
  v_add_f32 v87, v87, v91
  s_mov_b32 s42, 0x3f800000
  s_waitcnt vmcnt(1)
  v_lshlrev_b32 v88, 16, v8
  v_and_b32 v89, s41, v8
  v_fma_f32 v80, v80, s42, v88
  v_fma_f32 v81, v81, s42, v89
  v_lshlrev_b32 v90, 16, v9
  v_and_b32 v91, s41, v9
  v_fma_f32 v82, v82, s42, v90
  v_fma_f32 v83, v83, s42, v91
  s_waitcnt vmcnt(0)
  v_lshlrev_b32 v88, 16, v10
  v_and_b32 v89, s41, v10
  v_fma_f32 v84, v84, s42, v88
  v_fma_f32 v85, v85, s42, v89
  v_lshlrev_b32 v90, 16, v11
  v_and_b32 v91, s41, v11
  v_fma_f32 v86, v86, s42, v90
  v_fma_f32 v87, v87, s42, v91
  v_cvt_pk_bf16_f32 v92, v80, v81
  v_cvt_pk_bf16_f32 v93, v82, v83
  v_cvt_pk_bf16_f32 v94, v84, v85
  v_cvt_pk_bf16_f32 v95, v86, v87
  s_nop 0
  v_permlane16_swap_b32 v92, v94
  v_permlane16_swap_b32 v93, v95
  buffer_store_dwordx4 v[92:95], v6, s[24:27], 0 offen
  s_endpgm
K2_half:
  s_lshl_b32 s28, s22, 14
  s_sub_u32 s23, s23, 128
  s_lshl_b32 s29, s23, 10
  s_add_u32 s28, s28, s29
  s_add_u32 s28, s28, 16777216
  buffer_load_dwordx4 v[16:19], v5, s[12:15], s28 offen
  s_add_u32 s28, s28, 262144
  buffer_load_dwordx4 v[20:23], v5, s[12:15], s28 offen
  s_add_u32 s28, s28, 262144
  buffer_load_dwordx4 v[24:27], v5, s[12:15], s28 offen
  s_add_u32 s28, s28, 262144
  buffer_load_dwordx4 v[28:31], v5, s[12:15], s28 offen
  s_add_u32 s28, s28, 262144
  buffer_load_dwordx4 v[32:35], v5, s[12:15], s28 offen
  s_add_u32 s28, s28, 262144
  buffer_load_dwordx4 v[36:39], v5, s[12:15], s28 offen
  s_add_u32 s28, s28, 262144
  buffer_load_dwordx4 v[40:43], v5, s[12:15], s28 offen
  s_add_u32 s28, s28, 262144
  buffer_load_dwordx4 v[44:47], v5, s[12:15], s28 offen
  s_add_u32 s28, s28, 262144
  buffer_load_dwordx4 v[48:51], v5, s[12:15], s28 offen
  s_add_u32 s28, s28, 262144
  buffer_load_dwordx4 v[52:55], v5, s[12:15], s28 offen
  s_add_u32 s28, s28, 262144
  buffer_load_dwordx4 v[56:59], v5, s[12:15], s28 offen
  s_add_u32 s28, s28, 262144
  buffer_load_dwordx4 v[60:63], v5, s[12:15], s28 offen
  s_add_u32 s28, s28, 262144
  buffer_load_dwordx4 v[64:67], v5, s[12:15], s28 offen
  s_add_u32 s28, s28, 262144
  buffer_load_dwordx4 v[68:71], v5, s[12:15], s28 offen
  s_add_u32 s28, s28, 262144
  buffer_load_dwordx4 v[72:75], v5, s[12:15], s28 offen
  s_add_u32 s28, s28, 262144
  buffer_load_dwordx4 v[76:79], v5, s[12:15], s28 offen
  s_and_b32 s29, s23, 3
  s_lshr_b32 s31, s23, 2
  s_lshr_b32 s34, s31, 1
  s_lshl_b32 s35, s34, 5
  s_add_u32 s35, s35, 512
  s_and_b32 s33, s31, 1
  s_lshl_b32 s37, s22, 7
  s_lshl_b32 s38, s33, 6
  s_add_u32 s37, s37, s38
  s_lshl_b32 s38, s29, 4
  s_add_u32 s37, s37, s38
  v_add_u32 v6, s37, v3
  v_mul_u32_u24 v6, 1152, v6
  s_lshl_b32 s40, s35, 1
  v_add_u32 v6, s40, v6
  v_lshlrev_b32 v7, 3, v4
  v_add_u32 v7, v6, v7
  buffer_load_dwordx2 v[8:9], v7, s[8:11], 0 offen
  buffer_load_dwordx2 v[10:11], v7, s[8:11], 0 offen offset:32
  v_and_b32 v12, 1, v4
  v_lshlrev_b32 v12, 5, v12
  v_lshrrev_b32 v13, 1, v4
  v_lshlrev_b32 v13, 4, v13
  v_add3_u32 v6, v6, v12, v13
  s_mov_b32 s41, 0xffff0000
  s_waitcnt vmcnt(17)
  v_lshlrev_b32 v80, 16, v16
  v_and_b32 v81, s41, v16
  v_lshlrev_b32 v82, 16, v17
  v_and_b32 v83, s41, v17
  v_lshlrev_b32 v84, 16, v18
  v_and_b32 v85, s41, v18
  v_lshlrev_b32 v86, 16, v19
  v_and_b32 v87, s41, v19
  s_waitcnt vmcnt(16)
  v_lshlrev_b32 v88, 16, v20
  v_and_b32 v89, s41, v20
  v_add_f32 v80, v80, v88
  v_add_f32 v81, v81, v89
  v_lshlrev_b32 v90, 16, v21
  v_and_b32 v91, s41, v21
  v_add_f32 v82, v82, v90
  v_add_f32 v83, v83, v91
  v_lshlrev_b32 v88, 16, v22
  v_and_b32 v89, s41, v22
  v_add_f32 v84, v84, v88
  v_add_f32 v85, v85, v89
  v_lshlrev_b32 v90, 16, v23
  v_and_b32 v91, s41, v23
  v_add_f32 v86, v86, v90
  v_add_f32 v87, v87, v91
  s_waitcnt vmcnt(15)
  v_lshlrev_b32 v88, 16, v24
  v_and_b32 v89, s41, v24
  v_add_f32 v80, v80, v88
  v_add_f32 v81, v81, v89
  v_lshlrev_b32 v90, 16, v25
  v_and_b32 v91, s41, v25
  v_add_f32 v82, v82, v90
  v_add_f32 v83, v83, v91
  v_lshlrev_b32 v88, 16, v26
  v_and_b32 v89, s41, v26
  v_add_f32 v84, v84, v88
  v_add_f32 v85, v85, v89
  v_lshlrev_b32 v90, 16, v27
  v_and_b32 v91, s41, v27
  v_add_f32 v86, v86, v90
  v_add_f32 v87, v87, v91
  s_waitcnt vmcnt(14)
  v_lshlrev_b32 v88, 16, v28
  v_and_b32 v89, s41, v28
  v_add_f32 v80, v80, v88
  v_add_f32 v81, v81, v89
  v_lshlrev_b32 v90, 16, v29
  v_and_b32 v91, s41, v29
  v_add_f32 v82, v82, v90
  v_add_f32 v83, v83, v91
  v_lshlrev_b32 v88, 16, v30
  v_and_b32 v89, s41, v30
  v_add_f32 v84, v84, v88
  v_add_f32 v85, v85, v89
  v_lshlrev_b32 v90, 16, v31
  v_and_b32 v91, s41, v31
  v_add_f32 v86, v86, v90
  v_add_f32 v87, v87, v91
  s_waitcnt vmcnt(13)
  v_lshlrev_b32 v88, 16, v32
  v_and_b32 v89, s41, v32
  v_add_f32 v80, v80, v88
  v_add_f32 v81, v81, v89
  v_lshlrev_b32 v90, 16, v33
  v_and_b32 v91, s41, v33
  v_add_f32 v82, v82, v90
  v_add_f32 v83, v83, v91
  v_lshlrev_b32 v88, 16, v34
  v_and_b32 v89, s41, v34
  v_add_f32 v84, v84, v88
  v_add_f32 v85, v85, v89
  v_lshlrev_b32 v90, 16, v35
  v_and_b32 v91, s41, v35
  v_add_f32 v86, v86, v90
  v_add_f32 v87, v87, v91
  s_waitcnt vmcnt(12)
  v_lshlrev_b32 v88, 16, v36
  v_and_b32 v89, s41, v36
  v_add_f32 v80, v80, v88
  v_add_f32 v81, v81, v89
  v_lshlrev_b32 v90, 16, v37
  v_and_b32 v91, s41, v37
  v_add_f32 v82, v82, v90
  v_add_f32 v83, v83, v91
  v_lshlrev_b32 v88, 16, v38
  v_and_b32 v89, s41, v38
  v_add_f32 v84, v84, v88
  v_add_f32 v85, v85, v89
  v_lshlrev_b32 v90, 16, v39
  v_and_b32 v91, s41, v39
  v_add_f32 v86, v86, v90
  v_add_f32 v87, v87, v91
  s_waitcnt vmcnt(11)
  v_lshlrev_b32 v88, 16, v40
  v_and_b32 v89, s41, v40
  v_add_f32 v80, v80, v88
  v_add_f32 v81, v81, v89
  v_lshlrev_b32 v90, 16, v41
  v_and_b32 v91, s41, v41
  v_add_f32 v82, v82, v90
  v_add_f32 v83, v83, v91
  v_lshlrev_b32 v88, 16, v42
  v_and_b32 v89, s41, v42
  v_add_f32 v84, v84, v88
  v_add_f32 v85, v85, v89
  v_lshlrev_b32 v90, 16, v43
  v_and_b32 v91, s41, v43
  v_add_f32 v86, v86, v90
  v_add_f32 v87, v87, v91
  s_waitcnt vmcnt(10)
  v_lshlrev_b32 v88, 16, v44
  v_and_b32 v89, s41, v44
  v_add_f32 v80, v80, v88
  v_add_f32 v81, v81, v89
  v_lshlrev_b32 v90, 16, v45
  v_and_b32 v91, s41, v45
  v_add_f32 v82, v82, v90
  v_add_f32 v83, v83, v91
  v_lshlrev_b32 v88, 16, v46
  v_and_b32 v89, s41, v46
  v_add_f32 v84, v84, v88
  v_add_f32 v85, v85, v89
  v_lshlrev_b32 v90, 16, v47
  v_and_b32 v91, s41, v47
  v_add_f32 v86, v86, v90
  v_add_f32 v87, v87, v91
  s_waitcnt vmcnt(9)
  v_lshlrev_b32 v88, 16, v48
  v_and_b32 v89, s41, v48
  v_add_f32 v80, v80, v88
  v_add_f32 v81, v81, v89
  v_lshlrev_b32 v90, 16, v49
  v_and_b32 v91, s41, v49
  v_add_f32 v82, v82, v90
  v_add_f32 v83, v83, v91
  v_lshlrev_b32 v88, 16, v50
  v_and_b32 v89, s41, v50
  v_add_f32 v84, v84, v88
  v_add_f32 v85, v85, v89
  v_lshlrev_b32 v90, 16, v51
  v_and_b32 v91, s41, v51
  v_add_f32 v86, v86, v90
  v_add_f32 v87, v87, v91
  s_waitcnt vmcnt(8)
  v_lshlrev_b32 v88, 16, v52
  v_and_b32 v89, s41, v52
  v_add_f32 v80, v80, v88
  v_add_f32 v81, v81, v89
  v_lshlrev_b32 v90, 16, v53
  v_and_b32 v91, s41, v53
  v_add_f32 v82, v82, v90
  v_add_f32 v83, v83, v91
  v_lshlrev_b32 v88, 16, v54
  v_and_b32 v89, s41, v54
  v_add_f32 v84, v84, v88
  v_add_f32 v85, v85, v89
  v_lshlrev_b32 v90, 16, v55
  v_and_b32 v91, s41, v55
  v_add_f32 v86, v86, v90
  v_add_f32 v87, v87, v91
  s_waitcnt vmcnt(7)
  v_lshlrev_b32 v88, 16, v56
  v_and_b32 v89, s41, v56
  v_add_f32 v80, v80, v88
  v_add_f32 v81, v81, v89
  v_lshlrev_b32 v90, 16, v57
  v_and_b32 v91, s41, v57
  v_add_f32 v82, v82, v90
  v_add_f32 v83, v83, v91
  v_lshlrev_b32 v88, 16, v58
  v_and_b32 v89, s41, v58
  v_add_f32 v84, v84, v88
  v_add_f32 v85, v85, v89
  v_lshlrev_b32 v90, 16, v59
  v_and_b32 v91, s41, v59
  v_add_f32 v86, v86, v90
  v_add_f32 v87, v87, v91
  s_waitcnt vmcnt(6)
  v_lshlrev_b32 v88, 16, v60
  v_and_b32 v89, s41, v60
  v_add_f32 v80, v80, v88
  v_add_f32 v81, v81, v89
  v_lshlrev_b32 v90, 16, v61
  v_and_b32 v91, s41, v61
  v_add_f32 v82, v82, v90
  v_add_f32 v83, v83, v91
  v_lshlrev_b32 v88, 16, v62
  v_and_b32 v89, s41, v62
  v_add_f32 v84, v84, v88
  v_add_f32 v85, v85, v89
  v_lshlrev_b32 v90, 16, v63
  v_and_b32 v91, s41, v63
  v_add_f32 v86, v86, v90
  v_add_f32 v87, v87, v91
  s_waitcnt vmcnt(5)
  v_lshlrev_b32 v88, 16, v64
  v_and_b32 v89, s41, v64
  v_add_f32 v80, v80, v88
  v_add_f32 v81, v81, v89
  v_lshlrev_b32 v90, 16, v65
  v_and_b32 v91, s41, v65
  v_add_f32 v82, v82, v90
  v_add_f32 v83, v83, v91
  v_lshlrev_b32 v88, 16, v66
  v_and_b32 v89, s41, v66
  v_add_f32 v84, v84, v88
  v_add_f32 v85, v85, v89
  v_lshlrev_b32 v90, 16, v67
  v_and_b32 v91, s41, v67
  v_add_f32 v86, v86, v90
  v_add_f32 v87, v87, v91
  s_waitcnt vmcnt(4)
  v_lshlrev_b32 v88, 16, v68
  v_and_b32 v89, s41, v68
  v_add_f32 v80, v80, v88
  v_add_f32 v81, v81, v89
  v_lshlrev_b32 v90, 16, v69
  v_and_b32 v91, s41, v69
  v_add_f32 v82, v82, v90
  v_add_f32 v83, v83, v91
  v_lshlrev_b32 v88, 16, v70
  v_and_b32 v89, s41, v70
  v_add_f32 v84, v84, v88
  v_add_f32 v85, v85, v89
  v_lshlrev_b32 v90, 16, v71
  v_and_b32 v91, s41, v71
  v_add_f32 v86, v86, v90
  v_add_f32 v87, v87, v91
  s_waitcnt vmcnt(3)
  v_lshlrev_b32 v88, 16, v72
  v_and_b32 v89, s41, v72
  v_add_f32 v80, v80, v88
  v_add_f32 v81, v81, v89
  v_lshlrev_b32 v90, 16, v73
  v_and_b32 v91, s41, v73
  v_add_f32 v82, v82, v90
  v_add_f32 v83, v83, v91
  v_lshlrev_b32 v88, 16, v74
  v_and_b32 v89, s41, v74
  v_add_f32 v84, v84, v88
  v_add_f32 v85, v85, v89
  v_lshlrev_b32 v90, 16, v75
  v_and_b32 v91, s41, v75
  v_add_f32 v86, v86, v90
  v_add_f32 v87, v87, v91
  s_waitcnt vmcnt(2)
  v_lshlrev_b32 v88, 16, v76
  v_and_b32 v89, s41, v76
  v_add_f32 v80, v80, v88
  v_add_f32 v81, v81, v89
  v_lshlrev_b32 v90, 16, v77
  v_and_b32 v91, s41, v77
  v_add_f32 v82, v82, v90
  v_add_f32 v83, v83, v91
  v_lshlrev_b32 v88, 16, v78
  v_and_b32 v89, s41, v78
  v_add_f32 v84, v84, v88
  v_add_f32 v85, v85, v89
  v_lshlrev_b32 v90, 16, v79
  v_and_b32 v91, s41, v79
  v_add_f32 v86, v86, v90
  v_add_f32 v87, v87, v91
  s_mov_b32 s42, 0x3f800000
  s_waitcnt vmcnt(1)
  v_lshlrev_b32 v88, 16, v8
  v_and_b32 v89, s41, v8
  v_fma_f32 v80, v80, s42, v88
  v_fma_f32 v81, v81, s42, v89
  v_lshlrev_b32 v90, 16, v9
  v_and_b32 v91, s41, v9
  v_fma_f32 v82, v82, s42, v90
  v_fma_f32 v83, v83, s42, v91
  s_waitcnt vmcnt(0)
  v_lshlrev_b32 v88, 16, v10
  v_and_b32 v89, s41, v10
  v_fma_f32 v84, v84, s42, v88
  v_fma_f32 v85, v85, s42, v89
  v_lshlrev_b32 v90, 16, v11
  v_and_b32 v91, s41, v11
  v_fma_f32 v86, v86, s42, v90
  v_fma_f32 v87, v87, s42, v91
  v_cvt_pk_bf16_f32 v92, v80, v81
  v_cvt_pk_bf16_f32 v93, v82, v83
  v_cvt_pk_bf16_f32 v94, v84, v85
  v_cvt_pk_bf16_f32 v95, v86, v87
  s_nop 0
  v_permlane16_swap_b32 v92, v94
  v_permlane16_swap_b32 v93, v95
  buffer_store_dwordx4 v[92:95], v6, s[24:27], 0 offen
K2_end:
  s_endpgm
.section .rodata,"a"
.p2align 6
.amdhsa_kernel k0_ln_kernel
  .amdhsa_next_free_vgpr 64
  .amdhsa_next_free_sgpr 102
  .amdhsa_accum_offset 64
  .amdhsa_group_segment_fixed_size 0
  .amdhsa_kernarg_size 80
  .amdhsa_user_sgpr_count 2
  .amdhsa_user_sgpr_kernarg_segment_ptr 1
  .amdhsa_system_sgpr_workgroup_id_x 1
.end_amdhsa_kernel
.p2align 6
.amdhsa_kernel k1_main_kernel
  .amdhsa_next_free_vgpr 512
  .amdhsa_next_free_sgpr 102
  .amdhsa_accum_offset 256
  .amdhsa_group_segment_fixed_size 0
  .amdhsa_kernarg_size 80
  .amdhsa_user_sgpr_count 2
  .amdhsa_user_sgpr_kernarg_segment_ptr 1
  .amdhsa_system_sgpr_workgroup_id_x 1
.end_amdhsa_kernel
.p2align 6
.amdhsa_kernel k2_reduce_kernel
  .amdhsa_next_free_vgpr 96
  .amdhsa_next_free_sgpr 102
  .amdhsa_accum_offset 96
  .amdhsa_group_segment_fixed_size 0
  .amdhsa_kernarg_size 80
  .amdhsa_user_sgpr_count 2
  .amdhsa_user_sgpr_kernarg_segment_ptr 1
  .amdhsa_system_sgpr_workgroup_id_x 1
.end_amdhsa_kernel
```
